```python
import torch

def _softmax(x, axis=-1):
    return torch.softmax(x, dim=axis)

def _gelu(x):
    return torch.nn.functional.gelu(x, approximate='tanh')

def _silu(x):
    return torch.nn.functional.silu(x)

def _sigmoid(x):
    return torch.sigmoid(x)

def _layernorm(x, axis=-1, eps=1e-05):
    m = x.mean(dim=axis, keepdim=True)
    v = x.var(dim=axis, keepdim=True, unbiased=False)
    return (x - m) / torch.sqrt(v + eps)

def _scatter_add(tgt, idx, src, axis=0):
    return tgt.clone().index_add_(axis, idx, src)

def _segment_sum(src, seg, n):
    out = torch.zeros((n,) + src.shape[1:], dtype=src.dtype)
    return out.index_add_(0, seg, src)

def _pad(x, pw):
    flat = tuple((v for pair in reversed(pw) for v in pair))
    return torch.nn.functional.pad(x, flat)
kernel_name = 'sequential_preLN__linear_kernel_hedgehog__mixer_gmlp__prompt'

def setup_inputs():

    _w = lambda a: (lambda t: t.to(torch.bfloat16) if t.is_floating_point() else t)(torch.as_tensor(a))

    def _A_setup():
        B, S, D, H = (1, 2048, 1024, 32)
        Dh = D // H
        return {'x': _w((lambda *s: torch.randn(*s, dtype=torch.bfloat16) * 0.05)(B, S, D)), 'wqkv': _w((lambda *s: torch.randn(*s, dtype=torch.bfloat16) * 0.2)(D, 3 * D)), 'w_phi': _w((lambda *s: torch.randn(*s, dtype=torch.bfloat16) * 0.2)(H, Dh, Dh) * Dh ** (-0.5)), 'wo': _w((lambda *s: torch.randn(*s, dtype=torch.bfloat16) * 0.05)(D, D))}
    _A_in = _A_setup()

    def _B_setup():
        B, S, D, F = (1, 2048, 1024, 3584)
        Fh = F // 2
        return {'x': _w((lambda *s: torch.randn(*s, dtype=torch.bfloat16) * 0.05)(B, S, D)), 'w_in': _w((lambda *s: torch.randn(*s, dtype=torch.bfloat16) * 0.2)(D, 2 * Fh)), 'w_sp': _w(0.01 * (lambda *s: torch.randn(*s, dtype=torch.bfloat16) * 0.2)(S, S)), 'b_sp': _w(1.0 + 0.01 * (lambda *s: torch.randn(*s, dtype=torch.bfloat16) * 0.05)(S)), 'w_out': _w((lambda *s: torch.randn(*s, dtype=torch.bfloat16) * 0.05)(Fh, D))}
    _B_in = _B_setup()
    return {'A_x': _A_in['x'], 'A_wqkv': _A_in['wqkv'], 'A_w_phi': _A_in['w_phi'], 'A_wo': _A_in['wo'], 'B_x': _B_in['x'], 'B_w_in': _B_in['w_in'], 'B_w_sp': _B_in['w_sp'], 'B_b_sp': _B_in['b_sp'], 'B_w_out': _B_in['w_out']}

def reference(A_x, A_wqkv, A_w_phi, A_wo, B_x, B_w_in, B_w_sp, B_b_sp, B_w_out):

    def _A_ref(x, wqkv, w_phi, wo):
        B, S, D = x.shape
        H = 32
        Dh = D // H
        qkv = (lambda x, *d: x.permute(*d))((x @ wqkv).reshape(B, S, 3, H, Dh), 2, 0, 3, 1, 4)
        q, k, v = (qkv[0], qkv[1], qkv[2])
        pq = torch.einsum('bhsd,hdf->bhsf', q, w_phi)
        pk = torch.einsum('bhsd,hdf->bhsf', k, w_phi)
        phi_q = torch.concatenate([_softmax(pq, axis=-1), _softmax(-pq, axis=-1)], axis=-1)
        phi_k = torch.concatenate([_softmax(pk, axis=-1), _softmax(-pk, axis=-1)], axis=-1)
        kv = torch.einsum('bhsf,bhsd->bhfd', phi_k, v)
        z = torch.einsum('bhsf->bhf', phi_k)
        num = torch.einsum('bhqf,bhfd->bhqd', phi_q, kv)
        den = torch.einsum('bhqf,bhf->bhq', phi_q, z)[..., None] + 1e-06
        o = num / den
        return (lambda x, *d: x.permute(*d))(o, 0, 2, 1, 3).reshape(B, S, D) @ wo

    def _B_ref(x, w_in, w_sp, b_sp, w_out):
        B, S, D = x.shape
        F = w_in.shape[-1]
        Fh = F // 2
        z = _gelu(torch.einsum('bsd,df->bsf', x, w_in))
        z1 = z[..., :Fh].clone()
        z2 = _layernorm(z[..., Fh:], axis=-1)
        g = torch.einsum('ts,bsf->btf', w_sp, z2) + b_sp[None, :, None]
        return torch.einsum('bsf,fd->bsd', z1 * g, w_out)
    x = A_x
    h = x + _A_ref(_layernorm(x, axis=-1), A_wqkv, A_w_phi, A_wo)
    h2 = h + _B_ref(_layernorm(h, axis=-1), B_w_in, B_w_sp, B_b_sp, B_w_out)
    return h2
```

```asm
; @launch grid=(256,1,1) block=(512,1,1) lds=163840
.amdgcn_target "amdgcn-amd-amdhsa--gfx950"
.text
.globl sequential_preLN__linear_kernel_hedgehog__mixer_gmlp__prompt_kernel
.p2align 8
.type sequential_preLN__linear_kernel_hedgehog__mixer_gmlp__prompt_kernel,@function
sequential_preLN__linear_kernel_hedgehog__mixer_gmlp__prompt_kernel:
    s_cmp_ge_u32 s2, 256
    s_cbranch_scc1 .end_1
    s_load_dwordx16 s[4:19], s[0:1], 0
    s_load_dwordx8 s[20:27], s[0:1], 64
    v_lshrrev_b32 v2, 6, v0
    v_and_b32 v1, 63, v0
    v_readfirstlane_b32 s32, v2
    s_bfe_u32 s36, s2, 0x30003
    s_lshr_b32 s28, s2, 6
    s_bfe_u32 s29, s2, 0x20001
    s_lshl2_add_u32 s33, s29, s28
    s_and_b32 s28, s2, 1
    s_lshl3_add_u32 s34, s28, s36
    s_sub_u32 s35, s34, s28
    s_xor_b32 s34, s34, 4
    s_mov_b32 s38, 100000
    s_mov_b32 s40, 1
    s_and_b32 s37, s32, 1
    s_sub_u32 s29, 14, 7
    s_bitcmp1_b32 s2, 0
    s_cselect_b32 s28, 7, 0
    s_cselect_b32 s29, s29, 7
    s_add_u32 s35, s28, s36
    s_cmp_ge_u32 s36, s29
    s_cselect_b32 s35, 14, s35
    s_xor_b32 s39, s2, s36
    s_not_b32 s39, s39
    s_and_b32 s39, s39, 1
    s_cmp_lt_u32 s32, 4
    s_cbranch_scc1 .cmp_5
    s_setprio 2
    s_cmp_eq_u32 s32, 7
    s_cbranch_scc1 .aux_4
    s_cmp_lt_u32 s32, 6
    s_cbranch_scc1 .ldA_2
.ldW_3:
    s_sub_u32 s29, s33, s36
    s_and_b32 s29, s29, 3
    s_xor_b32 s30, s33, s34
    s_and_b32 s30, s30, 8
    s_sub_u32 s29, 4, s29
    v_add3_u32 v2, v1, s29, -1
    v_lshrrev_b32 v2, 2, v2
    v_add_u32 v3, s29, v1
    v_lshrrev_b32 v3, 2, v3
    v_add_u32 v4, 2, v1
    v_min_u32 v4, 15, v4
    v_add_u32 v4, s29, v4
    v_lshrrev_b32 v4, 2, v4
    v_sub_u32 v4, v4, v2
    v_add_u32 v4, v4, v1
    v_subrev_u32 v5, 2, v1
    v_max_i32_e64 v5, 0, v5
    v_add3_u32 v6, v5, s29, -1
    v_lshrrev_b32 v6, 2, v6
    v_sub_u32 v5, v5, v6
    v_add_u32 v5, v5, v2
    v_cmp_ne_u32 vcc, v3, v2
    s_nop 1
    v_cndmask_b32 v5, v4, v5, vcc
    v_max_u32_e64 v5, 1, v5
    v_writelane_b32 v5, 0, 0
    v_cmp_gt_u32 vcc, 16, v1
    s_nop 1
    v_cndmask_b32_e64 v5, v1, v5, vcc
    v_add_lshl_u32 v5, v5, 0, 2
    v_add_u32 v6, s30, v1
    v_and_b32 v6, 15, v6
    v_mul_u32_u24 v6, 393216, v6
    ds_permute_b32 v72, v5, v6
    v_lshrrev_b32 v2, 3, v1
    v_lshrrev_b32 v4, 2, v1
    v_and_b32_e64 v4, 4, v4
    v_mul_u32_u24 v2, 6144, v2
    v_and_b32 v3, 7, v1
    v_xor_b32 v3, v3, v4
    v_lshl_add_u32 v8, v3, 4, v2
    v_xor_b32_e64 v9, 32, v8
    v_add_u32 v9, 48128, v9
    v_add_u32 v10, 96256, v8
    v_add_u32 v11, 96256, v9
    v_add_u32 v12, 196608, v8
    v_add_u32 v13, 196608, v9
    v_add_u32 v14, 196608, v10
    v_add_u32 v15, 196608, v11
    v_add_u32 v16, 2048, v8
    v_add_u32 v17, 2048, v9
    v_add_u32 v18, 2048, v10
    v_add_u32 v19, 2048, v11
    v_add_u32 v20, 198656, v8
    v_add_u32 v21, 198656, v9
    v_add_u32 v22, 198656, v10
    v_add_u32 v23, 198656, v11
    s_waitcnt lgkmcnt(0)
    s_lshl_b32 s28, s34, 7
    s_add_u32 s70, s28, 2048
    s_add_u32 s68, s6, s70
    s_addc_u32 s69, s7, 0
    s_mov_b32 s70, 0
    s_mov_b32 s71, 0x20000
    s_sub_u32 s70, 6289408, s28
    s_mov_b32 s64, 65536
    s_mov_b32 s66, 0
    s_mov_b32 m0, s64
    s_waitcnt lgkmcnt(0)
    v_readlane_b32 s65, v72, 0
    s_nop 4
    s_mov_b32 s85, 2
.ll_6:
    buffer_load_dwordx4 v8, s[68:71], s65 offen offset:0 lds
    buffer_load_dwordx4 v9, s[68:71], s65 offen offset:1024 lds
    buffer_load_dwordx4 v10, s[68:71], s65 offen offset:2048 lds
    buffer_load_dwordx4 v11, s[68:71], s65 offen offset:3072 lds
    s_add_u32 m0, m0, 4096
    s_add_u32 s64, s64, 16384
    s_cmp_eq_u32 s64, 147456
    s_cselect_b32 s64, 65536, s64
    buffer_load_dwordx4 v12, s[68:71], s65 offen offset:0 lds
    buffer_load_dwordx4 v13, s[68:71], s65 offen offset:1024 lds
    buffer_load_dwordx4 v14, s[68:71], s65 offen offset:2048 lds
    buffer_load_dwordx4 v15, s[68:71], s65 offen offset:3072 lds
    s_add_u32 m0, m0, 4096
    s_add_u32 s66, s66, 1
    v_readlane_b32 s84, v72, s66
    buffer_load_dwordx4 v16, s[68:71], s65 offen offset:0 lds
    buffer_load_dwordx4 v17, s[68:71], s65 offen offset:1024 lds
    buffer_load_dwordx4 v18, s[68:71], s65 offen offset:2048 lds
    buffer_load_dwordx4 v19, s[68:71], s65 offen offset:3072 lds
    s_add_u32 m0, m0, 4096
    s_sub_u32 s85, s85, 1
    s_cmp_lg_u32 s85, 0
    buffer_load_dwordx4 v20, s[68:71], s65 offen offset:0 lds
    buffer_load_dwordx4 v21, s[68:71], s65 offen offset:1024 lds
    buffer_load_dwordx4 v22, s[68:71], s65 offen offset:2048 lds
    buffer_load_dwordx4 v23, s[68:71], s65 offen offset:3072 lds
    s_mov_b32 m0, s64
    s_mov_b32 s65, s84
    s_cbranch_scc1 .ll_6
    s_waitcnt vmcnt(16)
    s_barrier
    buffer_load_dwordx4 v8, s[68:71], s65 offen offset:0 lds
    buffer_load_dwordx4 v9, s[68:71], s65 offen offset:1024 lds
    buffer_load_dwordx4 v10, s[68:71], s65 offen offset:2048 lds
    buffer_load_dwordx4 v11, s[68:71], s65 offen offset:3072 lds
    s_add_u32 m0, m0, 4096
    s_add_u32 s64, s64, 16384
    s_cmp_eq_u32 s64, 147456
    s_cselect_b32 s64, 65536, s64
    buffer_load_dwordx4 v12, s[68:71], s65 offen offset:0 lds
    buffer_load_dwordx4 v13, s[68:71], s65 offen offset:1024 lds
    buffer_load_dwordx4 v14, s[68:71], s65 offen offset:2048 lds
    buffer_load_dwordx4 v15, s[68:71], s65 offen offset:3072 lds
    s_add_u32 m0, m0, 4096
    s_nop 0
    s_add_u32 s66, s66, 1
    v_readlane_b32 s84, v72, s66
    buffer_load_dwordx4 v16, s[68:71], s65 offen offset:0 lds
    buffer_load_dwordx4 v17, s[68:71], s65 offen offset:1024 lds
    buffer_load_dwordx4 v18, s[68:71], s65 offen offset:2048 lds
    buffer_load_dwordx4 v19, s[68:71], s65 offen offset:3072 lds
    s_add_u32 m0, m0, 4096
    s_nop 0
    buffer_load_dwordx4 v20, s[68:71], s65 offen offset:0 lds
    buffer_load_dwordx4 v21, s[68:71], s65 offen offset:1024 lds
    buffer_load_dwordx4 v22, s[68:71], s65 offen offset:2048 lds
    buffer_load_dwordx4 v23, s[68:71], s65 offen offset:3072 lds
    s_mov_b32 m0, s64
    s_mov_b32 s65, s84
    s_mov_b32 s85, 13
.ll_7:
    s_waitcnt vmcnt(16)
    buffer_load_dwordx4 v8, s[68:71], s65 offen offset:0 lds
    buffer_load_dwordx4 v9, s[68:71], s65 offen offset:1024 lds
    buffer_load_dwordx4 v10, s[68:71], s65 offen offset:2048 lds
    s_barrier
    buffer_load_dwordx4 v11, s[68:71], s65 offen offset:3072 lds
    s_add_u32 m0, m0, 4096
    s_add_u32 s64, s64, 16384
    s_cmp_eq_u32 s64, 147456
    s_cselect_b32 s64, 65536, s64
    buffer_load_dwordx4 v12, s[68:71], s65 offen offset:0 lds
    buffer_load_dwordx4 v13, s[68:71], s65 offen offset:1024 lds
    buffer_load_dwordx4 v14, s[68:71], s65 offen offset:2048 lds
    buffer_load_dwordx4 v15, s[68:71], s65 offen offset:3072 lds
    s_add_u32 m0, m0, 4096
    s_add_u32 s66, s66, 1
    v_readlane_b32 s84, v72, s66
    buffer_load_dwordx4 v16, s[68:71], s65 offen offset:0 lds
    buffer_load_dwordx4 v17, s[68:71], s65 offen offset:1024 lds
    buffer_load_dwordx4 v18, s[68:71], s65 offen offset:2048 lds
    buffer_load_dwordx4 v19, s[68:71], s65 offen offset:3072 lds
    s_add_u32 m0, m0, 4096
    s_sub_u32 s85, s85, 1
    s_cmp_lg_u32 s85, 0
    buffer_load_dwordx4 v20, s[68:71], s65 offen offset:0 lds
    buffer_load_dwordx4 v21, s[68:71], s65 offen offset:1024 lds
    buffer_load_dwordx4 v22, s[68:71], s65 offen offset:2048 lds
    buffer_load_dwordx4 v23, s[68:71], s65 offen offset:3072 lds
    s_mov_b32 m0, s64
    s_mov_b32 s65, s84
    s_cbranch_scc1 .ll_7
    s_waitcnt vmcnt(16)
    s_barrier
    s_waitcnt vmcnt(0)
    s_barrier
    s_branch .cont_8
.ldA_2:
    s_sub_u32 s29, s33, s36
    s_and_b32 s29, s29, 3
    s_xor_b32 s30, s33, s34
    s_and_b32 s30, s30, 8
    s_sub_u32 s29, 4, s29
    v_add3_u32 v2, v1, s29, -1
    v_lshrrev_b32 v2, 2, v2
    v_add_u32 v3, s29, v1
    v_lshrrev_b32 v3, 2, v3
    v_add_u32 v4, 2, v1
    v_min_u32 v4, 15, v4
    v_add_u32 v4, s29, v4
    v_lshrrev_b32 v4, 2, v4
    v_sub_u32 v4, v4, v2
    v_add_u32 v4, v4, v1
    v_subrev_u32 v5, 2, v1
    v_max_i32_e64 v5, 0, v5
    v_add3_u32 v6, v5, s29, -1
    v_lshrrev_b32 v6, 2, v6
    v_sub_u32 v5, v5, v6
    v_add_u32 v5, v5, v2
    v_cmp_ne_u32 vcc, v3, v2
    s_nop 1
    v_cndmask_b32 v5, v4, v5, vcc
    v_max_u32_e64 v5, 1, v5
    v_writelane_b32 v5, 0, 0
    v_cmp_gt_u32 vcc, 16, v1
    s_nop 1
    v_cndmask_b32_e64 v5, v1, v5, vcc
    v_add_lshl_u32 v5, v5, 0, 2
    v_add_u32 v6, s30, v1
    v_and_b32 v6, 15, v6
    v_mul_u32_u24 v6, 128, v6
    ds_permute_b32 v72, v5, v6
    v_lshrrev_b32_e64 v2, 3, v1
    v_lshl_add_u32 v2, s37, 6, v2
    v_mul_u32_u24 v2, 2048, v2
    v_lshrrev_b32 v4, 4, v1
    v_and_b32 v3, 7, v1
    v_xor_b32_e64 v3, v3, v4
    v_lshl_add_u32 v8, v3, 4, v2
    v_xor_b32_e64 v9, 64, v8
    v_add_u32 v9, 15360, v9
    v_add_u32 v10, 30720, v8
    v_add_u32 v11, 30720, v9
    v_add_u32 v12, 65536, v8
    v_add_u32 v13, 65536, v9
    v_add_u32 v14, 65536, v10
    v_add_u32 v15, 65536, v11
    s_waitcnt lgkmcnt(0)
    s_mul_i32 s28, s33, 262144
    s_add_u32 s68, s4, s28
    s_addc_u32 s69, s5, 0
    s_mov_b32 s70, 262144
    s_mov_b32 s71, 0x20000
    s_lshl_b32 s64, s37, 13
    s_mov_b32 s66, 0
    s_mov_b32 m0, s64
    s_waitcnt lgkmcnt(0)
    v_readlane_b32 s65, v72, 0
    s_nop 4
    s_nop 0
    s_mov_b32 s85, 2
.ll_24:
    buffer_load_dwordx4 v8, s[68:71], s65 offen offset:0 lds
    buffer_load_dwordx4 v9, s[68:71], s65 offen offset:1024 lds
    buffer_load_dwordx4 v10, s[68:71], s65 offen offset:2048 lds
    buffer_load_dwordx4 v11, s[68:71], s65 offen offset:3072 lds
    s_add_u32 m0, m0, 4096
    s_add_u32 s66, s66, 1
    v_readlane_b32 s84, v72, s66
    s_add_u32 s64, s64, 16384
    s_and_b32 s64, s64, 0xffff
    s_sub_u32 s85, s85, 1
    s_cmp_lg_u32 s85, 0
    buffer_load_dwordx4 v12, s[68:71], s65 offen offset:0 lds
    buffer_load_dwordx4 v13, s[68:71], s65 offen offset:1024 lds
    buffer_load_dwordx4 v14, s[68:71], s65 offen offset:2048 lds
    buffer_load_dwordx4 v15, s[68:71], s65 offen offset:3072 lds
    s_mov_b32 m0, s64
    s_mov_b32 s65, s84
    s_cbranch_scc1 .ll_24
    s_waitcnt vmcnt(8)
    s_barrier
    buffer_load_dwordx4 v8, s[68:71], s65 offen offset:0 lds
    buffer_load_dwordx4 v9, s[68:71], s65 offen offset:1024 lds
    buffer_load_dwordx4 v10, s[68:71], s65 offen offset:2048 lds
    buffer_load_dwordx4 v11, s[68:71], s65 offen offset:3072 lds
    s_add_u32 m0, m0, 4096
    s_nop 0
    s_add_u32 s66, s66, 1
    v_readlane_b32 s84, v72, s66
    s_add_u32 s64, s64, 16384
    s_and_b32 s64, s64, 0xffff
    buffer_load_dwordx4 v12, s[68:71], s65 offen offset:0 lds
    buffer_load_dwordx4 v13, s[68:71], s65 offen offset:1024 lds
    buffer_load_dwordx4 v14, s[68:71], s65 offen offset:2048 lds
    buffer_load_dwordx4 v15, s[68:71], s65 offen offset:3072 lds
    s_mov_b32 m0, s64
    s_mov_b32 s65, s84
    s_mov_b32 s85, 13
.ll_25:
    s_waitcnt vmcnt(8)
    buffer_load_dwordx4 v8, s[68:71], s65 offen offset:0 lds
    buffer_load_dwordx4 v9, s[68:71], s65 offen offset:1024 lds
    buffer_load_dwordx4 v10, s[68:71], s65 offen offset:2048 lds
    s_barrier
    buffer_load_dwordx4 v11, s[68:71], s65 offen offset:3072 lds
    s_add_u32 m0, m0, 4096
    s_add_u32 s66, s66, 1
    v_readlane_b32 s84, v72, s66
    s_add_u32 s64, s64, 16384
    s_and_b32 s64, s64, 0xffff
    s_sub_u32 s85, s85, 1
    s_cmp_lg_u32 s85, 0
    buffer_load_dwordx4 v12, s[68:71], s65 offen offset:0 lds
    buffer_load_dwordx4 v13, s[68:71], s65 offen offset:1024 lds
    buffer_load_dwordx4 v14, s[68:71], s65 offen offset:2048 lds
    buffer_load_dwordx4 v15, s[68:71], s65 offen offset:3072 lds
    s_mov_b32 m0, s64
    s_mov_b32 s65, s84
    s_cbranch_scc1 .ll_25
    s_waitcnt vmcnt(8)
    s_barrier
    s_waitcnt vmcnt(0)
    s_barrier
    s_branch .cont_26
.aux_4:
    s_getpc_b64 s[68:69]
.pc_46:
    s_sub_u32 s68, s68, .pc_46-sequential_preLN__linear_kernel_hedgehog__mixer_gmlp__prompt_kernel
    s_subb_u32 s69, s69, 0
    s_lshr_b32 s28, s2, 3
    s_lshl_b32 s28, s28, 8
    s_add_u32 s76, s68, s28
    s_addc_u32 s77, s69, 0
    s_mov_b32 s70, .end_1-sequential_preLN__linear_kernel_hedgehog__mixer_gmlp__prompt_kernel
    s_mov_b32 s71, 0x20000
    s_lshr_b32 s28, s2, 3
    s_lshl_b32 s28, s28, 11
    v_lshl_add_u32 v4, v1, 5, s28
    buffer_load_dword v152, v4, s[68:71], 0 offen
    v_lshlrev_b32 v153, 2, v1
    v_mov_b32 v136, 0
    v_mov_b32 v137, 0
    v_mov_b32 v138, 0
    v_mov_b32_e64 v139, 0
    v_add_u32 v4, 151040, v153
    ds_write_b32 v4, v136
    s_mul_i32 s28, s2, 22
    v_add_u32 v2, s28, v1
    v_and_b32 v3, 3, v2
    v_lshrrev_b32 v2, 2, v2
    v_lshlrev_b32_e64 v2, 11, v2
    v_lshl_add_u32 v2, v3, 7, v2
    v_lshlrev_b32_e64 v5, 4, v1
    s_mul_i32 s29, s2, 2688
    s_waitcnt lgkmcnt(0)
    s_add_u32 s52, s26, 35651584
    s_addc_u32 s53, s27, 0
    s_mov_b32 s54, 360448
    s_mov_b32 s55, 0x20000
    s_add_u32 s60, s26, 34603008
    s_addc_u32 s61, s27, 0
    s_mov_b32 s62, 86016
    s_mov_b32 s63, 0x20000
    s_cmp_ge_u32 s2, 32
    s_cbranch_scc1 .nz_47
    s_mov_b64 exec, 0x3fffff
    buffer_store_dword v136, v2, s[52:55], 0 offen sc1
    s_mov_b64 exec, -1
    buffer_store_dwordx4 v[136:139], v5, s[60:63], s29 offen offset:0 sc1
    buffer_store_dwordx4 v[136:139], v5, s[60:63], s29 offen offset:1024 sc1
    buffer_store_dwordx4 v[136:139], v5, s[60:63], s29 offen offset:1664 sc1
.nz_47:
    s_lshl_b32 s28, s34, 12
    s_add_u32 s68, s8, s28
    s_addc_u32 s69, s9, 0
    s_mov_b32 s70, 4096
    s_mov_b32 s71, 0x20000
    v_lshlrev_b32 v4, 4, v1
    s_mov_b32 m0, 155648
    s_nop 0
    buffer_load_dwordx4 v4, s[68:71], 0 offen offset:0 lds
    buffer_load_dwordx4 v4, s[68:71], 0 offen offset:1024 lds
    buffer_load_dwordx4 v4, s[68:71], 0 offen offset:2048 lds
    buffer_load_dwordx4 v4, s[68:71], 0 offen offset:3072 lds
    s_lshl_b32 s28, s33, 8
    s_add_u32 s72, s18, s28
    s_addc_u32 s73, s19, 0
    s_mov_b32 s74, 256
    s_mov_b32 s75, 0x20000
    s_mov_b32 m0, 159744
    s_nop 0
    buffer_load_dword v153, s[72:75], 0 offen lds
    s_barrier
    s_cmp_ge_u32 s2, 32
    s_cbranch_scc1 .nz_48
    s_lshl_b32 s28, s2, 2
    s_and_b32 s28, s28, 28
    s_waitcnt vmcnt(5)
    s_atomic_add s40, s[24:25], s28 offset:64
.nz_48:
    s_branch .cont_49
.cmp_5:
    s_lshr_b32 s64, s32, 1
    s_and_b32 s65, s32, 1
    v_and_b32 v8, 31, v1
    v_lshrrev_b32 v9, 5, v1
    v_and_b32 v10, 15, v1
    v_lshrrev_b32 v11, 4, v1
    v_mov_b32 v12, 0x3f803f80
    v_mov_b32 v13, 0x3f803f80
    v_mov_b32 v14, 0x3f803f80
    v_mov_b32 v15, 0x3f803f80
    s_lshl_b32 s28, s64, 13
    v_bfe_u32 v4, v10, 1, 3
    v_xor_b32 v4, v4, v11
    v_lshlrev_b32_e64 v4, 4, v4
    v_lshl_add_u32 v4, v10, 7, v4
    v_add_u32 v242, s28, v4
    v_xor_b32 v243, 64, v242
    v_lshrrev_b32_e64 v4, 2, v10
    v_lshl_add_u32 v4, v11, 3, v4
    v_lshlrev_b32_e64 v4, 7, v4
    v_bfe_u32 v5, v1, 4, 1
    v_lshl_add_u32 v4, v5, 5, v4
    v_bfe_u32 v5, v1, 3, 1
    v_lshl_add_u32 v4, v5, 6, v4
    v_and_b32_e64 v5, 3, v1
    v_lshl_add_u32 v4, v5, 3, v4
    s_lshl_b32 s28, s65, 6
    v_xor_b32 v4, s28, v4
    v_add_u32 v244, 65536, v4
    v_xor_b32 v245, 32, v244
    v_mov_b32 v254, v242
    v_mov_b32 v255, v244
    s_mov_b32 s66, 0
    s_mov_b32 s67, 0
    v_mov_b64 v[80:81], 0
    v_mov_b64 v[82:83], 0
    v_mov_b64 v[84:85], 0
    v_mov_b64 v[86:87], 0
    v_mov_b64 v[88:89], 0
    v_mov_b64 v[90:91], 0
    v_mov_b64 v[92:93], 0
    v_mov_b64 v[94:95], 0
    v_mov_b64 v[96:97], 0
    v_mov_b64 v[98:99], 0
    v_mov_b64 v[100:101], 0
    v_mov_b64 v[102:103], 0
    v_mov_b64 v[104:105], 0
    v_mov_b64 v[106:107], 0
    v_mov_b64 v[108:109], 0
    v_mov_b64 v[110:111], 0
    v_mov_b64 v[112:113], 0
    v_mov_b64 v[114:115], 0
    v_mov_b64 v[116:117], 0
    v_mov_b64 v[118:119], 0
    v_mov_b64 v[120:121], 0
    v_mov_b64 v[122:123], 0
    v_mov_b64 v[124:125], 0
    v_mov_b64 v[126:127], 0
    v_mov_b64 v[128:129], 0
    v_mov_b64 v[130:131], 0
    v_mov_b64 v[132:133], 0
    v_mov_b64 v[134:135], 0
    v_mov_b64 v[136:137], 0
    v_mov_b64 v[138:139], 0
    v_mov_b64 v[140:141], 0
    v_mov_b64 v[142:143], 0
    s_xor_b32 s29, s33, s34
    s_sub_u32 s28, s33, s36
    s_and_b32 s28, s28, 3
    s_and_b32 s69, s29, 4
    s_add_u32 s28, s28, s69
    s_lshl_b32 s28, s28, 2
    s_lshr_b32 s69, 0x54321110, s28
    s_and_b32 s69, s69, 15
    s_sub_u32 s70, 5, s69
    s_lshl3_add_u32 s28, s33, s32
    s_lshl_b32 s28, s28, 7
    s_add_u32 s28, s28, 65536
    v_lshl_add_u32 v150, v8, 2, s28
    v_lshl_add_u32 v150, v9, 9, v150
    s_lshl2_add_u32 s28, s34, s32
    s_lshl_b32 s28, s28, 7
    s_add_u32 s28, s28, 32768
    v_lshl_add_u32 v151, v8, 2, s28
    v_lshl_add_u32 v151, v9, 20, v151
    v_mov_b64 v[208:209], 0
    v_mov_b64 v[210:211], 0
    v_mov_b64 v[212:213], 0
    v_lshlrev_b32 v4, 2, v11
    v_sub_u32 v4, v10, v4
    v_mov_b32 v5, 0x3f80
    v_mov_b32 v6, 0x3f800000
    v_cmp_eq_u32 vcc, 0, v4
    s_nop 1
    v_cndmask_b32 v210, v210, v5, vcc
    v_cmp_eq_u32 vcc, 1, v4
    s_nop 1
    v_cndmask_b32 v210, v210, v6, vcc
    v_cmp_eq_u32 vcc, 2, v4
    s_nop 1
    v_cndmask_b32 v211, v211, v5, vcc
    v_cmp_eq_u32 vcc, 3, v4
    s_nop 1
    v_cndmask_b32 v211, v211, v6, vcc
    s_lshl_b32 s28, s64, 8
    s_add_u32 s28, s28, 147456
    v_lshl_add_u32 v216, v10, 2, s28
    s_lshl_b32 s28, s64, 8
    s_add_u32 s28, s28, 147456
    v_lshl_add_u32 v217, v8, 2, s28
    s_lshl_b32 s28, s64, 8
    s_add_u32 s28, s28, 147456
    v_lshl_add_u32 v218, v11, 4, s28
    v_lshrrev_b32 v4, 2, v1
    v_and_b32 v5, 3, v1
    v_lshlrev_b32_e64 v5, 3, v5
    v_lshl_add_u32 v4, v4, 6, v5
    s_lshl_b32 s28, s65, 11
    s_add_u32 s28, s28, 155648
    v_lshl_add_u32 v219, v4, 0, s28
    s_lshl_b32 s28, s65, 7
    s_branch .pg_0
.p2align 12
.pad_0:
    s_nop 0
    s_setpc_b64 s[44:45]
.pg_0:
    s_add_u32 s28, s28, 148480
    v_lshl_add_u32 v248, v11, 4, s28
    s_lshl_b32 s28, s65, 7
    s_add_u32 s28, s28, 148736
    v_lshl_add_u32 v249, v10, 2, s28
    s_lshl1_add_u32 s28, s33, s64
    s_lshl_b32 s28, s28, 9
    v_lshl_add_u32 v220, v8, 4, s28
    v_lshl_add_u32 v220, v9, 14, v220
    s_lshl1_add_u32 s31, s34, s65
    s_lshl_b32 s28, s31, 8
    s_add_u32 s28, s28, 57344
    v_and_b32 v4, 0x23, v1
    v_and_b32_e64 v5, 12, v1
    v_lshl_or_b32 v4, v5, 1, v4
    v_bfe_u32 v5, v1, 4, 1
    v_lshl_or_b32 v4, v5, 2, v4
    v_lshl_add_u32 v221, v4, 2, s28
    s_waitcnt lgkmcnt(0)
    s_add_u32 s52, s26, 35651584
    s_addc_u32 s53, s27, 0
    s_mov_b32 s54, 360448
    s_mov_b32 s55, 0x20000
    s_add_u32 s60, s26, 34603008
    s_addc_u32 s61, s27, 0
    s_mov_b32 s62, 86016
    s_mov_b32 s63, 0x20000
    s_lshl_b32 s28, s31, 17
    s_add_u32 s74, s28, 25165824
    s_add_u32 s72, s26, s74
    s_addc_u32 s73, s27, 0
    s_mov_b32 s74, 131072
    s_mov_b32 s75, 0x20000
    s_lshl_b32 s28, s33, 18
    s_add_u32 s76, s4, s28
    s_addc_u32 s77, s5, 0
    s_mov_b32 s78, 262144
    s_mov_b32 s79, 0x20000
    s_cmp_lg_u32 s32, 0
    s_cbranch_scc1 .wn_143
    s_call_b64 s[44:45], .pad_0
    s_call_b64 s[44:45], .pad_8
    s_call_b64 s[44:45], .pad_14
    s_branch .wu_142
.wn_143:
    s_cmp_lg_u32 s32, 1
    s_cbranch_scc1 .wn_144
    s_call_b64 s[44:45], .pad_1
    s_call_b64 s[44:45], .pad_9
    s_call_b64 s[44:45], .pad_15
    s_branch .wu_142
.wn_144:
    s_cmp_lg_u32 s32, 2
    s_cbranch_scc1 .wn_145
    s_call_b64 s[44:45], .pad_2
    s_call_b64 s[44:45], .pad_12
    s_nop 0
    s_branch .wu_142
.wn_145:
    s_call_b64 s[44:45], .pad_3
    s_call_b64 s[44:45], .pad_13
    s_nop 0
.wu_142:
    s_waitcnt lgkmcnt(0)
    s_barrier
    ds_read_b64_tr_b16 v[32:33], v244 offset:0
    ds_read_b64_tr_b16 v[34:35], v244 offset:512
    ds_read_b128 v[16:19], v242 offset:0
    ds_read_b128 v[20:23], v242 offset:2048
    ds_read_b128 v[24:27], v242 offset:4096
    ds_read_b128 v[28:31], v242 offset:6144
    ds_read_b64_tr_b16 v[36:37], v245 offset:0
    ds_read_b64_tr_b16 v[38:39], v245 offset:512
    ds_read_b64_tr_b16 v[40:41], v244 offset:8192
    ds_read_b64_tr_b16 v[42:43], v244 offset:8704
    ds_read_b64_tr_b16 v[44:45], v245 offset:8192
    ds_read_b64_tr_b16 v[46:47], v245 offset:8704
    s_add_u32 s66, s66, 16384
    s_and_b32 s66, s66, 0xffff
    s_add_u32 s67, s67, 16384
    s_cmp_eq_u32 s67, 81920
    s_cselect_b32 s67, 0, s67
    s_mov_b32 s68, s69
    s_cmp_eq_u32 s68, 0
    s_cbranch_scc1 .cd_148
.p2align 6
.cl_147:
    s_waitcnt lgkmcnt(6)
    v_mfma_f32_16x16x32_bf16 v[80:83], v[32:35], v[16:19], v[80:83]
    ds_read_b64_tr_b16 v[64:65], v244 offset:4096
    v_mfma_f32_16x16x32_bf16 v[96:99], v[32:35], v[20:23], v[96:99]
    ds_read_b64_tr_b16 v[66:67], v244 offset:4608
    v_mfma_f32_16x16x32_bf16 v[112:115], v[32:35], v[24:27], v[112:115]
    ds_read_b128 v[48:51], v243 offset:0
    v_mfma_f32_16x16x32_bf16 v[128:131], v[32:35], v[28:31], v[128:131]
    ds_read_b128 v[52:55], v243 offset:2048
    s_waitcnt lgkmcnt(4)
    v_mfma_f32_16x16x32_bf16 v[132:135], v[36:39], v[28:31], v[132:135]
    ds_read_b128 v[56:59], v243 offset:4096
    v_mfma_f32_16x16x32_bf16 v[116:119], v[36:39], v[24:27], v[116:119]
    ds_read_b128 v[60:63], v243 offset:6144
    v_mfma_f32_16x16x32_bf16 v[100:103], v[36:39], v[20:23], v[100:103]
    ds_read_b64_tr_b16 v[68:69], v245 offset:4096
    v_mfma_f32_16x16x32_bf16 v[84:87], v[36:39], v[16:19], v[84:87]
    ds_read_b64_tr_b16 v[70:71], v245 offset:4608
    v_mfma_f32_16x16x32_bf16 v[88:91], v[16:19], v[40:43], v[88:91]
    ds_read_b64_tr_b16 v[72:73], v244 offset:12288
    v_mfma_f32_16x16x32_bf16 v[104:107], v[20:23], v[40:43], v[104:107]
    ds_read_b64_tr_b16 v[74:75], v244 offset:12800
    v_mfma_f32_16x16x32_bf16 v[120:123], v[24:27], v[40:43], v[120:123]
    ds_read_b64_tr_b16 v[76:77], v245 offset:12288
    v_mfma_f32_16x16x32_bf16 v[136:139], v[28:31], v[40:43], v[136:139]
    ds_read_b64_tr_b16 v[78:79], v245 offset:12800
    v_mfma_f32_16x16x32_bf16 v[140:143], v[28:31], v[44:47], v[140:143]
    v_add_u32_e64 v242, s66, v254
    v_mfma_f32_16x16x32_bf16 v[124:127], v[24:27], v[44:47], v[124:127]
    v_xor_b32_e64 v243, 64, v242
    v_mfma_f32_16x16x32_bf16 v[108:111], v[20:23], v[44:47], v[108:111]
    v_add_u32_e64 v244, s67, v255
    v_mfma_f32_16x16x32_bf16 v[92:95], v[16:19], v[44:47], v[92:95]
    v_xor_b32 v245, 32, v244
    s_waitcnt lgkmcnt(0)
    v_mfma_f32_16x16x32_bf16 v[80:83], v[64:67], v[48:51], v[80:83]
    s_barrier
    v_mfma_f32_16x16x32_bf16 v[96:99], v[64:67], v[52:55], v[96:99]
    ds_read_b64_tr_b16 v[32:33], v244 offset:0
    v_mfma_f32_16x16x32_bf16 v[112:115], v[64:67], v[56:59], v[112:115]
    ds_read_b64_tr_b16 v[34:35], v244 offset:512
    v_mfma_f32_16x16x32_bf16 v[128:131], v[64:67], v[60:63], v[128:131]
    ds_read_b128 v[16:19], v242 offset:0
    v_mfma_f32_16x16x32_bf16 v[132:135], v[68:71], v[60:63], v[132:135]
    ds_read_b128 v[20:23], v242 offset:2048
    v_mfma_f32_16x16x32_bf16 v[116:119], v[68:71], v[56:59], v[116:119]
    ds_read_b128 v[24:27], v242 offset:4096
    s_add_u32 s66, s66, 16384
    v_mfma_f32_16x16x32_bf16 v[100:103], v[68:71], v[52:55], v[100:103]
    ds_read_b128 v[28:31], v242 offset:6144
    s_and_b32 s66, s66, 0xffff
    v_mfma_f32_16x16x32_bf16 v[84:87], v[68:71], v[48:51], v[84:87]
    ds_read_b64_tr_b16 v[36:37], v245 offset:0
    s_add_u32 s67, s67, 16384
    v_mfma_f32_16x16x32_bf16 v[88:91], v[48:51], v[72:75], v[88:91]
    ds_read_b64_tr_b16 v[38:39], v245 offset:512
    s_cmp_eq_u32 s67, 81920
    v_mfma_f32_16x16x32_bf16 v[104:107], v[52:55], v[72:75], v[104:107]
    ds_read_b64_tr_b16 v[40:41], v244 offset:8192
    s_cselect_b32 s67, 0, s67
    v_mfma_f32_16x16x32_bf16 v[120:123], v[56:59], v[72:75], v[120:123]
    ds_read_b64_tr_b16 v[42:43], v244 offset:8704
    v_mfma_f32_16x16x32_bf16 v[136:139], v[60:63], v[72:75], v[136:139]
    ds_read_b64_tr_b16 v[44:45], v245 offset:8192
    v_mfma_f32_16x16x32_bf16 v[140:143], v[60:63], v[76:79], v[140:143]
    ds_read_b64_tr_b16 v[46:47], v245 offset:8704
    v_mfma_f32_16x16x32_bf16 v[124:127], v[56:59], v[76:79], v[124:127]
    s_sub_u32 s68, s68, 1
    v_mfma_f32_16x16x32_bf16 v[108:111], v[52:55], v[76:79], v[108:111]
    s_cmp_lg_u32 s68, 0
    v_mfma_f32_16x16x32_bf16 v[92:95], v[48:51], v[76:79], v[92:95]
    s_cbranch_scc1 .cl_147
.cd_148:
    s_waitcnt lgkmcnt(6)
    v_mfma_f32_16x16x32_bf16 v[80:83], v[32:35], v[16:19], v[80:83]
    ds_read_b64_tr_b16 v[64:65], v244 offset:4096
    v_mfma_f32_16x16x32_bf16 v[96:99], v[32:35], v[20:23], v[96:99]
    ds_read_b64_tr_b16 v[66:67], v244 offset:4608
    v_mfma_f32_16x16x32_bf16 v[112:115], v[32:35], v[24:27], v[112:115]
    ds_read_b128 v[48:51], v243 offset:0
    v_mfma_f32_16x16x32_bf16 v[128:131], v[32:35], v[28:31], v[128:131]
    ds_read_b128 v[52:55], v243 offset:2048
    s_waitcnt lgkmcnt(4)
    v_mfma_f32_16x16x32_bf16 v[132:135], v[36:39], v[28:31], v[132:135]
    ds_read_b128 v[56:59], v243 offset:4096
    v_mfma_f32_16x16x32_bf16 v[116:119], v[36:39], v[24:27], v[116:119]
    ds_read_b128 v[60:63], v243 offset:6144
    v_mfma_f32_16x16x32_bf16 v[100:103], v[36:39], v[20:23], v[100:103]
    ds_read_b64_tr_b16 v[68:69], v245 offset:4096
    v_mfma_f32_16x16x32_bf16 v[84:87], v[36:39], v[16:19], v[84:87]
    ds_read_b64_tr_b16 v[70:71], v245 offset:4608
    v_mfma_f32_16x16x32_bf16 v[88:91], v[16:19], v[40:43], v[88:91]
    ds_read_b64_tr_b16 v[72:73], v244 offset:12288
    v_mfma_f32_16x16x32_bf16 v[104:107], v[20:23], v[40:43], v[104:107]
    ds_read_b64_tr_b16 v[74:75], v244 offset:12800
    v_mfma_f32_16x16x32_bf16 v[120:123], v[24:27], v[40:43], v[120:123]
    ds_read_b64_tr_b16 v[76:77], v245 offset:12288
    v_mfma_f32_16x16x32_bf16 v[136:139], v[28:31], v[40:43], v[136:139]
    ds_read_b64_tr_b16 v[78:79], v245 offset:12800
    v_mfma_f32_16x16x32_bf16 v[140:143], v[28:31], v[44:47], v[140:143]
    v_add_u32 v242, s66, v254
    v_mfma_f32_16x16x32_bf16 v[124:127], v[24:27], v[44:47], v[124:127]
    v_xor_b32_e64 v243, 64, v242
    v_mfma_f32_16x16x32_bf16 v[108:111], v[20:23], v[44:47], v[108:111]
    v_add_u32_e64 v244, s67, v255
    v_mfma_f32_16x16x32_bf16 v[92:95], v[16:19], v[44:47], v[92:95]
    v_xor_b32 v245, 32, v244
    s_cmp_lg_u32 s65, 0
    s_nop 0
    s_cbranch_scc1 .d1_149
    v_dot2_f32_bf16 v144, v16, v12, 0
    v_dot2_f32_bf16 v145, v16, v16, 0
    v_dot2_f32_bf16 v146, v20, v12, 0
    v_dot2_f32_bf16 v147, v20, v20, 0
    v_dot2_f32_bf16 v144, v17, v12, v144
    v_dot2_f32_bf16 v145, v17, v17, v145
    v_dot2_f32_bf16 v146, v21, v12, v146
    v_dot2_f32_bf16 v147, v21, v21, v147
    v_dot2_f32_bf16 v144, v18, v12, v144
    v_dot2_f32_bf16 v145, v18, v18, v145
    v_dot2_f32_bf16 v146, v22, v12, v146
    v_dot2_f32_bf16 v147, v22, v22, v147
    v_dot2_f32_bf16 v144, v19, v12, v144
    v_dot2_f32_bf16 v145, v19, v19, v145
    v_dot2_f32_bf16 v146, v23, v12, v146
    v_dot2_f32_bf16 v147, v23, v23, v147
    s_branch .d2_150
    s_nop 0
.d1_149:
    v_dot2_f32_bf16 v144, v24, v12, 0
    v_dot2_f32_bf16 v145, v24, v24, 0
    v_dot2_f32_bf16 v146, v28, v12, 0
    v_dot2_f32_bf16 v147, v28, v28, 0
    v_dot2_f32_bf16 v144, v25, v12, v144
    v_dot2_f32_bf16 v145, v25, v25, v145
    v_dot2_f32_bf16 v146, v29, v12, v146
    v_dot2_f32_bf16 v147, v29, v29, v147
    v_dot2_f32_bf16 v144, v26, v12, v144
    v_dot2_f32_bf16 v145, v26, v26, v145
    v_dot2_f32_bf16 v146, v30, v12, v146
    v_dot2_f32_bf16 v147, v30, v30, v147
    v_dot2_f32_bf16 v144, v27, v12, v144
    v_dot2_f32_bf16 v145, v27, v27, v145
    v_dot2_f32_bf16 v146, v31, v12, v146
    v_dot2_f32_bf16 v147, v31, v31, v147
.d2_150:
    s_cmp_lg_u32 s64, 0
    s_cbranch_scc1 .d1_151
    v_dot2_f32_bf16 v148, v32, v12, 0
    v_dot2_f32_bf16 v149, v36, v12, 0
    v_dot2_f32_bf16 v148, v33, v12, v148
    v_dot2_f32_bf16 v149, v37, v12, v149
    v_dot2_f32_bf16 v148, v34, v12, v148
    v_dot2_f32_bf16 v149, v38, v12, v149
    v_dot2_f32_bf16 v148, v35, v12, v148
    v_dot2_f32_bf16 v149, v39, v12, v149
    s_branch .d2_152
    s_nop 0
.d1_151:
    v_dot2_f32_bf16 v148, v40, v12, 0
    v_dot2_f32_bf16 v149, v44, v12, 0
    v_dot2_f32_bf16 v148, v41, v12, v148
    v_dot2_f32_bf16 v149, v45, v12, v149
    v_dot2_f32_bf16 v148, v42, v12, v148
    v_dot2_f32_bf16 v149, v46, v12, v149
    v_dot2_f32_bf16 v148, v43, v12, v148
    v_dot2_f32_bf16 v149, v47, v12, v149
.d2_152:
    s_waitcnt lgkmcnt(0)
    v_mfma_f32_16x16x32_bf16 v[80:83], v[64:67], v[48:51], v[80:83]
    s_barrier
    v_mfma_f32_16x16x32_bf16 v[96:99], v[64:67], v[52:55], v[96:99]
    ds_read_b64_tr_b16 v[32:33], v244 offset:0
    v_mfma_f32_16x16x32_bf16 v[112:115], v[64:67], v[56:59], v[112:115]
    ds_read_b64_tr_b16 v[34:35], v244 offset:512
    v_mfma_f32_16x16x32_bf16 v[128:131], v[64:67], v[60:63], v[128:131]
    ds_read_b128 v[16:19], v242 offset:0
    v_mfma_f32_16x16x32_bf16 v[132:135], v[68:71], v[60:63], v[132:135]
    ds_read_b128 v[20:23], v242 offset:2048
    v_mfma_f32_16x16x32_bf16 v[116:119], v[68:71], v[56:59], v[116:119]
    ds_read_b128 v[24:27], v242 offset:4096
    s_add_u32 s66, s66, 16384
    v_mfma_f32_16x16x32_bf16 v[100:103], v[68:71], v[52:55], v[100:103]
    ds_read_b128 v[28:31], v242 offset:6144
    s_and_b32 s66, s66, 0xffff
    v_mfma_f32_16x16x32_bf16 v[84:87], v[68:71], v[48:51], v[84:87]
    ds_read_b64_tr_b16 v[36:37], v245 offset:0
    s_add_u32 s67, s67, 16384
    v_mfma_f32_16x16x32_bf16 v[88:91], v[48:51], v[72:75], v[88:91]
    ds_read_b64_tr_b16 v[38:39], v245 offset:512
    s_cmp_eq_u32 s67, 81920
    v_mfma_f32_16x16x32_bf16 v[104:107], v[52:55], v[72:75], v[104:107]
    ds_read_b64_tr_b16 v[40:41], v244 offset:8192
    s_cselect_b32 s67, 0, s67
    v_mfma_f32_16x16x32_bf16 v[120:123], v[56:59], v[72:75], v[120:123]
    ds_read_b64_tr_b16 v[42:43], v244 offset:8704
    v_mfma_f32_16x16x32_bf16 v[136:139], v[60:63], v[72:75], v[136:139]
    ds_read_b64_tr_b16 v[44:45], v245 offset:8192
    v_mfma_f32_16x16x32_bf16 v[140:143], v[60:63], v[76:79], v[140:143]
    ds_read_b64_tr_b16 v[46:47], v245 offset:8704
    v_mfma_f32_16x16x32_bf16 v[124:127], v[56:59], v[76:79], v[124:127]
    v_mfma_f32_16x16x32_bf16 v[108:111], v[52:55], v[76:79], v[108:111]
    v_mfma_f32_16x16x32_bf16 v[92:95], v[48:51], v[76:79], v[92:95]
    s_cmp_lg_u32 s65, 0
    s_nop 0
    s_cbranch_scc1 .d1_153
    v_dot2_f32_bf16 v144, v48, v12, v144
    v_dot2_f32_bf16 v145, v48, v48, v145
    v_dot2_f32_bf16 v146, v52, v12, v146
    v_dot2_f32_bf16 v147, v52, v52, v147
    v_dot2_f32_bf16 v144, v49, v12, v144
    v_dot2_f32_bf16 v145, v49, v49, v145
    v_dot2_f32_bf16 v146, v53, v12, v146
    v_dot2_f32_bf16 v147, v53, v53, v147
    v_dot2_f32_bf16 v144, v50, v12, v144
    v_dot2_f32_bf16 v145, v50, v50, v145
    v_dot2_f32_bf16 v146, v54, v12, v146
    v_dot2_f32_bf16 v147, v54, v54, v147
    v_dot2_f32_bf16 v144, v51, v12, v144
    v_dot2_f32_bf16 v145, v51, v51, v145
    v_dot2_f32_bf16 v146, v55, v12, v146
    v_dot2_f32_bf16 v147, v55, v55, v147
    s_branch .d2_154
    s_nop 0
.d1_153:
    v_dot2_f32_bf16 v144, v56, v12, v144
    v_dot2_f32_bf16 v145, v56, v56, v145
    v_dot2_f32_bf16 v146, v60, v12, v146
    v_dot2_f32_bf16 v147, v60, v60, v147
    v_dot2_f32_bf16 v144, v57, v12, v144
    v_dot2_f32_bf16 v145, v57, v57, v145
    v_dot2_f32_bf16 v146, v61, v12, v146
    v_dot2_f32_bf16 v147, v61, v61, v147
    v_dot2_f32_bf16 v144, v58, v12, v144
    v_dot2_f32_bf16 v145, v58, v58, v145
    v_dot2_f32_bf16 v146, v62, v12, v146
    v_dot2_f32_bf16 v147, v62, v62, v147
    v_dot2_f32_bf16 v144, v59, v12, v144
    v_dot2_f32_bf16 v145, v59, v59, v145
    v_dot2_f32_bf16 v146, v63, v12, v146
    v_dot2_f32_bf16 v147, v63, v63, v147
.d2_154:
    s_cmp_lg_u32 s64, 0
    s_cbranch_scc1 .d1_155
    v_dot2_f32_bf16 v148, v64, v12, v148
    v_dot2_f32_bf16 v149, v68, v12, v149
    v_dot2_f32_bf16 v148, v65, v12, v148
    v_dot2_f32_bf16 v149, v69, v12, v149
    v_dot2_f32_bf16 v148, v66, v12, v148
    v_dot2_f32_bf16 v149, v70, v12, v149
    v_dot2_f32_bf16 v148, v67, v12, v148
    v_dot2_f32_bf16 v149, v71, v12, v149
    s_branch .d2_156
    s_nop 0
.d1_155:
    v_dot2_f32_bf16 v148, v72, v12, v148
    v_dot2_f32_bf16 v149, v76, v12, v149
    v_dot2_f32_bf16 v148, v73, v12, v148
    v_dot2_f32_bf16 v149, v77, v12, v149
    v_dot2_f32_bf16 v148, v74, v12, v148
    v_dot2_f32_bf16 v149, v78, v12, v149
    v_dot2_f32_bf16 v148, v75, v12, v148
    v_dot2_f32_bf16 v149, v79, v12, v149
.d2_156:
    s_mov_b32 s68, s70
    s_cmp_eq_u32 s68, 0
    s_cbranch_scc1 .cd_158
.p2align 6
.cl_157:
    s_waitcnt lgkmcnt(6)
    v_mfma_f32_16x16x32_bf16 v[80:83], v[32:35], v[16:19], v[80:83]
    ds_read_b64_tr_b16 v[64:65], v244 offset:4096
    v_mfma_f32_16x16x32_bf16 v[96:99], v[32:35], v[20:23], v[96:99]
    ds_read_b64_tr_b16 v[66:67], v244 offset:4608
    v_mfma_f32_16x16x32_bf16 v[112:115], v[32:35], v[24:27], v[112:115]
    ds_read_b128 v[48:51], v243 offset:0
    v_mfma_f32_16x16x32_bf16 v[128:131], v[32:35], v[28:31], v[128:131]
    ds_read_b128 v[52:55], v243 offset:2048
    s_waitcnt lgkmcnt(4)
    v_mfma_f32_16x16x32_bf16 v[132:135], v[36:39], v[28:31], v[132:135]
    ds_read_b128 v[56:59], v243 offset:4096
    v_mfma_f32_16x16x32_bf16 v[116:119], v[36:39], v[24:27], v[116:119]
    ds_read_b128 v[60:63], v243 offset:6144
    v_mfma_f32_16x16x32_bf16 v[100:103], v[36:39], v[20:23], v[100:103]
    ds_read_b64_tr_b16 v[68:69], v245 offset:4096
    v_mfma_f32_16x16x32_bf16 v[84:87], v[36:39], v[16:19], v[84:87]
    ds_read_b64_tr_b16 v[70:71], v245 offset:4608
    v_mfma_f32_16x16x32_bf16 v[88:91], v[16:19], v[40:43], v[88:91]
    ds_read_b64_tr_b16 v[72:73], v244 offset:12288
    v_mfma_f32_16x16x32_bf16 v[104:107], v[20:23], v[40:43], v[104:107]
    ds_read_b64_tr_b16 v[74:75], v244 offset:12800
    v_mfma_f32_16x16x32_bf16 v[120:123], v[24:27], v[40:43], v[120:123]
    ds_read_b64_tr_b16 v[76:77], v245 offset:12288
    v_mfma_f32_16x16x32_bf16 v[136:139], v[28:31], v[40:43], v[136:139]
    ds_read_b64_tr_b16 v[78:79], v245 offset:12800
    v_mfma_f32_16x16x32_bf16 v[140:143], v[28:31], v[44:47], v[140:143]
    v_add_u32_e64 v242, s66, v254
    v_mfma_f32_16x16x32_bf16 v[124:127], v[24:27], v[44:47], v[124:127]
    v_xor_b32_e64 v243, 64, v242
    v_mfma_f32_16x16x32_bf16 v[108:111], v[20:23], v[44:47], v[108:111]
    v_add_u32_e64 v244, s67, v255
    v_mfma_f32_16x16x32_bf16 v[92:95], v[16:19], v[44:47], v[92:95]
    v_xor_b32 v245, 32, v244
    s_waitcnt lgkmcnt(0)
    v_mfma_f32_16x16x32_bf16 v[80:83], v[64:67], v[48:51], v[80:83]
    s_barrier
    v_mfma_f32_16x16x32_bf16 v[96:99], v[64:67], v[52:55], v[96:99]
    ds_read_b64_tr_b16 v[32:33], v244 offset:0
    v_mfma_f32_16x16x32_bf16 v[112:115], v[64:67], v[56:59], v[112:115]
    ds_read_b64_tr_b16 v[34:35], v244 offset:512
    v_mfma_f32_16x16x32_bf16 v[128:131], v[64:67], v[60:63], v[128:131]
    ds_read_b128 v[16:19], v242 offset:0
    v_mfma_f32_16x16x32_bf16 v[132:135], v[68:71], v[60:63], v[132:135]
    ds_read_b128 v[20:23], v242 offset:2048
    v_mfma_f32_16x16x32_bf16 v[116:119], v[68:71], v[56:59], v[116:119]
    ds_read_b128 v[24:27], v242 offset:4096
    s_add_u32 s66, s66, 16384
    v_mfma_f32_16x16x32_bf16 v[100:103], v[68:71], v[52:55], v[100:103]
    ds_read_b128 v[28:31], v242 offset:6144
    s_and_b32 s66, s66, 0xffff
    v_mfma_f32_16x16x32_bf16 v[84:87], v[68:71], v[48:51], v[84:87]
    ds_read_b64_tr_b16 v[36:37], v245 offset:0
    s_add_u32 s67, s67, 16384
    v_mfma_f32_16x16x32_bf16 v[88:91], v[48:51], v[72:75], v[88:91]
    ds_read_b64_tr_b16 v[38:39], v245 offset:512
    s_cmp_eq_u32 s67, 81920
    v_mfma_f32_16x16x32_bf16 v[104:107], v[52:55], v[72:75], v[104:107]
    ds_read_b64_tr_b16 v[40:41], v244 offset:8192
    s_cselect_b32 s67, 0, s67
    v_mfma_f32_16x16x32_bf16 v[120:123], v[56:59], v[72:75], v[120:123]
    ds_read_b64_tr_b16 v[42:43], v244 offset:8704
    v_mfma_f32_16x16x32_bf16 v[136:139], v[60:63], v[72:75], v[136:139]
    ds_read_b64_tr_b16 v[44:45], v245 offset:8192
    v_mfma_f32_16x16x32_bf16 v[140:143], v[60:63], v[76:79], v[140:143]
    ds_read_b64_tr_b16 v[46:47], v245 offset:8704
    v_mfma_f32_16x16x32_bf16 v[124:127], v[56:59], v[76:79], v[124:127]
    s_sub_u32 s68, s68, 1
    v_mfma_f32_16x16x32_bf16 v[108:111], v[52:55], v[76:79], v[108:111]
    s_cmp_lg_u32 s68, 0
    v_mfma_f32_16x16x32_bf16 v[92:95], v[48:51], v[76:79], v[92:95]
    s_cbranch_scc1 .cl_157
.cd_158:
    v_permlane32_swap_b32 v144, v145
    v_permlane32_swap_b32 v146, v147
    v_permlane16_swap_b32 v148, v149
    v_add_f32 v144, v144, v145
    v_add_f32 v146, v146, v147
    v_add_f32 v148, v148, v149
    v_mov_b32 v149, v148
    v_permlane16_swap_b32 v144, v146
    s_nop 0
    v_permlane32_swap_b32 v148, v149
    v_add_f32 v144, v144, v146
    v_add_f32_e64 v148, v148, v149
    buffer_atomic_add_f32 v144, v150, s[60:63], 0 offen sc1
    buffer_atomic_add_f32 v148, v151, s[60:63], 0 offen sc1
    s_waitcnt lgkmcnt(6)
    v_mfma_f32_16x16x32_bf16 v[80:83], v[32:35], v[16:19], v[80:83]
    ds_read_b64_tr_b16 v[64:65], v244 offset:4096
    v_mfma_f32_16x16x32_bf16 v[96:99], v[32:35], v[20:23], v[96:99]
    ds_read_b64_tr_b16 v[66:67], v244 offset:4608
    v_mfma_f32_16x16x32_bf16 v[112:115], v[32:35], v[24:27], v[112:115]
    ds_read_b128 v[48:51], v243 offset:0
    v_mfma_f32_16x16x32_bf16 v[128:131], v[32:35], v[28:31], v[128:131]
    ds_read_b128 v[52:55], v243 offset:2048
    s_waitcnt lgkmcnt(4)
    v_mfma_f32_16x16x32_bf16 v[132:135], v[36:39], v[28:31], v[132:135]
    ds_read_b128 v[56:59], v243 offset:4096
    v_mfma_f32_16x16x32_bf16 v[116:119], v[36:39], v[24:27], v[116:119]
    ds_read_b128 v[60:63], v243 offset:6144
    v_mfma_f32_16x16x32_bf16 v[100:103], v[36:39], v[20:23], v[100:103]
    ds_read_b64_tr_b16 v[68:69], v245 offset:4096
    v_mfma_f32_16x16x32_bf16 v[84:87], v[36:39], v[16:19], v[84:87]
    ds_read_b64_tr_b16 v[70:71], v245 offset:4608
    v_mfma_f32_16x16x32_bf16 v[88:91], v[16:19], v[40:43], v[88:91]
    ds_read_b64_tr_b16 v[72:73], v244 offset:12288
    v_mfma_f32_16x16x32_bf16 v[104:107], v[20:23], v[40:43], v[104:107]
    ds_read_b64_tr_b16 v[74:75], v244 offset:12800
    v_mfma_f32_16x16x32_bf16 v[120:123], v[24:27], v[40:43], v[120:123]
    ds_read_b64_tr_b16 v[76:77], v245 offset:12288
    v_mfma_f32_16x16x32_bf16 v[136:139], v[28:31], v[40:43], v[136:139]
    ds_read_b64_tr_b16 v[78:79], v245 offset:12800
    v_mfma_f32_16x16x32_bf16 v[140:143], v[28:31], v[44:47], v[140:143]
    v_add_u32_e64 v242, s66, v254
    v_mfma_f32_16x16x32_bf16 v[124:127], v[24:27], v[44:47], v[124:127]
    v_xor_b32_e64 v243, 64, v242
    v_mfma_f32_16x16x32_bf16 v[108:111], v[20:23], v[44:47], v[108:111]
    v_add_u32_e64 v244, s67, v255
    v_mfma_f32_16x16x32_bf16 v[92:95], v[16:19], v[44:47], v[92:95]
    v_xor_b32 v245, 32, v244
    s_waitcnt lgkmcnt(0)
    v_mfma_f32_16x16x32_bf16 v[80:83], v[64:67], v[48:51], v[80:83]
    s_barrier
    v_mfma_f32_16x16x32_bf16 v[96:99], v[64:67], v[52:55], v[96:99]
    ds_read_b64_tr_b16 v[32:33], v244 offset:0
    v_mfma_f32_16x16x32_bf16 v[112:115], v[64:67], v[56:59], v[112:115]
    ds_read_b64_tr_b16 v[34:35], v244 offset:512
    v_mfma_f32_16x16x32_bf16 v[128:131], v[64:67], v[60:63], v[128:131]
    ds_read_b128 v[16:19], v242 offset:0
    v_mfma_f32_16x16x32_bf16 v[132:135], v[68:71], v[60:63], v[132:135]
    ds_read_b128 v[20:23], v242 offset:2048
    v_mfma_f32_16x16x32_bf16 v[116:119], v[68:71], v[56:59], v[116:119]
    ds_read_b128 v[24:27], v242 offset:4096
    s_add_u32 s66, s66, 16384
    v_mfma_f32_16x16x32_bf16 v[100:103], v[68:71], v[52:55], v[100:103]
    ds_read_b128 v[28:31], v242 offset:6144
    s_and_b32 s66, s66, 0xffff
    v_mfma_f32_16x16x32_bf16 v[84:87], v[68:71], v[48:51], v[84:87]
    ds_read_b64_tr_b16 v[36:37], v245 offset:0
    s_add_u32 s67, s67, 16384
    v_mfma_f32_16x16x32_bf16 v[88:91], v[48:51], v[72:75], v[88:91]
    ds_read_b64_tr_b16 v[38:39], v245 offset:512
    s_cmp_eq_u32 s67, 81920
    v_mfma_f32_16x16x32_bf16 v[104:107], v[52:55], v[72:75], v[104:107]
    ds_read_b64_tr_b16 v[40:41], v244 offset:8192
    s_cselect_b32 s67, 0, s67
    v_mfma_f32_16x16x32_bf16 v[120:123], v[56:59], v[72:75], v[120:123]
    ds_read_b64_tr_b16 v[42:43], v244 offset:8704
    v_mfma_f32_16x16x32_bf16 v[136:139], v[60:63], v[72:75], v[136:139]
    ds_read_b64_tr_b16 v[44:45], v245 offset:8192
    v_mfma_f32_16x16x32_bf16 v[140:143], v[60:63], v[76:79], v[140:143]
    ds_read_b64_tr_b16 v[46:47], v245 offset:8704
    v_mfma_f32_16x16x32_bf16 v[124:127], v[56:59], v[76:79], v[124:127]
    v_mfma_f32_16x16x32_bf16 v[108:111], v[52:55], v[76:79], v[108:111]
    v_mfma_f32_16x16x32_bf16 v[92:95], v[48:51], v[76:79], v[92:95]
    s_mov_b32 s68, 8
    s_branch .pg_1
.p2align 12
.pad_1:
    s_nop 0
    s_setpc_b64 s[44:45]
.pg_1:
.p2align 6
.cl_159:
    s_waitcnt lgkmcnt(6)
    v_mfma_f32_16x16x32_bf16 v[80:83], v[32:35], v[16:19], v[80:83]
    ds_read_b64_tr_b16 v[64:65], v244 offset:4096
    v_mfma_f32_16x16x32_bf16 v[96:99], v[32:35], v[20:23], v[96:99]
    ds_read_b64_tr_b16 v[66:67], v244 offset:4608
    v_mfma_f32_16x16x32_bf16 v[112:115], v[32:35], v[24:27], v[112:115]
    ds_read_b128 v[48:51], v243 offset:0
    v_mfma_f32_16x16x32_bf16 v[128:131], v[32:35], v[28:31], v[128:131]
    ds_read_b128 v[52:55], v243 offset:2048
    s_waitcnt lgkmcnt(4)
    v_mfma_f32_16x16x32_bf16 v[132:135], v[36:39], v[28:31], v[132:135]
    ds_read_b128 v[56:59], v243 offset:4096
    v_mfma_f32_16x16x32_bf16 v[116:119], v[36:39], v[24:27], v[116:119]
    ds_read_b128 v[60:63], v243 offset:6144
    v_mfma_f32_16x16x32_bf16 v[100:103], v[36:39], v[20:23], v[100:103]
    ds_read_b64_tr_b16 v[68:69], v245 offset:4096
    v_mfma_f32_16x16x32_bf16 v[84:87], v[36:39], v[16:19], v[84:87]
    ds_read_b64_tr_b16 v[70:71], v245 offset:4608
    v_mfma_f32_16x16x32_bf16 v[88:91], v[16:19], v[40:43], v[88:91]
    ds_read_b64_tr_b16 v[72:73], v244 offset:12288
    v_mfma_f32_16x16x32_bf16 v[104:107], v[20:23], v[40:43], v[104:107]
    ds_read_b64_tr_b16 v[74:75], v244 offset:12800
    v_mfma_f32_16x16x32_bf16 v[120:123], v[24:27], v[40:43], v[120:123]
    ds_read_b64_tr_b16 v[76:77], v245 offset:12288
    v_mfma_f32_16x16x32_bf16 v[136:139], v[28:31], v[40:43], v[136:139]
    ds_read_b64_tr_b16 v[78:79], v245 offset:12800
    v_mfma_f32_16x16x32_bf16 v[140:143], v[28:31], v[44:47], v[140:143]
    v_add_u32_e64 v242, s66, v254
    v_mfma_f32_16x16x32_bf16 v[124:127], v[24:27], v[44:47], v[124:127]
    v_xor_b32_e64 v243, 64, v242
    v_mfma_f32_16x16x32_bf16 v[108:111], v[20:23], v[44:47], v[108:111]
    v_add_u32_e64 v244, s67, v255
    v_mfma_f32_16x16x32_bf16 v[92:95], v[16:19], v[44:47], v[92:95]
    v_xor_b32 v245, 32, v244
    s_waitcnt lgkmcnt(0)
    v_mfma_f32_16x16x32_bf16 v[80:83], v[64:67], v[48:51], v[80:83]
    s_waitcnt vmcnt(0)
    s_barrier
    v_mfma_f32_16x16x32_bf16 v[96:99], v[64:67], v[52:55], v[96:99]
    ds_read_b64_tr_b16 v[32:33], v244 offset:0
    v_mfma_f32_16x16x32_bf16 v[112:115], v[64:67], v[56:59], v[112:115]
    ds_read_b64_tr_b16 v[34:35], v244 offset:512
    v_mfma_f32_16x16x32_bf16 v[128:131], v[64:67], v[60:63], v[128:131]
    ds_read_b128 v[16:19], v242 offset:0
    v_mfma_f32_16x16x32_bf16 v[132:135], v[68:71], v[60:63], v[132:135]
    ds_read_b128 v[20:23], v242 offset:2048
    v_mfma_f32_16x16x32_bf16 v[116:119], v[68:71], v[56:59], v[116:119]
    ds_read_b128 v[24:27], v242 offset:4096
    s_add_u32 s66, s66, 16384
    v_mfma_f32_16x16x32_bf16 v[100:103], v[68:71], v[52:55], v[100:103]
    ds_read_b128 v[28:31], v242 offset:6144
    s_and_b32 s66, s66, 0xffff
    v_mfma_f32_16x16x32_bf16 v[84:87], v[68:71], v[48:51], v[84:87]
    ds_read_b64_tr_b16 v[36:37], v245 offset:0
    s_add_u32 s67, s67, 16384
    v_mfma_f32_16x16x32_bf16 v[88:91], v[48:51], v[72:75], v[88:91]
    ds_read_b64_tr_b16 v[38:39], v245 offset:512
    s_cmp_eq_u32 s67, 81920
    v_mfma_f32_16x16x32_bf16 v[104:107], v[52:55], v[72:75], v[104:107]
    ds_read_b64_tr_b16 v[40:41], v244 offset:8192
    s_cselect_b32 s67, 0, s67
    v_mfma_f32_16x16x32_bf16 v[120:123], v[56:59], v[72:75], v[120:123]
    ds_read_b64_tr_b16 v[42:43], v244 offset:8704
    v_mfma_f32_16x16x32_bf16 v[136:139], v[60:63], v[72:75], v[136:139]
    ds_read_b64_tr_b16 v[44:45], v245 offset:8192
    v_mfma_f32_16x16x32_bf16 v[140:143], v[60:63], v[76:79], v[140:143]
    ds_read_b64_tr_b16 v[46:47], v245 offset:8704
    v_mfma_f32_16x16x32_bf16 v[124:127], v[56:59], v[76:79], v[124:127]
    s_sub_u32 s68, s68, 1
    v_mfma_f32_16x16x32_bf16 v[108:111], v[52:55], v[76:79], v[108:111]
    s_cmp_lg_u32 s68, 0
    v_mfma_f32_16x16x32_bf16 v[92:95], v[48:51], v[76:79], v[92:95]
    s_cbranch_scc1 .cl_159
.code_ck:
    s_waitcnt lgkmcnt(6)
    v_mfma_f32_16x16x32_bf16 v[80:83], v[32:35], v[16:19], v[80:83]
    ds_read_b64_tr_b16 v[64:65], v244 offset:4096
    v_mfma_f32_16x16x32_bf16 v[96:99], v[32:35], v[20:23], v[96:99]
    ds_read_b64_tr_b16 v[66:67], v244 offset:4608
    v_mfma_f32_16x16x32_bf16 v[112:115], v[32:35], v[24:27], v[112:115]
    ds_read_b128 v[48:51], v243 offset:0
    v_mfma_f32_16x16x32_bf16 v[128:131], v[32:35], v[28:31], v[128:131]
    ds_read_b128 v[52:55], v243 offset:2048
    s_waitcnt lgkmcnt(4)
    v_mfma_f32_16x16x32_bf16 v[132:135], v[36:39], v[28:31], v[132:135]
    ds_read_b128 v[56:59], v243 offset:4096
    v_mfma_f32_16x16x32_bf16 v[116:119], v[36:39], v[24:27], v[116:119]
    ds_read_b128 v[60:63], v243 offset:6144
    v_mfma_f32_16x16x32_bf16 v[100:103], v[36:39], v[20:23], v[100:103]
    ds_read_b64_tr_b16 v[68:69], v245 offset:4096
    v_mfma_f32_16x16x32_bf16 v[84:87], v[36:39], v[16:19], v[84:87]
    ds_read_b64_tr_b16 v[70:71], v245 offset:4608
    v_mfma_f32_16x16x32_bf16 v[88:91], v[16:19], v[40:43], v[88:91]
    ds_read_b64_tr_b16 v[72:73], v244 offset:12288
    v_mfma_f32_16x16x32_bf16 v[104:107], v[20:23], v[40:43], v[104:107]
    ds_read_b64_tr_b16 v[74:75], v244 offset:12800
    v_mfma_f32_16x16x32_bf16 v[120:123], v[24:27], v[40:43], v[120:123]
    ds_read_b64_tr_b16 v[76:77], v245 offset:12288
    v_mfma_f32_16x16x32_bf16 v[136:139], v[28:31], v[40:43], v[136:139]
    ds_read_b64_tr_b16 v[78:79], v245 offset:12800
    v_mfma_f32_16x16x32_bf16 v[140:143], v[28:31], v[44:47], v[140:143]
    v_mfma_f32_16x16x32_bf16 v[124:127], v[24:27], v[44:47], v[124:127]
    v_mfma_f32_16x16x32_bf16 v[108:111], v[20:23], v[44:47], v[108:111]
    v_mfma_f32_16x16x32_bf16 v[92:95], v[16:19], v[44:47], v[92:95]
    s_waitcnt lgkmcnt(0)
    v_mfma_f32_16x16x32_bf16 v[80:83], v[64:67], v[48:51], v[80:83]
    s_barrier
    ds_read2_b32 v[232:233], v216 offset0:0 offset1:128
    ds_read2_b32 v[234:235], v216 offset0:16 offset1:144
    v_mfma_f32_16x16x32_bf16 v[96:99], v[64:67], v[52:55], v[96:99]
    ds_read2_b32 v[236:237], v216 offset0:32 offset1:160
    ds_read2_b32 v[238:239], v216 offset0:48 offset1:176
    v_mfma_f32_16x16x32_bf16 v[112:115], v[64:67], v[56:59], v[112:115]
    ds_read_b128 v[144:147], v248 offset:0
    ds_read_b128 v[148:151], v248 offset:64
    v_mfma_f32_16x16x32_bf16 v[128:131], v[64:67], v[60:63], v[128:131]
    ds_read_b64_tr_b16 v[224:225], v219 offset:0
    ds_read_b64_tr_b16 v[226:227], v219 offset:1024
    v_mfma_f32_16x16x32_bf16 v[132:135], v[68:71], v[60:63], v[132:135]
    ds_read_b64_tr_b16 v[228:229], v219 offset:32
    ds_read_b64_tr_b16 v[230:231], v219 offset:1056
    v_mfma_f32_16x16x32_bf16 v[116:119], v[68:71], v[56:59], v[116:119]
    ds_read2_b32 v[240:241], v217 offset0:0 offset1:32
    ds_read2_b32 v[152:153], v249 offset0:0 offset1:16
    v_mfma_f32_16x16x32_bf16 v[100:103], v[68:71], v[52:55], v[100:103]
    ds_read_b128 v[164:167], v218 offset:0
    ds_read_b128 v[168:171], v218 offset:512
    v_mfma_f32_16x16x32_bf16 v[84:87], v[68:71], v[48:51], v[84:87]
    ds_read_b128 v[172:175], v218 offset:64
    ds_read_b128 v[176:179], v218 offset:576
    v_mfma_f32_16x16x32_bf16 v[88:91], v[48:51], v[72:75], v[88:91]
    ds_read_b128 v[180:183], v218 offset:128
    ds_read_b128 v[184:187], v218 offset:640
    v_mfma_f32_16x16x32_bf16 v[104:107], v[52:55], v[72:75], v[104:107]
    ds_read_b128 v[188:191], v218 offset:192
    ds_read_b128 v[192:195], v218 offset:704
    v_mfma_f32_16x16x32_bf16 v[120:123], v[56:59], v[72:75], v[120:123]
    v_mfma_f32_16x16x32_bf16 v[136:139], v[60:63], v[72:75], v[136:139]
    v_mfma_f32_16x16x32_bf16 v[140:143], v[60:63], v[76:79], v[140:143]
    v_mfma_f32_16x16x32_bf16 v[124:127], v[56:59], v[76:79], v[124:127]
    v_mfma_f32_16x16x32_bf16 v[108:111], v[52:55], v[76:79], v[108:111]
    v_mfma_f32_16x16x32_bf16 v[92:95], v[48:51], v[76:79], v[92:95]
    s_nop 0
    s_waitcnt lgkmcnt(0)
    v_pk_fma_f32 v[80:81], v[144:145], v[232:233], v[80:81] op_sel:[0,1,0] op_sel_hi:[1,1,1]
    v_pk_fma_f32 v[82:83], v[146:147], v[232:233], v[82:83] op_sel:[0,1,0] op_sel_hi:[1,1,1]
    v_pk_fma_f32 v[84:85], v[148:149], v[232:233], v[84:85] op_sel:[0,1,0] op_sel_hi:[1,1,1]
    v_pk_fma_f32 v[86:87], v[150:151], v[232:233], v[86:87] op_sel:[0,1,0] op_sel_hi:[1,1,1]
    v_pk_fma_f32 v[96:97], v[144:145], v[234:235], v[96:97] op_sel:[0,1,0] op_sel_hi:[1,1,1]
    v_pk_fma_f32 v[98:99], v[146:147], v[234:235], v[98:99] op_sel:[0,1,0] op_sel_hi:[1,1,1]
    v_pk_fma_f32 v[100:101], v[148:149], v[234:235], v[100:101] op_sel:[0,1,0] op_sel_hi:[1,1,1]
    v_pk_fma_f32 v[102:103], v[150:151], v[234:235], v[102:103] op_sel:[0,1,0] op_sel_hi:[1,1,1]
    v_pk_fma_f32 v[112:113], v[144:145], v[236:237], v[112:113] op_sel:[0,1,0] op_sel_hi:[1,1,1]
    v_pk_fma_f32 v[114:115], v[146:147], v[236:237], v[114:115] op_sel:[0,1,0] op_sel_hi:[1,1,1]
    v_pk_fma_f32 v[116:117], v[148:149], v[236:237], v[116:117] op_sel:[0,1,0] op_sel_hi:[1,1,1]
    v_pk_fma_f32 v[118:119], v[150:151], v[236:237], v[118:119] op_sel:[0,1,0] op_sel_hi:[1,1,1]
    v_pk_fma_f32 v[128:129], v[144:145], v[238:239], v[128:129] op_sel:[0,1,0] op_sel_hi:[1,1,1]
    v_pk_fma_f32 v[130:131], v[146:147], v[238:239], v[130:131] op_sel:[0,1,0] op_sel_hi:[1,1,1]
    v_pk_fma_f32 v[132:133], v[148:149], v[238:239], v[132:133] op_sel:[0,1,0] op_sel_hi:[1,1,1]
    v_pk_fma_f32 v[134:135], v[150:151], v[238:239], v[134:135] op_sel:[0,1,0] op_sel_hi:[1,1,1]
    v_cvt_pk_bf16_f32 v80, v80, v81
    v_cvt_pk_bf16_f32 v81, v82, v83
    v_cvt_pk_bf16_f32 v82, v84, v85
    v_cvt_pk_bf16_f32 v83, v86, v87
    v_cvt_pk_bf16_f32 v96, v96, v97
    v_cvt_pk_bf16_f32 v97, v98, v99
    v_cvt_pk_bf16_f32 v98, v100, v101
    v_cvt_pk_bf16_f32 v99, v102, v103
    v_cvt_pk_bf16_f32 v112, v112, v113
    v_cvt_pk_bf16_f32 v113, v114, v115
    v_cvt_pk_bf16_f32 v114, v116, v117
    v_cvt_pk_bf16_f32 v115, v118, v119
    v_cvt_pk_bf16_f32 v128, v128, v129
    v_cvt_pk_bf16_f32 v129, v130, v131
    v_cvt_pk_bf16_f32 v130, v132, v133
    v_cvt_pk_bf16_f32 v131, v134, v135
    v_mfma_f32_16x16x32_bf16 v[16:19], v[224:227], v[80:83], 0
    v_mfma_f32_16x16x32_bf16 v[20:23], v[228:231], v[80:83], 0
    v_mfma_f32_16x16x32_bf16 v[24:27], v[224:227], v[96:99], 0
    v_mfma_f32_16x16x32_bf16 v[28:31], v[228:231], v[96:99], 0
    v_mfma_f32_16x16x32_bf16 v[32:35], v[224:227], v[112:115], 0
    v_mfma_f32_16x16x32_bf16 v[36:39], v[228:231], v[112:115], 0
    v_mfma_f32_16x16x32_bf16 v[40:43], v[224:227], v[128:131], 0
    v_mfma_f32_16x16x32_bf16 v[44:47], v[228:231], v[128:131], 0
    v_mul_f32 v232, 0x3fb8aa3b, v232
    v_mul_f32 v234, 0x3fb8aa3b, v234
    v_mul_f32 v236, 0x3fb8aa3b, v236
    v_mul_f32 v238, 0x3fb8aa3b, v238
    v_mul_f32 v240, 0x3fb8aa3b, v240
    v_mul_f32 v241, 0x3fb8aa3b, v241
    v_pk_fma_f32 v[88:89], v[168:169], v[152:153], v[88:89] op_sel:[0,0,0] op_sel_hi:[1,0,1]
    v_pk_fma_f32 v[90:91], v[170:171], v[152:153], v[90:91] op_sel:[0,0,0] op_sel_hi:[1,0,1]
    v_pk_fma_f32 v[92:93], v[168:169], v[152:153], v[92:93] op_sel:[0,1,0] op_sel_hi:[1,1,1]
    v_pk_fma_f32 v[94:95], v[170:171], v[152:153], v[94:95] op_sel:[0,1,0] op_sel_hi:[1,1,1]
    v_pk_mul_f32 v[88:89], v[88:89], v[164:165]
    v_pk_mul_f32 v[90:91], v[90:91], v[166:167]
    v_pk_mul_f32 v[92:93], v[92:93], v[164:165]
    v_pk_mul_f32 v[94:95], v[94:95], v[166:167]
    v_pk_fma_f32 v[104:105], v[176:177], v[152:153], v[104:105] op_sel:[0,0,0] op_sel_hi:[1,0,1]
    v_pk_fma_f32 v[106:107], v[178:179], v[152:153], v[106:107] op_sel:[0,0,0] op_sel_hi:[1,0,1]
    v_pk_fma_f32 v[108:109], v[176:177], v[152:153], v[108:109] op_sel:[0,1,0] op_sel_hi:[1,1,1]
    v_pk_fma_f32 v[110:111], v[178:179], v[152:153], v[110:111] op_sel:[0,1,0] op_sel_hi:[1,1,1]
    v_pk_mul_f32 v[104:105], v[104:105], v[172:173]
    v_pk_mul_f32 v[106:107], v[106:107], v[174:175]
    v_pk_mul_f32 v[108:109], v[108:109], v[172:173]
    v_pk_mul_f32 v[110:111], v[110:111], v[174:175]
    v_pk_fma_f32 v[120:121], v[184:185], v[152:153], v[120:121] op_sel:[0,0,0] op_sel_hi:[1,0,1]
    v_pk_fma_f32 v[122:123], v[186:187], v[152:153], v[122:123] op_sel:[0,0,0] op_sel_hi:[1,0,1]
    v_pk_fma_f32 v[124:125], v[184:185], v[152:153], v[124:125] op_sel:[0,1,0] op_sel_hi:[1,1,1]
    v_pk_fma_f32 v[126:127], v[186:187], v[152:153], v[126:127] op_sel:[0,1,0] op_sel_hi:[1,1,1]
    v_pk_mul_f32 v[120:121], v[120:121], v[180:181]
    v_pk_mul_f32 v[122:123], v[122:123], v[182:183]
    v_pk_mul_f32 v[124:125], v[124:125], v[180:181]
    v_pk_mul_f32 v[126:127], v[126:127], v[182:183]
    v_pk_fma_f32 v[136:137], v[192:193], v[152:153], v[136:137] op_sel:[0,0,0] op_sel_hi:[1,0,1]
    v_pk_fma_f32 v[138:139], v[194:195], v[152:153], v[138:139] op_sel:[0,0,0] op_sel_hi:[1,0,1]
    v_pk_fma_f32 v[140:141], v[192:193], v[152:153], v[140:141] op_sel:[0,1,0] op_sel_hi:[1,1,1]
    v_pk_fma_f32 v[142:143], v[194:195], v[152:153], v[142:143] op_sel:[0,1,0] op_sel_hi:[1,1,1]
    v_pk_mul_f32 v[136:137], v[136:137], v[188:189]
    v_pk_mul_f32 v[138:139], v[138:139], v[190:191]
    v_pk_mul_f32 v[140:141], v[140:141], v[188:189]
    v_pk_mul_f32 v[142:143], v[142:143], v[190:191]
    v_cvt_pk_bf16_f32 v164, v88, v89
    v_cvt_pk_bf16_f32 v165, v90, v91
    v_cvt_pk_bf16_f32 v168, v92, v93
    v_cvt_pk_bf16_f32 v169, v94, v95
    v_cvt_pk_bf16_f32 v166, v104, v105
    v_cvt_pk_bf16_f32 v167, v106, v107
    v_cvt_pk_bf16_f32 v170, v108, v109
    v_cvt_pk_bf16_f32 v171, v110, v111
    v_cvt_pk_bf16_f32 v172, v120, v121
    v_cvt_pk_bf16_f32 v173, v122, v123
    v_cvt_pk_bf16_f32 v176, v124, v125
    v_cvt_pk_bf16_f32 v177, v126, v127
    v_cvt_pk_bf16_f32 v174, v136, v137
    v_cvt_pk_bf16_f32 v175, v138, v139
    v_cvt_pk_bf16_f32 v178, v140, v141
    v_cvt_pk_bf16_f32 v179, v142, v143
    v_max3_f32 v154, v16, v17, v18
    v_max3_f32 v155, -v16, -v17, -v18
    v_max3_f32 v156, v24, v25, v26
    v_max3_f32 v157, -v24, -v25, -v26
    v_max3_f32 v158, v32, v33, v34
    v_max3_f32 v159, -v32, -v33, -v34
    v_max3_f32 v160, v40, v41, v42
    v_max3_f32 v161, -v40, -v41, -v42
    v_max3_f32 v154, v154, v19, v20
    v_max3_f32 v155, v155, -v19, -v20
    v_max3_f32 v156, v156, v27, v28
    v_max3_f32 v157, v157, -v27, -v28
    v_max3_f32 v158, v158, v35, v36
    v_max3_f32 v159, v159, -v35, -v36
    v_max3_f32 v160, v160, v43, v44
    v_max3_f32 v161, v161, -v43, -v44
    v_max3_f32 v154, v154, v21, v22
    v_max3_f32 v155, v155, -v21, -v22
    v_max3_f32 v156, v156, v29, v30
    v_max3_f32 v157, v157, -v29, -v30
    v_max3_f32 v158, v158, v37, v38
    v_max3_f32 v159, v159, -v37, -v38
    v_max3_f32 v160, v160, v45, v46
    v_max3_f32 v161, v161, -v45, -v46
    v_max_f32_e64 v154, v154, v23
    v_max_f32_e64 v155, v155, -v23
    v_max_f32_e64 v156, v156, v31
    v_max_f32_e64 v157, v157, -v31
    v_max_f32_e64 v158, v158, v39
    v_max_f32_e64 v159, v159, -v39
    v_max_f32_e64 v160, v160, v47
    v_max_f32_e64 v161, v161, -v47
    v_permlane32_swap_b32 v154, v155
    v_permlane32_swap_b32 v156, v157
    v_permlane32_swap_b32 v158, v159
    v_permlane32_swap_b32 v160, v161
    v_max_f32 v154, v154, v155
    v_max_f32 v156, v156, v157
    v_max_f32 v158, v158, v159
    v_max_f32 v160, v160, v161
    v_permlane16_swap_b32 v154, v156
    s_nop 0
    v_permlane16_swap_b32 v158, v160
    v_max_f32 v154, v154, v156
    v_max_f32_e64 v158, v158, v160
    v_mul_f32_e64 v154, -v240, v154
    v_mul_f32_e64 v158, -v241, v158
    v_mov_b32 v156, v154
    v_mov_b32 v160, v158
    s_nop 0
    v_permlane16_swap_b32 v154, v156
    v_permlane16_swap_b32 v158, v160
    v_mov_b32 v155, v154
    v_mov_b32 v157, v156
    v_mov_b32 v159, v158
    v_mov_b32 v161, v160
    v_permlane32_swap_b32 v154, v155
    v_permlane32_swap_b32 v156, v157
    v_permlane32_swap_b32 v158, v159
    v_permlane32_swap_b32_e64 v160, v161
    v_pk_fma_f32 v[48:49], v[16:17], v[232:233], v[154:155] op_sel:[0,0,1] op_sel_hi:[1,0,1] neg_lo:[1,0,0] neg_hi:[1,0,0]
    v_pk_fma_f32 v[16:17], v[16:17], v[232:233], v[154:155] op_sel:[0,0,0] op_sel_hi:[1,0,0]
    v_pk_fma_f32 v[50:51], v[18:19], v[232:233], v[154:155] op_sel:[0,0,1] op_sel_hi:[1,0,1] neg_lo:[1,0,0] neg_hi:[1,0,0]
    v_pk_fma_f32 v[18:19], v[18:19], v[232:233], v[154:155] op_sel:[0,0,0] op_sel_hi:[1,0,0]
    v_pk_fma_f32 v[52:53], v[20:21], v[232:233], v[154:155] op_sel:[0,0,1] op_sel_hi:[1,0,1] neg_lo:[1,0,0] neg_hi:[1,0,0]
    v_pk_fma_f32 v[20:21], v[20:21], v[232:233], v[154:155] op_sel:[0,0,0] op_sel_hi:[1,0,0]
    v_pk_fma_f32 v[54:55], v[22:23], v[232:233], v[154:155] op_sel:[0,0,1] op_sel_hi:[1,0,1] neg_lo:[1,0,0] neg_hi:[1,0,0]
    v_pk_fma_f32 v[22:23], v[22:23], v[232:233], v[154:155] op_sel:[0,0,0] op_sel_hi:[1,0,0]
    v_pk_fma_f32 v[56:57], v[24:25], v[234:235], v[156:157] op_sel:[0,0,1] op_sel_hi:[1,0,1] neg_lo:[1,0,0] neg_hi:[1,0,0]
    v_pk_fma_f32 v[24:25], v[24:25], v[234:235], v[156:157] op_sel:[0,0,0] op_sel_hi:[1,0,0]
    v_pk_fma_f32 v[58:59], v[26:27], v[234:235], v[156:157] op_sel:[0,0,1] op_sel_hi:[1,0,1] neg_lo:[1,0,0] neg_hi:[1,0,0]
    v_pk_fma_f32 v[26:27], v[26:27], v[234:235], v[156:157] op_sel:[0,0,0] op_sel_hi:[1,0,0]
    v_pk_fma_f32 v[60:61], v[28:29], v[234:235], v[156:157] op_sel:[0,0,1] op_sel_hi:[1,0,1] neg_lo:[1,0,0] neg_hi:[1,0,0]
    v_pk_fma_f32 v[28:29], v[28:29], v[234:235], v[156:157] op_sel:[0,0,0] op_sel_hi:[1,0,0]
    v_pk_fma_f32 v[62:63], v[30:31], v[234:235], v[156:157] op_sel:[0,0,1] op_sel_hi:[1,0,1] neg_lo:[1,0,0] neg_hi:[1,0,0]
    v_pk_fma_f32 v[30:31], v[30:31], v[234:235], v[156:157] op_sel:[0,0,0] op_sel_hi:[1,0,0]
    v_pk_fma_f32 v[64:65], v[32:33], v[236:237], v[158:159] op_sel:[0,0,1] op_sel_hi:[1,0,1] neg_lo:[1,0,0] neg_hi:[1,0,0]
    v_pk_fma_f32 v[32:33], v[32:33], v[236:237], v[158:159] op_sel:[0,0,0] op_sel_hi:[1,0,0]
    v_pk_fma_f32 v[66:67], v[34:35], v[236:237], v[158:159] op_sel:[0,0,1] op_sel_hi:[1,0,1] neg_lo:[1,0,0] neg_hi:[1,0,0]
    v_pk_fma_f32 v[34:35], v[34:35], v[236:237], v[158:159] op_sel:[0,0,0] op_sel_hi:[1,0,0]
    v_pk_fma_f32 v[68:69], v[36:37], v[236:237], v[158:159] op_sel:[0,0,1] op_sel_hi:[1,0,1] neg_lo:[1,0,0] neg_hi:[1,0,0]
    v_pk_fma_f32 v[36:37], v[36:37], v[236:237], v[158:159] op_sel:[0,0,0] op_sel_hi:[1,0,0]
    v_pk_fma_f32 v[70:71], v[38:39], v[236:237], v[158:159] op_sel:[0,0,1] op_sel_hi:[1,0,1] neg_lo:[1,0,0] neg_hi:[1,0,0]
    v_pk_fma_f32 v[38:39], v[38:39], v[236:237], v[158:159] op_sel:[0,0,0] op_sel_hi:[1,0,0]
    v_pk_fma_f32 v[72:73], v[40:41], v[238:239], v[160:161] op_sel:[0,0,1] op_sel_hi:[1,0,1] neg_lo:[1,0,0] neg_hi:[1,0,0]
    v_pk_fma_f32 v[40:41], v[40:41], v[238:239], v[160:161] op_sel:[0,0,0] op_sel_hi:[1,0,0]
    v_pk_fma_f32 v[74:75], v[42:43], v[238:239], v[160:161] op_sel:[0,0,1] op_sel_hi:[1,0,1] neg_lo:[1,0,0] neg_hi:[1,0,0]
    v_pk_fma_f32 v[42:43], v[42:43], v[238:239], v[160:161] op_sel:[0,0,0] op_sel_hi:[1,0,0]
    v_pk_fma_f32 v[76:77], v[44:45], v[238:239], v[160:161] op_sel:[0,0,1] op_sel_hi:[1,0,1] neg_lo:[1,0,0] neg_hi:[1,0,0]
    v_pk_fma_f32 v[44:45], v[44:45], v[238:239], v[160:161] op_sel:[0,0,0] op_sel_hi:[1,0,0]
    v_pk_fma_f32 v[78:79], v[46:47], v[238:239], v[160:161] op_sel:[0,0,1] op_sel_hi:[1,0,1] neg_lo:[1,0,0] neg_hi:[1,0,0]
    v_pk_fma_f32 v[46:47], v[46:47], v[238:239], v[160:161] op_sel:[0,0,0] op_sel_hi:[1,0,0]
    v_exp_f32 v48, v48
    v_exp_f32 v16, v16
    v_exp_f32 v49, v49
    v_exp_f32 v17, v17
    v_exp_f32 v50, v50
    v_exp_f32 v18, v18
    v_exp_f32 v51, v51
    v_exp_f32 v19, v19
    v_exp_f32 v52, v52
    v_exp_f32 v20, v20
    v_exp_f32 v53, v53
    v_exp_f32 v21, v21
    v_exp_f32 v54, v54
    v_exp_f32 v22, v22
    v_exp_f32 v55, v55
    v_exp_f32 v23, v23
    v_exp_f32 v56, v56
    v_exp_f32 v24, v24
    v_exp_f32 v57, v57
    v_exp_f32 v25, v25
    v_exp_f32 v58, v58
    v_exp_f32 v26, v26
    v_exp_f32 v59, v59
    v_exp_f32 v27, v27
    v_exp_f32 v60, v60
    v_exp_f32 v28, v28
    v_exp_f32 v61, v61
    v_exp_f32 v29, v29
    v_exp_f32 v62, v62
    v_exp_f32 v30, v30
    v_exp_f32 v63, v63
    v_exp_f32 v31, v31
    v_exp_f32 v64, v64
    v_exp_f32 v32, v32
    v_exp_f32 v65, v65
    v_exp_f32 v33, v33
    v_exp_f32 v66, v66
    v_exp_f32 v34, v34
    v_exp_f32 v67, v67
    v_exp_f32 v35, v35
    v_exp_f32 v68, v68
    v_exp_f32 v36, v36
    v_exp_f32 v69, v69
    v_exp_f32 v37, v37
    v_exp_f32 v70, v70
    v_exp_f32 v38, v38
    v_exp_f32 v71, v71
    v_exp_f32 v39, v39
    v_exp_f32 v72, v72
    v_exp_f32 v40, v40
    v_exp_f32 v73, v73
    v_exp_f32 v41, v41
    v_exp_f32 v74, v74
    v_exp_f32 v42, v42
    v_exp_f32 v75, v75
    v_exp_f32 v43, v43
    v_exp_f32 v76, v76
    v_exp_f32 v44, v44
    v_exp_f32 v77, v77
    v_exp_f32 v45, v45
    v_exp_f32 v78, v78
    v_exp_f32 v46, v46
    v_exp_f32 v79, v79
    v_exp_f32 v47, v47
    v_pk_add_f32 v[184:185], v[16:17], v[18:19]
    v_pk_add_f32 v[186:187], v[48:49], v[50:51]
    v_pk_add_f32 v[188:189], v[24:25], v[26:27]
    v_pk_add_f32 v[190:191], v[56:57], v[58:59]
    v_pk_add_f32 v[192:193], v[32:33], v[34:35]
    v_pk_add_f32 v[194:195], v[64:65], v[66:67]
    v_pk_add_f32 v[196:197], v[40:41], v[42:43]
    v_pk_add_f32 v[198:199], v[72:73], v[74:75]
    v_pk_add_f32 v[184:185], v[184:185], v[20:21]
    v_pk_add_f32 v[186:187], v[186:187], v[52:53]
    v_pk_add_f32 v[188:189], v[188:189], v[28:29]
    v_pk_add_f32 v[190:191], v[190:191], v[60:61]
    v_pk_add_f32 v[192:193], v[192:193], v[36:37]
    v_pk_add_f32 v[194:195], v[194:195], v[68:69]
    v_pk_add_f32 v[196:197], v[196:197], v[44:45]
    v_pk_add_f32 v[198:199], v[198:199], v[76:77]
    v_pk_add_f32 v[184:185], v[184:185], v[22:23]
    v_pk_add_f32 v[186:187], v[186:187], v[54:55]
    v_pk_add_f32 v[188:189], v[188:189], v[30:31]
    v_pk_add_f32 v[190:191], v[190:191], v[62:63]
    v_pk_add_f32 v[192:193], v[192:193], v[38:39]
    v_pk_add_f32 v[194:195], v[194:195], v[70:71]
    v_pk_add_f32 v[196:197], v[196:197], v[46:47]
    v_pk_add_f32 v[198:199], v[198:199], v[78:79]
    v_add_f32 v154, v184, v185
    v_add_f32 v155, v186, v187
    v_add_f32 v156, v188, v189
    v_add_f32 v157, v190, v191
    v_add_f32 v158, v192, v193
    v_add_f32 v159, v194, v195
    v_add_f32 v160, v196, v197
    v_add_f32 v161, v198, v199
    v_permlane32_swap_b32 v154, v155
    v_permlane32_swap_b32 v156, v157
    v_permlane32_swap_b32 v158, v159
    v_permlane32_swap_b32 v160, v161
    v_add_f32 v154, v154, v155
    v_add_f32 v156, v156, v157
    v_add_f32 v158, v158, v159
    v_add_f32 v160, v160, v161
    v_permlane16_swap_b32 v154, v156
    s_nop 0
    v_permlane16_swap_b32 v158, v160
    v_add_f32 v154, v154, v156
    v_add_f32 v158, v158, v160
    v_rcp_f32 v154, v154
    v_rcp_f32 v158, v158
    v_mov_b32 v156, v154
    v_mov_b32 v160, v158
    s_nop 0
    v_permlane16_swap_b32 v154, v156
    v_permlane16_swap_b32 v158, v160
    v_mov_b32 v155, v154
    v_mov_b32 v157, v156
    v_mov_b32 v159, v158
    v_mov_b32 v161, v160
    v_permlane32_swap_b32 v154, v155
    v_permlane32_swap_b32 v156, v157
    v_permlane32_swap_b32 v158, v159
    v_permlane32_swap_b32 v160, v161
    v_pk_mul_f32 v[16:17], v[16:17], v[154:155] op_sel:[0,0] op_sel_hi:[1,0]
    v_pk_mul_f32 v[18:19], v[18:19], v[154:155] op_sel:[0,0] op_sel_hi:[1,0]
    v_pk_mul_f32 v[20:21], v[20:21], v[154:155] op_sel:[0,0] op_sel_hi:[1,0]
    v_pk_mul_f32 v[22:23], v[22:23], v[154:155] op_sel:[0,0] op_sel_hi:[1,0]
    v_pk_mul_f32 v[48:49], v[48:49], v[154:155] op_sel:[0,1] op_sel_hi:[1,1]
    v_pk_mul_f32 v[50:51], v[50:51], v[154:155] op_sel:[0,1] op_sel_hi:[1,1]
    v_pk_mul_f32 v[52:53], v[52:53], v[154:155] op_sel:[0,1] op_sel_hi:[1,1]
    v_pk_mul_f32 v[54:55], v[54:55], v[154:155] op_sel:[0,1] op_sel_hi:[1,1]
    v_pk_mul_f32 v[24:25], v[24:25], v[156:157] op_sel:[0,0] op_sel_hi:[1,0]
    v_pk_mul_f32 v[26:27], v[26:27], v[156:157] op_sel:[0,0] op_sel_hi:[1,0]
    v_pk_mul_f32 v[28:29], v[28:29], v[156:157] op_sel:[0,0] op_sel_hi:[1,0]
    v_pk_mul_f32 v[30:31], v[30:31], v[156:157] op_sel:[0,0] op_sel_hi:[1,0]
    v_pk_mul_f32 v[56:57], v[56:57], v[156:157] op_sel:[0,1] op_sel_hi:[1,1]
    v_pk_mul_f32 v[58:59], v[58:59], v[156:157] op_sel:[0,1] op_sel_hi:[1,1]
    v_pk_mul_f32 v[60:61], v[60:61], v[156:157] op_sel:[0,1] op_sel_hi:[1,1]
    v_pk_mul_f32 v[62:63], v[62:63], v[156:157] op_sel:[0,1] op_sel_hi:[1,1]
    v_pk_mul_f32 v[32:33], v[32:33], v[158:159] op_sel:[0,0] op_sel_hi:[1,0]
    v_pk_mul_f32 v[34:35], v[34:35], v[158:159] op_sel:[0,0] op_sel_hi:[1,0]
    v_pk_mul_f32 v[36:37], v[36:37], v[158:159] op_sel:[0,0] op_sel_hi:[1,0]
    v_pk_mul_f32 v[38:39], v[38:39], v[158:159] op_sel:[0,0] op_sel_hi:[1,0]
    v_pk_mul_f32 v[64:65], v[64:65], v[158:159] op_sel:[0,1] op_sel_hi:[1,1]
    v_pk_mul_f32 v[66:67], v[66:67], v[158:159] op_sel:[0,1] op_sel_hi:[1,1]
    v_pk_mul_f32 v[68:69], v[68:69], v[158:159] op_sel:[0,1] op_sel_hi:[1,1]
    v_pk_mul_f32 v[70:71], v[70:71], v[158:159] op_sel:[0,1] op_sel_hi:[1,1]
    v_pk_mul_f32 v[40:41], v[40:41], v[160:161] op_sel:[0,0] op_sel_hi:[1,0]
    v_pk_mul_f32 v[42:43], v[42:43], v[160:161] op_sel:[0,0] op_sel_hi:[1,0]
    v_pk_mul_f32 v[44:45], v[44:45], v[160:161] op_sel:[0,0] op_sel_hi:[1,0]
    v_pk_mul_f32 v[46:47], v[46:47], v[160:161] op_sel:[0,0] op_sel_hi:[1,0]
    v_pk_mul_f32 v[72:73], v[72:73], v[160:161] op_sel:[0,1] op_sel_hi:[1,1]
    v_pk_mul_f32 v[74:75], v[74:75], v[160:161] op_sel:[0,1] op_sel_hi:[1,1]
    v_pk_mul_f32 v[76:77], v[76:77], v[160:161] op_sel:[0,1] op_sel_hi:[1,1]
    v_pk_mul_f32 v[78:79], v[78:79], v[160:161] op_sel:[0,1] op_sel_hi:[1,1]
    v_cvt_pk_bf16_f32 v80, v16, v17
    v_cvt_pk_bf16_f32 v81, v18, v19
    v_cvt_pk_bf16_f32 v82, v20, v21
    v_cvt_pk_bf16_f32 v83, v22, v23
    v_cvt_pk_bf16_f32 v88, v24, v25
    v_cvt_pk_bf16_f32 v89, v26, v27
    v_cvt_pk_bf16_f32 v90, v28, v29
    v_cvt_pk_bf16_f32 v91, v30, v31
    v_cvt_pk_bf16_f32 v96, v32, v33
    v_cvt_pk_bf16_f32 v97, v34, v35
    v_cvt_pk_bf16_f32 v98, v36, v37
    v_cvt_pk_bf16_f32 v99, v38, v39
    v_cvt_pk_bf16_f32 v104, v40, v41
    v_cvt_pk_bf16_f32 v105, v42, v43
    v_cvt_pk_bf16_f32 v106, v44, v45
    v_cvt_pk_bf16_f32 v107, v46, v47
    v_mfma_f32_16x16x32_bf16 v[16:19], v[80:83], v[210:213], 0
    v_cvt_pk_bf16_f32 v84, v48, v49
    v_cvt_pk_bf16_f32 v85, v50, v51
    v_mfma_f32_16x16x32_bf16 v[20:23], v[88:91], v[210:213], 0
    v_cvt_pk_bf16_f32 v86, v52, v53
    v_cvt_pk_bf16_f32 v87, v54, v55
    v_mfma_f32_16x16x32_bf16 v[24:27], v[96:99], v[210:213], 0
    v_cvt_pk_bf16_f32 v92, v56, v57
    v_cvt_pk_bf16_f32 v93, v58, v59
    v_mfma_f32_16x16x32_bf16 v[28:31], v[104:107], v[210:213], 0
    v_cvt_pk_bf16_f32 v94, v60, v61
    v_cvt_pk_bf16_f32 v95, v62, v63
    v_mfma_f32_16x16x32_bf16 v[32:35], v[80:83], v[208:211], 0
    v_cvt_pk_bf16_f32 v100, v64, v65
    v_cvt_pk_bf16_f32 v101, v66, v67
    v_mfma_f32_16x16x32_bf16 v[36:39], v[88:91], v[208:211], 0
    v_cvt_pk_bf16_f32 v102, v68, v69
    v_cvt_pk_bf16_f32 v103, v70, v71
    v_mfma_f32_16x16x32_bf16 v[40:43], v[96:99], v[208:211], 0
    v_cvt_pk_bf16_f32 v108, v72, v73
    v_cvt_pk_bf16_f32 v109, v74, v75
    v_mfma_f32_16x16x32_bf16 v[44:47], v[104:107], v[208:211], 0
    v_cvt_pk_bf16_f32 v110, v76, v77
    v_cvt_pk_bf16_f32 v111, v78, v79
    v_mfma_f32_16x16x32_bf16 v[48:51], v[84:87], v[210:213], 0
    v_cvt_pk_bf16_f32 v16, v16, v17
    v_cvt_pk_bf16_f32 v17, v18, v19
    v_mfma_f32_16x16x32_bf16 v[52:55], v[92:95], v[210:213], 0
    v_cvt_pk_bf16_f32 v18, v20, v21
    v_cvt_pk_bf16_f32 v19, v22, v23
    v_mfma_f32_16x16x32_bf16 v[56:59], v[100:103], v[210:213], 0
    v_cvt_pk_bf16_f32 v20, v24, v25
    v_cvt_pk_bf16_f32 v21, v26, v27
    v_mfma_f32_16x16x32_bf16 v[60:63], v[108:111], v[210:213], 0
    v_cvt_pk_bf16_f32 v22, v28, v29
    v_cvt_pk_bf16_f32 v23, v30, v31
    v_mfma_f32_16x16x32_bf16 v[64:67], v[84:87], v[208:211], 0
    v_cvt_pk_bf16_f32 v32, v32, v33
    v_cvt_pk_bf16_f32 v33, v34, v35
    v_mfma_f32_16x16x32_bf16 v[68:71], v[92:95], v[208:211], 0
    v_cvt_pk_bf16_f32 v34, v36, v37
    v_cvt_pk_bf16_f32 v35, v38, v39
    v_mfma_f32_16x16x32_bf16 v[72:75], v[100:103], v[208:211], 0
    v_cvt_pk_bf16_f32 v36, v40, v41
    v_cvt_pk_bf16_f32 v37, v42, v43
    v_mfma_f32_16x16x32_bf16 v[76:79], v[108:111], v[208:211], 0
    v_cvt_pk_bf16_f32 v38, v44, v45
    v_cvt_pk_bf16_f32 v39, v46, v47
    v_mfma_f32_16x16x32_bf16 v[112:115], v[16:19], v[164:167], 0
    v_cvt_pk_bf16_f32 v48, v48, v49
    v_cvt_pk_bf16_f32 v49, v50, v51
    v_mfma_f32_16x16x32_bf16 v[120:123], v[16:19], v[168:171], 0
    v_cvt_pk_bf16_f32 v50, v52, v53
    v_cvt_pk_bf16_f32 v51, v54, v55
    v_mfma_f32_16x16x32_bf16 v[112:115], v[20:23], v[172:175], v[112:115]
    v_cvt_pk_bf16_f32 v52, v56, v57
    v_cvt_pk_bf16_f32 v53, v58, v59
    v_mfma_f32_16x16x32_bf16 v[120:123], v[20:23], v[176:179], v[120:123]
    v_cvt_pk_bf16_f32 v54, v60, v61
    v_cvt_pk_bf16_f32 v55, v62, v63
    v_mfma_f32_16x16x32_bf16 v[116:119], v[32:35], v[164:167], 0
    v_cvt_pk_bf16_f32 v64, v64, v65
    v_cvt_pk_bf16_f32 v65, v66, v67
    v_mfma_f32_16x16x32_bf16 v[124:127], v[32:35], v[168:171], 0
    v_cvt_pk_bf16_f32 v66, v68, v69
    v_cvt_pk_bf16_f32 v67, v70, v71
    v_mfma_f32_16x16x32_bf16 v[116:119], v[36:39], v[172:175], v[116:119]
    v_cvt_pk_bf16_f32 v68, v72, v73
    v_cvt_pk_bf16_f32 v69, v74, v75
    v_mfma_f32_16x16x32_bf16 v[124:127], v[36:39], v[176:179], v[124:127]
    s_branch .pg_2
.p2align 12
.pad_2:
    s_nop 0
    s_setpc_b64 s[44:45]
.pg_2:
    v_cvt_pk_bf16_f32 v70, v76, v77
    v_cvt_pk_bf16_f32 v71, v78, v79
    s_mov_b32 s28, 0
    v_mfma_f32_16x16x32_bf16 v[128:131], v[48:51], v[164:167], 0
    s_mov_b32 s66, 0
    s_mov_b32 s67, 0
    v_mfma_f32_16x16x32_bf16 v[136:139], v[48:51], v[168:171], 0
    v_add_u32 v242, s66, v254
    v_xor_b32_e64 v243, 64, v242
    v_mfma_f32_16x16x32_bf16 v[128:131], v[52:55], v[172:175], v[128:131]
    v_add_u32 v244, s67, v255
    v_xor_b32 v245, 32, v244
    v_mfma_f32_16x16x32_bf16 v[136:139], v[52:55], v[176:179], v[136:139]
    v_cvt_pk_bf16_f32 v112, v112, v113
    v_cvt_pk_bf16_f32 v113, v114, v115
    v_cvt_pk_bf16_f32 v114, v116, v117
    v_mfma_f32_16x16x32_bf16 v[132:135], v[64:67], v[164:167], 0
    v_cvt_pk_bf16_f32 v115, v118, v119
    buffer_store_dwordx4 v[112:115], v220, s[72:75], s28 offen sc1
    v_mfma_f32_16x16x32_bf16 v[140:143], v[64:67], v[168:171], 0
    s_add_u32 s28, s28, 32768
    v_cvt_pk_bf16_f32 v120, v120, v121
    v_mfma_f32_16x16x32_bf16 v[132:135], v[68:71], v[172:175], v[132:135]
    v_cvt_pk_bf16_f32 v121, v122, v123
    v_cvt_pk_bf16_f32 v122, v124, v125
    v_mfma_f32_16x16x32_bf16 v[140:143], v[68:71], v[176:179], v[140:143]
    v_cvt_pk_bf16_f32 v123, v126, v127
    buffer_store_dwordx4 v[120:123], v220, s[72:75], s28 offen sc1
    s_add_u32 s28, s28, 32768
    v_mfma_f32_16x16x32_bf16 v[184:187], v[12:15], v[16:19], 0
    s_nop 0
    s_nop 0
    v_mfma_f32_16x16x32_bf16 v[184:187], v[12:15], v[20:23], v[184:187]
    s_nop 0
    s_nop 0
    v_mfma_f32_16x16x32_bf16 v[188:191], v[12:15], v[32:35], 0
    v_cvt_pk_bf16_f32 v128, v128, v129
    v_cvt_pk_bf16_f32 v129, v130, v131
    v_mfma_f32_16x16x32_bf16 v[188:191], v[12:15], v[36:39], v[188:191]
    v_cvt_pk_bf16_f32 v130, v132, v133
    v_cvt_pk_bf16_f32 v131, v134, v135
    v_mfma_f32_16x16x32_bf16 v[192:195], v[12:15], v[48:51], 0
    buffer_store_dwordx4 v[128:131], v220, s[72:75], s28 offen sc1
    s_add_u32 s28, s28, 32768
    v_mfma_f32_16x16x32_bf16 v[192:195], v[12:15], v[52:55], v[192:195]
    v_cvt_pk_bf16_f32 v136, v136, v137
    v_cvt_pk_bf16_f32 v137, v138, v139
    v_mfma_f32_16x16x32_bf16 v[196:199], v[12:15], v[64:67], 0
    v_cvt_pk_bf16_f32 v138, v140, v141
    v_cvt_pk_bf16_f32 v139, v142, v143
    v_mfma_f32_16x16x32_bf16 v[196:199], v[12:15], v[68:71], v[196:199]
    buffer_store_dwordx4 v[136:139], v220, s[72:75], s28 offen sc1
    s_add_u32 s28, s28, 32768
    v_mov_b32 v2, v184
    v_cmp_le_u32 vcc, 16, v1
    s_nop 1
    v_cndmask_b32 v2, v2, v188, vcc
    v_cmp_le_u32 vcc, 32, v1
    s_nop 1
    v_cndmask_b32 v2, v2, v192, vcc
    v_cmp_le_u32 vcc, 48, v1
    s_nop 1
    v_cndmask_b32 v2, v2, v196, vcc
    buffer_atomic_add_f32 v2, v221, s[60:63], 0 offen sc1
    s_waitcnt lgkmcnt(0)
    s_barrier
    ds_read_b64_tr_b16 v[32:33], v244 offset:0
    ds_read_b64_tr_b16 v[34:35], v244 offset:512
    ds_read_b128 v[16:19], v242 offset:0
    ds_read_b64_tr_b16 v[56:57], v244 offset:4096
    ds_read_b64_tr_b16 v[58:59], v244 offset:4608
    ds_read_b128 v[40:43], v243 offset:0
    ds_read_b128 v[20:23], v242 offset:2048
    ds_read_b128 v[44:47], v243 offset:2048
    ds_read_b128 v[24:27], v242 offset:4096
    ds_read_b128 v[48:51], v243 offset:4096
    ds_read_b128 v[28:31], v242 offset:6144
    ds_read_b128 v[52:55], v243 offset:6144
    ds_read_b64_tr_b16 v[36:37], v245 offset:0
    ds_read_b64_tr_b16 v[38:39], v245 offset:512
    ds_read_b64_tr_b16 v[60:61], v245 offset:4096
    ds_read_b64_tr_b16 v[62:63], v245 offset:4608
    s_add_u32 s66, s66, 16384
    s_and_b32 s66, s66, 0xffff
    s_add_u32 s67, s67, 8192
    s_cmp_eq_u32 s67, 81920
    s_cselect_b32 s67, 0, s67
    v_add_u32 v242, s66, v254
    v_xor_b32 v243, 64, v242
    v_add_u32 v244, s67, v255
    v_xor_b32_e64 v245, 32, v244
    s_add_u32 s66, s66, 16384
    s_and_b32 s66, s66, 0xffff
    s_add_u32 s67, s67, 8192
    s_cmp_eq_u32 s67, 81920
    s_cselect_b32 s67, 0, s67
    s_waitcnt lgkmcnt(0)
    v_mfma_f32_16x16x32_bf16 v[80:83], v[32:35], v[16:19], 0
    s_barrier
    v_mfma_f32_16x16x32_bf16 v[80:83], v[56:59], v[40:43], v[80:83]
    ds_read_b64_tr_b16 v[160:161], v244 offset:0
    ds_read_b64_tr_b16 v[162:163], v244 offset:512
    v_mfma_f32_16x16x32_bf16 v[88:91], v[32:35], v[20:23], 0
    ds_read_b128 v[144:147], v242 offset:0
    ds_read_b64_tr_b16 v[184:185], v244 offset:4096
    v_mfma_f32_16x16x32_bf16 v[88:91], v[56:59], v[44:47], v[88:91]
    ds_read_b64_tr_b16 v[186:187], v244 offset:4608
    ds_read_b128 v[168:171], v243 offset:0
    v_mfma_f32_16x16x32_bf16 v[96:99], v[32:35], v[24:27], 0
    ds_read_b128 v[148:151], v242 offset:2048
    ds_read_b128 v[172:175], v243 offset:2048
    v_mfma_f32_16x16x32_bf16 v[96:99], v[56:59], v[48:51], v[96:99]
    ds_read_b128 v[152:155], v242 offset:4096
    v_mfma_f32_16x16x32_bf16 v[104:107], v[32:35], v[28:31], 0
    ds_read_b128 v[176:179], v243 offset:4096
    v_mfma_f32_16x16x32_bf16 v[104:107], v[56:59], v[52:55], v[104:107]
    ds_read_b128 v[156:159], v242 offset:6144
    v_mfma_f32_16x16x32_bf16 v[108:111], v[36:39], v[28:31], 0
    ds_read_b128 v[180:183], v243 offset:6144
    v_mfma_f32_16x16x32_bf16 v[108:111], v[60:63], v[52:55], v[108:111]
    ds_read_b64_tr_b16 v[164:165], v245 offset:0
    ds_read_b64_tr_b16 v[166:167], v245 offset:512
    v_mfma_f32_16x16x32_bf16 v[100:103], v[36:39], v[24:27], 0
    ds_read_b64_tr_b16 v[188:189], v245 offset:4096
    ds_read_b64_tr_b16 v[190:191], v245 offset:4608
    v_mfma_f32_16x16x32_bf16 v[100:103], v[60:63], v[48:51], v[100:103]
    v_add_u32 v242, s66, v254
    v_xor_b32_e64 v243, 64, v242
    v_mfma_f32_16x16x32_bf16 v[92:95], v[36:39], v[20:23], 0
    v_add_u32 v244, s67, v255
    v_xor_b32 v245, 32, v244
    s_add_u32 s66, s66, 16384
    s_and_b32 s66, s66, 0xffff
    v_mfma_f32_16x16x32_bf16 v[92:95], v[60:63], v[44:47], v[92:95]
    s_add_u32 s67, s67, 8192
    s_cmp_eq_u32 s67, 81920
    s_cselect_b32 s67, 0, s67
    v_mfma_f32_16x16x32_bf16 v[84:87], v[36:39], v[16:19], 0
    v_mfma_f32_16x16x32_bf16 v[84:87], v[60:63], v[40:43], v[84:87]
    s_waitcnt lgkmcnt(0)
    v_mfma_f32_16x16x32_bf16 v[80:83], v[160:163], v[144:147], v[80:83]
    s_barrier
    v_mfma_f32_16x16x32_bf16 v[80:83], v[184:187], v[168:171], v[80:83]
    ds_read_b64_tr_b16 v[32:33], v244 offset:0
    ds_read_b64_tr_b16 v[34:35], v244 offset:512
    v_mfma_f32_16x16x32_bf16 v[88:91], v[160:163], v[148:151], v[88:91]
    ds_read_b128 v[16:19], v242 offset:0
    ds_read_b64_tr_b16 v[56:57], v244 offset:4096
    v_mfma_f32_16x16x32_bf16 v[88:91], v[184:187], v[172:175], v[88:91]
    ds_read_b64_tr_b16 v[58:59], v244 offset:4608
    ds_read_b128 v[40:43], v243 offset:0
    v_mfma_f32_16x16x32_bf16 v[96:99], v[160:163], v[152:155], v[96:99]
    ds_read_b128 v[20:23], v242 offset:2048
    ds_read_b128 v[44:47], v243 offset:2048
    v_mfma_f32_16x16x32_bf16 v[96:99], v[184:187], v[176:179], v[96:99]
    ds_read_b128 v[24:27], v242 offset:4096
    v_mfma_f32_16x16x32_bf16 v[104:107], v[160:163], v[156:159], v[104:107]
    ds_read_b128 v[48:51], v243 offset:4096
    v_mfma_f32_16x16x32_bf16 v[104:107], v[184:187], v[180:183], v[104:107]
    ds_read_b128 v[28:31], v242 offset:6144
    v_mfma_f32_16x16x32_bf16 v[108:111], v[164:167], v[156:159], v[108:111]
    ds_read_b128 v[52:55], v243 offset:6144
    v_mfma_f32_16x16x32_bf16 v[108:111], v[188:191], v[180:183], v[108:111]
    ds_read_b64_tr_b16 v[36:37], v245 offset:0
    ds_read_b64_tr_b16 v[38:39], v245 offset:512
    v_mfma_f32_16x16x32_bf16 v[100:103], v[164:167], v[152:155], v[100:103]
    ds_read_b64_tr_b16 v[60:61], v245 offset:4096
    ds_read_b64_tr_b16 v[62:63], v245 offset:4608
    v_mfma_f32_16x16x32_bf16 v[100:103], v[188:191], v[176:179], v[100:103]
    v_add_u32 v242, s66, v254
    v_xor_b32_e64 v243, 64, v242
    v_mfma_f32_16x16x32_bf16 v[92:95], v[164:167], v[148:151], v[92:95]
    v_add_u32 v244, s67, v255
    v_xor_b32 v245, 32, v244
    s_add_u32 s66, s66, 16384
    s_and_b32 s66, s66, 0xffff
    v_mfma_f32_16x16x32_bf16 v[92:95], v[188:191], v[172:175], v[92:95]
    s_add_u32 s67, s67, 8192
    s_cmp_eq_u32 s67, 81920
    s_cselect_b32 s67, 0, s67
    v_mfma_f32_16x16x32_bf16 v[84:87], v[164:167], v[144:147], v[84:87]
    v_mfma_f32_16x16x32_bf16 v[84:87], v[188:191], v[168:171], v[84:87]
    s_mov_b32 s68, 6
.p2align 6
.cl_161:
    s_waitcnt lgkmcnt(0)
    v_mfma_f32_16x16x32_bf16 v[80:83], v[32:35], v[16:19], v[80:83]
    s_waitcnt vmcnt(0)
    s_barrier
    v_mfma_f32_16x16x32_bf16 v[80:83], v[56:59], v[40:43], v[80:83]
    ds_read_b64_tr_b16 v[160:161], v244 offset:0
    ds_read_b64_tr_b16 v[162:163], v244 offset:512
    v_mfma_f32_16x16x32_bf16 v[88:91], v[32:35], v[20:23], v[88:91]
    ds_read_b128 v[144:147], v242 offset:0
    ds_read_b64_tr_b16 v[184:185], v244 offset:4096
    v_mfma_f32_16x16x32_bf16 v[88:91], v[56:59], v[44:47], v[88:91]
    ds_read_b64_tr_b16 v[186:187], v244 offset:4608
    ds_read_b128 v[168:171], v243 offset:0
    v_mfma_f32_16x16x32_bf16 v[96:99], v[32:35], v[24:27], v[96:99]
    ds_read_b128 v[148:151], v242 offset:2048
    ds_read_b128 v[172:175], v243 offset:2048
    v_mfma_f32_16x16x32_bf16 v[96:99], v[56:59], v[48:51], v[96:99]
    ds_read_b128 v[152:155], v242 offset:4096
    v_mfma_f32_16x16x32_bf16 v[104:107], v[32:35], v[28:31], v[104:107]
    ds_read_b128 v[176:179], v243 offset:4096
    v_mfma_f32_16x16x32_bf16 v[104:107], v[56:59], v[52:55], v[104:107]
    ds_read_b128 v[156:159], v242 offset:6144
    v_mfma_f32_16x16x32_bf16 v[108:111], v[36:39], v[28:31], v[108:111]
    ds_read_b128 v[180:183], v243 offset:6144
    v_mfma_f32_16x16x32_bf16 v[108:111], v[60:63], v[52:55], v[108:111]
    ds_read_b64_tr_b16 v[164:165], v245 offset:0
    ds_read_b64_tr_b16 v[166:167], v245 offset:512
    v_mfma_f32_16x16x32_bf16 v[100:103], v[36:39], v[24:27], v[100:103]
    ds_read_b64_tr_b16 v[188:189], v245 offset:4096
    ds_read_b64_tr_b16 v[190:191], v245 offset:4608
    v_mfma_f32_16x16x32_bf16 v[100:103], v[60:63], v[48:51], v[100:103]
    v_add_u32 v242, s66, v254
    v_xor_b32_e64 v243, 64, v242
    v_mfma_f32_16x16x32_bf16 v[92:95], v[36:39], v[20:23], v[92:95]
    v_add_u32 v244, s67, v255
    v_xor_b32 v245, 32, v244
    s_add_u32 s66, s66, 16384
    s_and_b32 s66, s66, 0xffff
    v_mfma_f32_16x16x32_bf16 v[92:95], v[60:63], v[44:47], v[92:95]
    s_add_u32 s67, s67, 8192
    s_cmp_eq_u32 s67, 81920
    s_cselect_b32 s67, 0, s67
    v_mfma_f32_16x16x32_bf16 v[84:87], v[36:39], v[16:19], v[84:87]
    v_mfma_f32_16x16x32_bf16 v[84:87], v[60:63], v[40:43], v[84:87]
    s_waitcnt lgkmcnt(0)
    v_mfma_f32_16x16x32_bf16 v[80:83], v[160:163], v[144:147], v[80:83]
    s_waitcnt vmcnt(0)
    s_barrier
    v_mfma_f32_16x16x32_bf16 v[80:83], v[184:187], v[168:171], v[80:83]
    ds_read_b64_tr_b16 v[32:33], v244 offset:0
    ds_read_b64_tr_b16 v[34:35], v244 offset:512
    v_mfma_f32_16x16x32_bf16 v[88:91], v[160:163], v[148:151], v[88:91]
    ds_read_b128 v[16:19], v242 offset:0
    ds_read_b64_tr_b16 v[56:57], v244 offset:4096
    v_mfma_f32_16x16x32_bf16 v[88:91], v[184:187], v[172:175], v[88:91]
    ds_read_b64_tr_b16 v[58:59], v244 offset:4608
    ds_read_b128 v[40:43], v243 offset:0
    v_mfma_f32_16x16x32_bf16 v[96:99], v[160:163], v[152:155], v[96:99]
    ds_read_b128 v[20:23], v242 offset:2048
    ds_read_b128 v[44:47], v243 offset:2048
    v_mfma_f32_16x16x32_bf16 v[96:99], v[184:187], v[176:179], v[96:99]
    ds_read_b128 v[24:27], v242 offset:4096
    v_mfma_f32_16x16x32_bf16 v[104:107], v[160:163], v[156:159], v[104:107]
    ds_read_b128 v[48:51], v243 offset:4096
    v_mfma_f32_16x16x32_bf16 v[104:107], v[184:187], v[180:183], v[104:107]
    ds_read_b128 v[28:31], v242 offset:6144
    v_mfma_f32_16x16x32_bf16 v[108:111], v[164:167], v[156:159], v[108:111]
    ds_read_b128 v[52:55], v243 offset:6144
    v_mfma_f32_16x16x32_bf16 v[108:111], v[188:191], v[180:183], v[108:111]
    ds_read_b64_tr_b16 v[36:37], v245 offset:0
    ds_read_b64_tr_b16 v[38:39], v245 offset:512
    v_mfma_f32_16x16x32_bf16 v[100:103], v[164:167], v[152:155], v[100:103]
    ds_read_b64_tr_b16 v[60:61], v245 offset:4096
    ds_read_b64_tr_b16 v[62:63], v245 offset:4608
    v_mfma_f32_16x16x32_bf16 v[100:103], v[188:191], v[176:179], v[100:103]
    v_add_u32 v242, s66, v254
    v_xor_b32 v243, 64, v242
    v_mfma_f32_16x16x32_bf16 v[92:95], v[164:167], v[148:151], v[92:95]
    v_add_u32 v244, s67, v255
    v_xor_b32 v245, 32, v244
    s_add_u32 s66, s66, 16384
    s_and_b32 s66, s66, 0xffff
    v_mfma_f32_16x16x32_bf16 v[92:95], v[188:191], v[172:175], v[92:95]
    s_add_u32 s67, s67, 8192
    s_cmp_eq_u32 s67, 81920
    s_cselect_b32 s67, 0, s67
    v_mfma_f32_16x16x32_bf16 v[84:87], v[164:167], v[144:147], v[84:87]
    s_sub_u32 s68, s68, 1
    s_cmp_lg_u32 s68, 0
    v_mfma_f32_16x16x32_bf16 v[84:87], v[188:191], v[168:171], v[84:87]
    s_cbranch_scc1 .cl_161
.code_cq:
    s_waitcnt lgkmcnt(0)
    v_mfma_f32_16x16x32_bf16 v[80:83], v[32:35], v[16:19], v[80:83]
    s_barrier
    v_mfma_f32_16x16x32_bf16 v[80:83], v[56:59], v[40:43], v[80:83]
    ds_read_b64_tr_b16 v[160:161], v244 offset:0
    ds_read_b64_tr_b16 v[162:163], v244 offset:512
    v_mfma_f32_16x16x32_bf16 v[88:91], v[32:35], v[20:23], v[88:91]
    ds_read_b128 v[144:147], v242 offset:0
    ds_read_b64_tr_b16 v[184:185], v244 offset:4096
    v_mfma_f32_16x16x32_bf16 v[88:91], v[56:59], v[44:47], v[88:91]
    ds_read_b64_tr_b16 v[186:187], v244 offset:4608
    ds_read_b128 v[168:171], v243 offset:0
    v_mfma_f32_16x16x32_bf16 v[96:99], v[32:35], v[24:27], v[96:99]
    ds_read_b128 v[148:151], v242 offset:2048
    ds_read_b128 v[172:175], v243 offset:2048
    v_mfma_f32_16x16x32_bf16 v[96:99], v[56:59], v[48:51], v[96:99]
    ds_read_b128 v[152:155], v242 offset:4096
    v_mfma_f32_16x16x32_bf16 v[104:107], v[32:35], v[28:31], v[104:107]
    ds_read_b128 v[176:179], v243 offset:4096
    v_mfma_f32_16x16x32_bf16 v[104:107], v[56:59], v[52:55], v[104:107]
    ds_read_b128 v[156:159], v242 offset:6144
    v_mfma_f32_16x16x32_bf16 v[108:111], v[36:39], v[28:31], v[108:111]
    ds_read_b128 v[180:183], v243 offset:6144
    v_mfma_f32_16x16x32_bf16 v[108:111], v[60:63], v[52:55], v[108:111]
    ds_read_b64_tr_b16 v[164:165], v245 offset:0
    ds_read_b64_tr_b16 v[166:167], v245 offset:512
    v_mfma_f32_16x16x32_bf16 v[100:103], v[36:39], v[24:27], v[100:103]
    ds_read_b64_tr_b16 v[188:189], v245 offset:4096
    ds_read_b64_tr_b16 v[190:191], v245 offset:4608
    v_mfma_f32_16x16x32_bf16 v[100:103], v[60:63], v[48:51], v[100:103]
    v_add_u32 v242, s66, v254
    v_xor_b32 v243, 64, v242
    v_mfma_f32_16x16x32_bf16 v[92:95], v[36:39], v[20:23], v[92:95]
    v_add_u32 v244, s67, v255
    v_xor_b32 v245, 32, v244
    s_add_u32 s66, s66, 16384
    s_and_b32 s66, s66, 0xffff
    v_mfma_f32_16x16x32_bf16 v[92:95], v[60:63], v[44:47], v[92:95]
    s_add_u32 s67, s67, 8192
    s_cmp_eq_u32 s67, 81920
    s_cselect_b32 s67, 0, s67
    v_mfma_f32_16x16x32_bf16 v[84:87], v[36:39], v[16:19], v[84:87]
    v_mfma_f32_16x16x32_bf16 v[84:87], v[60:63], v[40:43], v[84:87]
    s_waitcnt lgkmcnt(0)
    v_mfma_f32_16x16x32_bf16 v[80:83], v[160:163], v[144:147], v[80:83]
    s_barrier
    ds_read_b128 v[112:115], v248 offset:512
    v_mfma_f32_16x16x32_bf16 v[80:83], v[184:187], v[168:171], v[80:83]
    ds_read_b128 v[116:119], v248 offset:576
    v_mfma_f32_16x16x32_bf16 v[88:91], v[160:163], v[148:151], v[88:91]
    ds_read_b128 v[120:123], v248 offset:2048
    v_mfma_f32_16x16x32_bf16 v[88:91], v[184:187], v[172:175], v[88:91]
    ds_read_b128 v[124:127], v248 offset:2112
    v_mfma_f32_16x16x32_bf16 v[96:99], v[160:163], v[152:155], v[96:99]
    v_mfma_f32_16x16x32_bf16 v[96:99], v[184:187], v[176:179], v[96:99]
    v_mfma_f32_16x16x32_bf16 v[104:107], v[160:163], v[156:159], v[104:107]
    v_mfma_f32_16x16x32_bf16 v[104:107], v[184:187], v[180:183], v[104:107]
    v_mfma_f32_16x16x32_bf16 v[108:111], v[164:167], v[156:159], v[108:111]
    v_mfma_f32_16x16x32_bf16 v[108:111], v[188:191], v[180:183], v[108:111]
    v_mfma_f32_16x16x32_bf16 v[100:103], v[164:167], v[152:155], v[100:103]
    v_mfma_f32_16x16x32_bf16 v[100:103], v[188:191], v[176:179], v[100:103]
    v_mfma_f32_16x16x32_bf16 v[92:95], v[164:167], v[148:151], v[92:95]
    v_mfma_f32_16x16x32_bf16 v[92:95], v[188:191], v[172:175], v[92:95]
    v_mfma_f32_16x16x32_bf16 v[84:87], v[164:167], v[144:147], v[84:87]
    v_mfma_f32_16x16x32_bf16 v[84:87], v[188:191], v[168:171], v[84:87]
    s_waitcnt lgkmcnt(0)
    v_pk_fma_f32 v[80:81], v[112:113], v[232:233], v[80:81] op_sel:[0,1,0] op_sel_hi:[1,1,1]
    v_pk_fma_f32 v[82:83], v[114:115], v[232:233], v[82:83] op_sel:[0,1,0] op_sel_hi:[1,1,1]
    s_nop 0
    s_nop 4
    v_pk_fma_f32 v[84:85], v[116:117], v[232:233], v[84:85] op_sel:[0,1,0] op_sel_hi:[1,1,1]
    v_pk_fma_f32 v[86:87], v[118:119], v[232:233], v[86:87] op_sel:[0,1,0] op_sel_hi:[1,1,1]
    v_pk_fma_f32 v[88:89], v[112:113], v[234:235], v[88:89] op_sel:[0,1,0] op_sel_hi:[1,1,1]
    v_pk_fma_f32 v[90:91], v[114:115], v[234:235], v[90:91] op_sel:[0,1,0] op_sel_hi:[1,1,1]
    v_pk_fma_f32 v[92:93], v[116:117], v[234:235], v[92:93] op_sel:[0,1,0] op_sel_hi:[1,1,1]
    v_pk_fma_f32 v[94:95], v[118:119], v[234:235], v[94:95] op_sel:[0,1,0] op_sel_hi:[1,1,1]
    v_pk_fma_f32 v[96:97], v[112:113], v[236:237], v[96:97] op_sel:[0,1,0] op_sel_hi:[1,1,1]
    v_pk_fma_f32 v[98:99], v[114:115], v[236:237], v[98:99] op_sel:[0,1,0] op_sel_hi:[1,1,1]
    v_pk_fma_f32 v[100:101], v[116:117], v[236:237], v[100:101] op_sel:[0,1,0] op_sel_hi:[1,1,1]
    v_pk_fma_f32 v[102:103], v[118:119], v[236:237], v[102:103] op_sel:[0,1,0] op_sel_hi:[1,1,1]
    v_pk_fma_f32 v[104:105], v[112:113], v[238:239], v[104:105] op_sel:[0,1,0] op_sel_hi:[1,1,1]
    v_pk_fma_f32 v[106:107], v[114:115], v[238:239], v[106:107] op_sel:[0,1,0] op_sel_hi:[1,1,1]
    v_pk_fma_f32 v[108:109], v[116:117], v[238:239], v[108:109] op_sel:[0,1,0] op_sel_hi:[1,1,1]
    v_pk_fma_f32 v[110:111], v[118:119], v[238:239], v[110:111] op_sel:[0,1,0] op_sel_hi:[1,1,1]
    v_cvt_pk_bf16_f32 v80, v80, v81
    v_cvt_pk_bf16_f32 v81, v82, v83
    v_cvt_pk_bf16_f32 v82, v84, v85
    v_cvt_pk_bf16_f32 v83, v86, v87
    v_cvt_pk_bf16_f32 v88, v88, v89
    v_cvt_pk_bf16_f32 v89, v90, v91
    v_cvt_pk_bf16_f32 v90, v92, v93
    v_cvt_pk_bf16_f32 v91, v94, v95
    v_cvt_pk_bf16_f32 v96, v96, v97
    v_cvt_pk_bf16_f32 v97, v98, v99
    v_cvt_pk_bf16_f32 v98, v100, v101
    v_cvt_pk_bf16_f32 v99, v102, v103
    v_cvt_pk_bf16_f32 v104, v104, v105
    v_cvt_pk_bf16_f32 v105, v106, v107
    v_cvt_pk_bf16_f32 v106, v108, v109
    v_cvt_pk_bf16_f32 v107, v110, v111
    v_mfma_f32_16x16x32_bf16 v[16:19], v[224:227], v[80:83], 0
    v_mfma_f32_16x16x32_bf16 v[20:23], v[228:231], v[80:83], 0
    v_mfma_f32_16x16x32_bf16 v[24:27], v[224:227], v[88:91], 0
    v_mfma_f32_16x16x32_bf16 v[28:31], v[228:231], v[88:91], 0
    v_mfma_f32_16x16x32_bf16 v[32:35], v[224:227], v[96:99], 0
    v_mfma_f32_16x16x32_bf16 v[36:39], v[228:231], v[96:99], 0
    v_mfma_f32_16x16x32_bf16 v[40:43], v[224:227], v[104:107], 0
    v_mfma_f32_16x16x32_bf16 v[44:47], v[228:231], v[104:107], 0
    s_lshl_b32 s28, s64, 17
    s_lshl1_add_u32 s29, s34, s65
    s_lshl_b32 s29, s29, 6
    s_add_u32 s28, s28, s29
    v_lshl_add_u32 v248, v10, 11, s28
    v_lshl_add_u32 v248, v9, 4, v248
    v_and_b32_e64 v2, 1, v11
    v_lshl_add_u32 v248, v2, 5, v248
    s_nop 0
    s_mov_b32 s28, 0
    buffer_load_dwordx4 v[208:211], v248, s[76:79], s28 offen
    s_mov_b32 s28, 32768
    buffer_load_dwordx4 v[212:215], v248, s[76:79], s28 offen
    s_mov_b32 s28, 65536
    buffer_load_dwordx4 v[216:219], v248, s[76:79], s28 offen
    s_mov_b32 s28, 98304
    buffer_load_dwordx4 v[220:223], v248, s[76:79], s28 offen
    s_mul_i32 s28, s33, 16
    s_add_u32 s28, s28, s34
    s_lshl_b32 s28, s28, 14
    s_add_u32 s72, s26, s28
    s_addc_u32 s73, s27, 0
    s_mov_b32 s74, 16384
    s_mov_b32 s75, 0x20000
    s_lshl3_add_u32 s28, s64, s65
    s_lshl_b32 s28, s28, 10
    v_lshl_add_u32 v249, v1, 4, s28
    s_mov_b32 s30, 4096
    s_lshl_b32 s28, s65, 12
    s_add_u32 s28, s28, 151552
    v_lshl_add_u32 v6, v1, 4, s28
    v_max3_f32 v128, v16, v17, v18
    v_max3_f32 v129, -v16, -v17, -v18
    v_max3_f32 v130, v24, v25, v26
    v_max3_f32 v131, -v24, -v25, -v26
    v_max3_f32 v132, v32, v33, v34
    v_max3_f32 v133, -v32, -v33, -v34
    v_max3_f32 v134, v40, v41, v42
    v_max3_f32 v135, -v40, -v41, -v42
    v_max3_f32 v128, v128, v19, v20
    v_max3_f32 v129, v129, -v19, -v20
    v_max3_f32 v130, v130, v27, v28
    v_max3_f32 v131, v131, -v27, -v28
    v_max3_f32 v132, v132, v35, v36
    v_max3_f32 v133, v133, -v35, -v36
    v_max3_f32 v134, v134, v43, v44
    v_max3_f32 v135, v135, -v43, -v44
    v_max3_f32 v128, v128, v21, v22
    v_max3_f32 v129, v129, -v21, -v22
    v_max3_f32 v130, v130, v29, v30
    v_max3_f32 v131, v131, -v29, -v30
    v_max3_f32 v132, v132, v37, v38
    v_max3_f32 v133, v133, -v37, -v38
    v_max3_f32 v134, v134, v45, v46
    v_max3_f32 v135, v135, -v45, -v46
    v_max_f32_e64 v128, v128, v23
    v_max_f32_e64 v129, v129, -v23
    v_max_f32_e64 v130, v130, v31
    v_max_f32_e64 v131, v131, -v31
    v_max_f32_e64 v132, v132, v39
    v_max_f32_e64 v133, v133, -v39
    v_max_f32_e64 v134, v134, v47
    v_max_f32_e64 v135, v135, -v47
    v_permlane32_swap_b32 v128, v129
    v_permlane32_swap_b32 v130, v131
    v_permlane32_swap_b32 v132, v133
    v_permlane32_swap_b32 v134, v135
    v_max_f32 v128, v128, v129
    v_max_f32 v130, v130, v131
    v_max_f32 v132, v132, v133
    v_max_f32 v134, v134, v135
    v_permlane16_swap_b32 v128, v130
    s_nop 0
    v_permlane16_swap_b32 v132, v134
    v_max_f32 v128, v128, v130
    v_max_f32_e64 v132, v132, v134
    v_mul_f32_e64 v128, -v240, v128
    v_mul_f32_e64 v132, -v241, v132
    v_mov_b32 v130, v128
    v_mov_b32 v134, v132
    s_nop 0
    v_permlane16_swap_b32 v128, v130
    v_permlane16_swap_b32 v132, v134
    v_mov_b32 v129, v128
    v_mov_b32 v131, v130
    v_mov_b32 v133, v132
    v_mov_b32 v135, v134
    v_permlane32_swap_b32 v128, v129
    v_permlane32_swap_b32 v130, v131
    v_permlane32_swap_b32 v132, v133
    v_permlane32_swap_b32_e64 v134, v135
    v_pk_fma_f32 v[48:49], v[16:17], v[232:233], v[128:129] op_sel:[0,0,1] op_sel_hi:[1,0,1] neg_lo:[1,0,0] neg_hi:[1,0,0]
    v_pk_fma_f32 v[16:17], v[16:17], v[232:233], v[128:129] op_sel:[0,0,0] op_sel_hi:[1,0,0]
    v_pk_fma_f32 v[50:51], v[18:19], v[232:233], v[128:129] op_sel:[0,0,1] op_sel_hi:[1,0,1] neg_lo:[1,0,0] neg_hi:[1,0,0]
    v_pk_fma_f32 v[18:19], v[18:19], v[232:233], v[128:129] op_sel:[0,0,0] op_sel_hi:[1,0,0]
    v_pk_fma_f32 v[52:53], v[20:21], v[232:233], v[128:129] op_sel:[0,0,1] op_sel_hi:[1,0,1] neg_lo:[1,0,0] neg_hi:[1,0,0]
    v_pk_fma_f32 v[20:21], v[20:21], v[232:233], v[128:129] op_sel:[0,0,0] op_sel_hi:[1,0,0]
    v_pk_fma_f32 v[54:55], v[22:23], v[232:233], v[128:129] op_sel:[0,0,1] op_sel_hi:[1,0,1] neg_lo:[1,0,0] neg_hi:[1,0,0]
    v_pk_fma_f32 v[22:23], v[22:23], v[232:233], v[128:129] op_sel:[0,0,0] op_sel_hi:[1,0,0]
    v_pk_fma_f32 v[56:57], v[24:25], v[234:235], v[130:131] op_sel:[0,0,1] op_sel_hi:[1,0,1] neg_lo:[1,0,0] neg_hi:[1,0,0]
    v_pk_fma_f32 v[24:25], v[24:25], v[234:235], v[130:131] op_sel:[0,0,0] op_sel_hi:[1,0,0]
    v_pk_fma_f32 v[58:59], v[26:27], v[234:235], v[130:131] op_sel:[0,0,1] op_sel_hi:[1,0,1] neg_lo:[1,0,0] neg_hi:[1,0,0]
    v_pk_fma_f32 v[26:27], v[26:27], v[234:235], v[130:131] op_sel:[0,0,0] op_sel_hi:[1,0,0]
    v_pk_fma_f32 v[60:61], v[28:29], v[234:235], v[130:131] op_sel:[0,0,1] op_sel_hi:[1,0,1] neg_lo:[1,0,0] neg_hi:[1,0,0]
    v_pk_fma_f32 v[28:29], v[28:29], v[234:235], v[130:131] op_sel:[0,0,0] op_sel_hi:[1,0,0]
    v_pk_fma_f32 v[62:63], v[30:31], v[234:235], v[130:131] op_sel:[0,0,1] op_sel_hi:[1,0,1] neg_lo:[1,0,0] neg_hi:[1,0,0]
    v_pk_fma_f32 v[30:31], v[30:31], v[234:235], v[130:131] op_sel:[0,0,0] op_sel_hi:[1,0,0]
    v_pk_fma_f32 v[64:65], v[32:33], v[236:237], v[132:133] op_sel:[0,0,1] op_sel_hi:[1,0,1] neg_lo:[1,0,0] neg_hi:[1,0,0]
    v_pk_fma_f32 v[32:33], v[32:33], v[236:237], v[132:133] op_sel:[0,0,0] op_sel_hi:[1,0,0]
    v_pk_fma_f32 v[66:67], v[34:35], v[236:237], v[132:133] op_sel:[0,0,1] op_sel_hi:[1,0,1] neg_lo:[1,0,0] neg_hi:[1,0,0]
    v_pk_fma_f32 v[34:35], v[34:35], v[236:237], v[132:133] op_sel:[0,0,0] op_sel_hi:[1,0,0]
    v_pk_fma_f32 v[68:69], v[36:37], v[236:237], v[132:133] op_sel:[0,0,1] op_sel_hi:[1,0,1] neg_lo:[1,0,0] neg_hi:[1,0,0]
    v_pk_fma_f32 v[36:37], v[36:37], v[236:237], v[132:133] op_sel:[0,0,0] op_sel_hi:[1,0,0]
    v_pk_fma_f32 v[70:71], v[38:39], v[236:237], v[132:133] op_sel:[0,0,1] op_sel_hi:[1,0,1] neg_lo:[1,0,0] neg_hi:[1,0,0]
    v_pk_fma_f32 v[38:39], v[38:39], v[236:237], v[132:133] op_sel:[0,0,0] op_sel_hi:[1,0,0]
    v_pk_fma_f32 v[72:73], v[40:41], v[238:239], v[134:135] op_sel:[0,0,1] op_sel_hi:[1,0,1] neg_lo:[1,0,0] neg_hi:[1,0,0]
    v_pk_fma_f32 v[40:41], v[40:41], v[238:239], v[134:135] op_sel:[0,0,0] op_sel_hi:[1,0,0]
    v_pk_fma_f32 v[74:75], v[42:43], v[238:239], v[134:135] op_sel:[0,0,1] op_sel_hi:[1,0,1] neg_lo:[1,0,0] neg_hi:[1,0,0]
    v_pk_fma_f32 v[42:43], v[42:43], v[238:239], v[134:135] op_sel:[0,0,0] op_sel_hi:[1,0,0]
    v_pk_fma_f32 v[76:77], v[44:45], v[238:239], v[134:135] op_sel:[0,0,1] op_sel_hi:[1,0,1] neg_lo:[1,0,0] neg_hi:[1,0,0]
    v_pk_fma_f32 v[44:45], v[44:45], v[238:239], v[134:135] op_sel:[0,0,0] op_sel_hi:[1,0,0]
    v_pk_fma_f32 v[78:79], v[46:47], v[238:239], v[134:135] op_sel:[0,0,1] op_sel_hi:[1,0,1] neg_lo:[1,0,0] neg_hi:[1,0,0]
    v_pk_fma_f32 v[46:47], v[46:47], v[238:239], v[134:135] op_sel:[0,0,0] op_sel_hi:[1,0,0]
    v_exp_f32 v48, v48
    v_exp_f32 v16, v16
    v_exp_f32 v49, v49
    v_exp_f32 v17, v17
    v_exp_f32 v50, v50
    v_exp_f32 v18, v18
    v_exp_f32 v51, v51
    v_exp_f32 v19, v19
    v_exp_f32 v52, v52
    v_exp_f32 v20, v20
    v_exp_f32 v53, v53
    v_exp_f32 v21, v21
    v_exp_f32 v54, v54
    v_exp_f32 v22, v22
    v_exp_f32 v55, v55
    v_exp_f32 v23, v23
    v_exp_f32 v56, v56
    v_exp_f32 v24, v24
    v_exp_f32 v57, v57
    v_exp_f32 v25, v25
    v_exp_f32 v58, v58
    v_exp_f32 v26, v26
    v_exp_f32 v59, v59
    v_exp_f32 v27, v27
    v_exp_f32 v60, v60
    v_exp_f32 v28, v28
    v_exp_f32 v61, v61
    v_exp_f32 v29, v29
    v_exp_f32 v62, v62
    v_exp_f32 v30, v30
    v_exp_f32 v63, v63
    v_exp_f32 v31, v31
    v_exp_f32 v64, v64
    v_exp_f32 v32, v32
    v_exp_f32 v65, v65
    v_exp_f32 v33, v33
    v_exp_f32 v66, v66
    v_exp_f32 v34, v34
    v_exp_f32 v67, v67
    v_exp_f32 v35, v35
    v_exp_f32 v68, v68
    v_exp_f32 v36, v36
    v_exp_f32 v69, v69
    v_exp_f32 v37, v37
    v_exp_f32 v70, v70
    v_exp_f32 v38, v38
    v_exp_f32 v71, v71
    v_exp_f32 v39, v39
    v_exp_f32 v72, v72
    v_exp_f32 v40, v40
    v_exp_f32 v73, v73
    v_exp_f32 v41, v41
    v_exp_f32 v74, v74
    v_exp_f32 v42, v42
    v_exp_f32 v75, v75
    v_exp_f32 v43, v43
    v_exp_f32 v76, v76
    v_exp_f32 v44, v44
    v_exp_f32 v77, v77
    v_exp_f32 v45, v45
    v_exp_f32 v78, v78
    v_exp_f32 v46, v46
    v_exp_f32 v79, v79
    v_exp_f32 v47, v47
    v_cvt_pk_bf16_f32 v80, v16, v17
    v_cvt_pk_bf16_f32 v81, v18, v19
    v_cvt_pk_bf16_f32 v82, v20, v21
    v_cvt_pk_bf16_f32 v83, v22, v23
    v_cvt_pk_bf16_f32 v84, v48, v49
    v_cvt_pk_bf16_f32 v85, v50, v51
    v_cvt_pk_bf16_f32 v86, v52, v53
    v_cvt_pk_bf16_f32 v87, v54, v55
    v_mfma_f32_16x16x32_bf16 v[144:147], v[12:15], v[80:83], 0
    v_mfma_f32_16x16x32_bf16 v[176:179], v[120:123], v[80:83], 0
    v_mfma_f32_16x16x32_bf16 v[148:151], v[12:15], v[84:87], 0
    v_mfma_f32_16x16x32_bf16 v[180:183], v[124:127], v[84:87], 0
    v_cvt_pk_bf16_f32 v88, v24, v25
    v_cvt_pk_bf16_f32 v89, v26, v27
    v_cvt_pk_bf16_f32 v90, v28, v29
    v_cvt_pk_bf16_f32 v91, v30, v31
    v_cvt_pk_bf16_f32 v92, v56, v57
    v_cvt_pk_bf16_f32 v93, v58, v59
    v_cvt_pk_bf16_f32 v94, v60, v61
    v_cvt_pk_bf16_f32 v95, v62, v63
    v_mfma_f32_16x16x32_bf16 v[152:155], v[12:15], v[88:91], 0
    s_branch .pg_3
.p2align 12
.pad_3:
    s_nop 0
    s_setpc_b64 s[44:45]
.pg_3:
    v_mfma_f32_16x16x32_bf16 v[184:187], v[120:123], v[88:91], 0
    v_mfma_f32_16x16x32_bf16 v[156:159], v[12:15], v[92:95], 0
    v_mfma_f32_16x16x32_bf16 v[188:191], v[124:127], v[92:95], 0
    v_cvt_pk_bf16_f32 v96, v32, v33
    v_cvt_pk_bf16_f32 v97, v34, v35
    v_cvt_pk_bf16_f32 v98, v36, v37
    v_cvt_pk_bf16_f32 v99, v38, v39
    v_cvt_pk_bf16_f32 v100, v64, v65
    v_cvt_pk_bf16_f32 v101, v66, v67
    v_cvt_pk_bf16_f32 v102, v68, v69
    v_cvt_pk_bf16_f32 v103, v70, v71
    v_mfma_f32_16x16x32_bf16 v[160:163], v[12:15], v[96:99], 0
    v_mfma_f32_16x16x32_bf16 v[192:195], v[120:123], v[96:99], 0
    v_mfma_f32_16x16x32_bf16 v[164:167], v[12:15], v[100:103], 0
    v_mfma_f32_16x16x32_bf16 v[196:199], v[124:127], v[100:103], 0
    v_cvt_pk_bf16_f32 v104, v40, v41
    v_cvt_pk_bf16_f32 v105, v42, v43
    v_cvt_pk_bf16_f32 v106, v44, v45
    v_cvt_pk_bf16_f32 v107, v46, v47
    v_cvt_pk_bf16_f32 v108, v72, v73
    v_cvt_pk_bf16_f32 v109, v74, v75
    v_cvt_pk_bf16_f32 v110, v76, v77
    v_cvt_pk_bf16_f32 v111, v78, v79
    v_mfma_f32_16x16x32_bf16 v[168:171], v[12:15], v[104:107], 0
    v_mfma_f32_16x16x32_bf16 v[200:203], v[120:123], v[104:107], 0
    v_mfma_f32_16x16x32_bf16 v[172:175], v[12:15], v[108:111], 0
    v_mfma_f32_16x16x32_bf16 v[204:207], v[124:127], v[108:111], 0
    v_rcp_f32 v128, v144
    v_rcp_f32 v129, v148
    v_rcp_f32 v130, v152
    v_rcp_f32 v131, v156
    v_rcp_f32 v132, v160
    v_rcp_f32 v133, v164
    v_rcp_f32 v134, v168
    v_rcp_f32 v135, v172
    v_fmaak_f32 v176, v176, v128, 0x358637bd
    v_fmaak_f32 v184, v184, v130, 0x358637bd
    v_fmaak_f32 v192, v192, v132, 0x358637bd
    v_fmaak_f32 v200, v200, v134, 0x358637bd
    v_fmac_f32 v176, v180, v129
    v_fmac_f32 v184, v188, v131
    v_fmac_f32 v192, v196, v133
    v_fmac_f32 v200, v204, v135
    v_rcp_f32 v176, v176
    v_rcp_f32 v184, v184
    v_rcp_f32 v192, v192
    v_rcp_f32 v200, v200
    v_pk_mul_f32 v[128:129], v[128:129], v[176:177] op_sel_hi:[1,0]
    v_pk_mul_f32 v[130:131], v[130:131], v[184:185] op_sel_hi:[1,0]
    v_pk_mul_f32 v[132:133], v[132:133], v[192:193] op_sel_hi:[1,0]
    v_pk_mul_f32 v[134:135], v[134:135], v[200:201] op_sel_hi:[1,0]
    s_barrier
    ds_read_b128 v[112:115], v6 offset:0
    ds_read_b128 v[116:119], v6 offset:1024
    ds_read_b128 v[120:123], v6 offset:2048
    ds_read_b128 v[124:127], v6 offset:3072
    s_waitcnt lgkmcnt(0)
    v_mfma_f32_16x16x32_bf16 v[16:19], v[112:115], v[80:83], 0
    v_mfma_f32_16x16x32_bf16 v[20:23], v[116:119], v[80:83], 0
    v_mfma_f32_16x16x32_bf16 v[24:27], v[120:123], v[84:87], 0
    v_mfma_f32_16x16x32_bf16 v[28:31], v[124:127], v[84:87], 0
    v_mfma_f32_16x16x32_bf16 v[32:35], v[112:115], v[88:91], 0
    v_mfma_f32_16x16x32_bf16 v[36:39], v[116:119], v[88:91], 0
    v_mfma_f32_16x16x32_bf16 v[40:43], v[120:123], v[92:95], 0
    v_mfma_f32_16x16x32_bf16 v[44:47], v[124:127], v[92:95], 0
    v_mfma_f32_16x16x32_bf16 v[48:51], v[112:115], v[96:99], 0
    v_mfma_f32_16x16x32_bf16 v[52:55], v[116:119], v[96:99], 0
    v_mfma_f32_16x16x32_bf16 v[56:59], v[120:123], v[100:103], 0
    v_mfma_f32_16x16x32_bf16 v[60:63], v[124:127], v[100:103], 0
    v_mfma_f32_16x16x32_bf16 v[64:67], v[112:115], v[104:107], 0
    v_mfma_f32_16x16x32_bf16 v[68:71], v[116:119], v[104:107], 0
    v_mfma_f32_16x16x32_bf16 v[72:75], v[120:123], v[108:111], 0
    v_mfma_f32_16x16x32_bf16 v[76:79], v[124:127], v[108:111], 0
    v_pk_mul_f32 v[16:17], v[16:17], v[128:129] op_sel_hi:[1,0]
    v_pk_mul_f32 v[18:19], v[18:19], v[128:129] op_sel_hi:[1,0]
    v_pk_mul_f32 v[20:21], v[20:21], v[128:129] op_sel_hi:[1,0]
    v_pk_mul_f32 v[22:23], v[22:23], v[128:129] op_sel_hi:[1,0]
    v_pk_fma_f32 v[16:17], v[24:25], v[128:129], v[16:17] op_sel:[0,1,0] op_sel_hi:[1,1,1]
    v_pk_fma_f32 v[18:19], v[26:27], v[128:129], v[18:19] op_sel:[0,1,0] op_sel_hi:[1,1,1]
    v_pk_fma_f32 v[20:21], v[28:29], v[128:129], v[20:21] op_sel:[0,1,0] op_sel_hi:[1,1,1]
    v_pk_fma_f32 v[22:23], v[30:31], v[128:129], v[22:23] op_sel:[0,1,0] op_sel_hi:[1,1,1]
    v_cvt_pk_bf16_f32 v16, v16, v17
    v_cvt_pk_bf16_f32 v17, v18, v19
    v_cvt_pk_bf16_f32 v18, v20, v21
    v_cvt_pk_bf16_f32 v19, v22, v23
    buffer_store_dwordx4 v[16:19], v249, s[72:75], 0 offen offset:0 sc1
    v_pk_mul_f32 v[32:33], v[32:33], v[130:131] op_sel_hi:[1,0]
    v_pk_mul_f32 v[34:35], v[34:35], v[130:131] op_sel_hi:[1,0]
    v_pk_mul_f32 v[36:37], v[36:37], v[130:131] op_sel_hi:[1,0]
    v_pk_mul_f32 v[38:39], v[38:39], v[130:131] op_sel_hi:[1,0]
    v_pk_fma_f32 v[32:33], v[40:41], v[130:131], v[32:33] op_sel:[0,1,0] op_sel_hi:[1,1,1]
    v_pk_fma_f32 v[34:35], v[42:43], v[130:131], v[34:35] op_sel:[0,1,0] op_sel_hi:[1,1,1]
    v_pk_fma_f32 v[36:37], v[44:45], v[130:131], v[36:37] op_sel:[0,1,0] op_sel_hi:[1,1,1]
    v_pk_fma_f32 v[38:39], v[46:47], v[130:131], v[38:39] op_sel:[0,1,0] op_sel_hi:[1,1,1]
    v_cvt_pk_bf16_f32 v32, v32, v33
    v_cvt_pk_bf16_f32 v33, v34, v35
    v_cvt_pk_bf16_f32 v34, v36, v37
    v_cvt_pk_bf16_f32 v35, v38, v39
    buffer_store_dwordx4 v[32:35], v249, s[72:75], 0 offen offset:2048 sc1
    v_pk_mul_f32 v[48:49], v[48:49], v[132:133] op_sel_hi:[1,0]
    v_pk_mul_f32 v[50:51], v[50:51], v[132:133] op_sel_hi:[1,0]
    v_pk_mul_f32 v[52:53], v[52:53], v[132:133] op_sel_hi:[1,0]
    v_pk_mul_f32 v[54:55], v[54:55], v[132:133] op_sel_hi:[1,0]
    v_pk_fma_f32 v[48:49], v[56:57], v[132:133], v[48:49] op_sel:[0,1,0] op_sel_hi:[1,1,1]
    v_pk_fma_f32 v[50:51], v[58:59], v[132:133], v[50:51] op_sel:[0,1,0] op_sel_hi:[1,1,1]
    v_pk_fma_f32 v[52:53], v[60:61], v[132:133], v[52:53] op_sel:[0,1,0] op_sel_hi:[1,1,1]
    v_pk_fma_f32 v[54:55], v[62:63], v[132:133], v[54:55] op_sel:[0,1,0] op_sel_hi:[1,1,1]
    v_cvt_pk_bf16_f32 v48, v48, v49
    v_cvt_pk_bf16_f32 v49, v50, v51
    v_cvt_pk_bf16_f32 v50, v52, v53
    v_cvt_pk_bf16_f32 v51, v54, v55
    buffer_store_dwordx4 v[48:51], v249, s[72:75], s30 offen offset:0 sc1
    v_pk_mul_f32 v[64:65], v[64:65], v[134:135] op_sel_hi:[1,0]
    v_pk_mul_f32 v[66:67], v[66:67], v[134:135] op_sel_hi:[1,0]
    v_pk_mul_f32 v[68:69], v[68:69], v[134:135] op_sel_hi:[1,0]
    v_pk_mul_f32 v[70:71], v[70:71], v[134:135] op_sel_hi:[1,0]
    v_pk_fma_f32 v[64:65], v[72:73], v[134:135], v[64:65] op_sel:[0,1,0] op_sel_hi:[1,1,1]
    v_pk_fma_f32 v[66:67], v[74:75], v[134:135], v[66:67] op_sel:[0,1,0] op_sel_hi:[1,1,1]
    v_pk_fma_f32 v[68:69], v[76:77], v[134:135], v[68:69] op_sel:[0,1,0] op_sel_hi:[1,1,1]
    v_pk_fma_f32 v[70:71], v[78:79], v[134:135], v[70:71] op_sel:[0,1,0] op_sel_hi:[1,1,1]
    v_cvt_pk_bf16_f32 v64, v64, v65
    v_cvt_pk_bf16_f32 v65, v66, v67
    v_cvt_pk_bf16_f32 v66, v68, v69
    v_cvt_pk_bf16_f32 v67, v70, v71
    buffer_store_dwordx4 v[64:67], v249, s[72:75], s30 offen offset:2048 sc1
    s_waitcnt vmcnt(0)
    s_barrier
    s_cmp_lg_u32 s32, 0
    s_cbranch_scc1 .ho_163
    s_lshl_b32 s28, s33, 11
    s_atomic_add s40, s[52:53], s28 offset:32768
    s_atomic_add s40, s[52:53], s28 offset:32896
    s_atomic_add s40, s[52:53], s28 offset:33024
    s_atomic_add s40, s[52:53], s28 offset:33152
.ho_163:
    s_lshl_b32 s28, s64, 13
    v_lshl_add_u32 v242, v1, 4, s28
    v_lshrrev_b32_e64 v4, 2, v10
    v_lshl_add_u32 v4, v11, 2, v4
    v_bfe_u32 v5, v4, 1, 2
    v_lshlrev_b32_e64 v4, 7, v4
    v_lshl_add_u32 v4, v5, 5, v4
    v_and_b32_e64 v5, 3, v1
    v_lshl_add_u32 v4, v5, 3, v4
    s_lshl_b32 s28, s65, 6
    v_xor_b32 v4, s28, v4
    v_add_u32 v246, 65536, v4
    v_xor_b32 v247, 32, v246
    v_mov_b32 v254, v242
    v_mov_b32 v255, v246
    s_mov_b32 s66, 0
    s_mov_b32 s67, 0
    v_permlane16_swap_b32 v208, v210
    v_permlane16_swap_b32 v209, v211
    v_permlane16_swap_b32 v212, v214
    v_permlane16_swap_b32 v213, v215
    v_permlane16_swap_b32 v216, v218
    v_permlane16_swap_b32 v217, v219
    v_permlane16_swap_b32 v220, v222
    v_permlane16_swap_b32 v221, v223
    v_lshlrev_b32 v80, 16, v208
    v_and_b32 v81, 0xffff0000, v208
    v_lshlrev_b32_e64 v82, 16, v209
    v_and_b32 v83, 0xffff0000, v209
    v_lshlrev_b32_e64 v84, 16, v210
    v_and_b32 v85, 0xffff0000, v210
    v_lshlrev_b32_e64 v86, 16, v211
    v_and_b32 v87, 0xffff0000, v211
    v_lshlrev_b32_e64 v88, 16, v212
    v_and_b32 v89, 0xffff0000, v212
    v_lshlrev_b32_e64 v90, 16, v213
    v_and_b32 v91, 0xffff0000, v213
    v_lshlrev_b32_e64 v92, 16, v214
    v_and_b32 v93, 0xffff0000, v214
    v_lshlrev_b32_e64 v94, 16, v215
    v_and_b32 v95, 0xffff0000, v215
    v_lshlrev_b32_e64 v96, 16, v216
    v_and_b32 v97, 0xffff0000, v216
    v_lshlrev_b32_e64 v98, 16, v217
    v_and_b32 v99, 0xffff0000, v217
    v_lshlrev_b32_e64 v100, 16, v218
    v_and_b32 v101, 0xffff0000, v218
    v_lshlrev_b32_e64 v102, 16, v219
    v_and_b32 v103, 0xffff0000, v219
    v_lshlrev_b32_e64 v104, 16, v220
    v_and_b32 v105, 0xffff0000, v220
    v_lshlrev_b32_e64 v106, 16, v221
    v_and_b32 v107, 0xffff0000, v221
    v_lshlrev_b32_e64 v108, 16, v222
    v_and_b32 v109, 0xffff0000, v222
    v_lshlrev_b32_e64 v110, 16, v223
    v_and_b32 v111, 0xffff0000, v223
    s_mul_i32 s28, s33, 16
    s_add_u32 s28, s28, s34
    s_lshl_b32 s28, s28, 14
    s_add_u32 s74, s28, 4194304
    s_add_u32 s72, s26, s74
    s_addc_u32 s73, s27, 0
    s_mov_b32 s74, 16384
    s_mov_b32 s75, 0x20000
    s_mov_b32 s30, 4096
    s_cmp_lg_u32 s32, 0
    s_cbranch_scc1 .wn_165
    s_call_b64 s[44:45], .pad_4
    s_call_b64 s[44:45], .pad_10
    s_nop 0
    s_branch .wu_164
.wn_165:
    s_cmp_lg_u32 s32, 1
    s_cbranch_scc1 .wn_166
    s_call_b64 s[44:45], .pad_5
    s_call_b64 s[44:45], .pad_11
    s_nop 0
    s_branch .wu_164
.wn_166:
    s_cmp_lg_u32 s32, 2
    s_cbranch_scc1 .wn_167
    s_call_b64 s[44:45], .pad_6
    s_call_b64 s[44:45], .pad_16
    s_nop 0
    s_branch .wu_164
.wn_167:
    s_call_b64 s[44:45], .pad_7
    s_call_b64 s[44:45], .pad_17
    s_nop 0
.wu_164:
    s_waitcnt lgkmcnt(0)
    s_barrier
    ds_read_b64_tr_b16 v[32:33], v246 offset:0
    ds_read_b64_tr_b16 v[34:35], v246 offset:2048
    ds_read_b128 v[16:19], v242 offset:0
    ds_read_b64_tr_b16 v[56:57], v246 offset:4096
    ds_read_b64_tr_b16 v[58:59], v246 offset:6144
    ds_read_b128 v[40:43], v242 offset:1024
    ds_read_b128 v[20:23], v242 offset:2048
    ds_read_b128 v[44:47], v242 offset:3072
    ds_read_b128 v[24:27], v242 offset:4096
    ds_read_b128 v[48:51], v242 offset:5120
    ds_read_b128 v[28:31], v242 offset:6144
    ds_read_b128 v[52:55], v242 offset:7168
    ds_read_b64_tr_b16 v[36:37], v247 offset:0
    ds_read_b64_tr_b16 v[38:39], v247 offset:2048
    ds_read_b64_tr_b16 v[60:61], v247 offset:4096
    ds_read_b64_tr_b16 v[62:63], v247 offset:6144
    s_add_u32 s66, s66, 16384
    s_and_b32 s66, s66, 0xffff
    s_add_u32 s67, s67, 8192
    s_cmp_eq_u32 s67, 81920
    s_cselect_b32 s67, 0, s67
    v_add_u32 v242, s66, v254
    v_add_u32 v246, s67, v255
    v_xor_b32 v247, 32, v246
    s_add_u32 s66, s66, 16384
    s_and_b32 s66, s66, 0xffff
    s_add_u32 s67, s67, 8192
    s_cmp_eq_u32 s67, 81920
    s_cselect_b32 s67, 0, s67
    s_mov_b32 s68, 7
.p2align 6
.cl_169:
    s_waitcnt lgkmcnt(0)
    v_mfma_f32_16x16x32_bf16 v[80:83], v[32:35], v[16:19], v[80:83]
    s_barrier
    v_mfma_f32_16x16x32_bf16 v[80:83], v[56:59], v[40:43], v[80:83]
    ds_read_b64_tr_b16 v[160:161], v246 offset:0
    ds_read_b64_tr_b16 v[162:163], v246 offset:2048
    v_mfma_f32_16x16x32_bf16 v[88:91], v[32:35], v[20:23], v[88:91]
    ds_read_b128 v[144:147], v242 offset:0
    ds_read_b64_tr_b16 v[184:185], v246 offset:4096
    v_mfma_f32_16x16x32_bf16 v[88:91], v[56:59], v[44:47], v[88:91]
    ds_read_b64_tr_b16 v[186:187], v246 offset:6144
    ds_read_b128 v[168:171], v242 offset:1024
    v_mfma_f32_16x16x32_bf16 v[96:99], v[32:35], v[24:27], v[96:99]
    ds_read_b128 v[148:151], v242 offset:2048
    ds_read_b128 v[172:175], v242 offset:3072
    v_mfma_f32_16x16x32_bf16 v[96:99], v[56:59], v[48:51], v[96:99]
    ds_read_b128 v[152:155], v242 offset:4096
    v_mfma_f32_16x16x32_bf16 v[104:107], v[32:35], v[28:31], v[104:107]
    ds_read_b128 v[176:179], v242 offset:5120
    v_mfma_f32_16x16x32_bf16 v[104:107], v[56:59], v[52:55], v[104:107]
    ds_read_b128 v[156:159], v242 offset:6144
    v_mfma_f32_16x16x32_bf16 v[108:111], v[36:39], v[28:31], v[108:111]
    ds_read_b128 v[180:183], v242 offset:7168
    v_mfma_f32_16x16x32_bf16 v[108:111], v[60:63], v[52:55], v[108:111]
    ds_read_b64_tr_b16 v[164:165], v247 offset:0
    ds_read_b64_tr_b16 v[166:167], v247 offset:2048
    v_mfma_f32_16x16x32_bf16 v[100:103], v[36:39], v[24:27], v[100:103]
    ds_read_b64_tr_b16 v[188:189], v247 offset:4096
    ds_read_b64_tr_b16 v[190:191], v247 offset:6144
    v_mfma_f32_16x16x32_bf16 v[100:103], v[60:63], v[48:51], v[100:103]
    v_add_u32 v242, s66, v254
    v_add_u32 v246, s67, v255
    v_mfma_f32_16x16x32_bf16 v[92:95], v[36:39], v[20:23], v[92:95]
    v_xor_b32_e64 v247, 32, v246
    s_add_u32 s66, s66, 16384
    s_and_b32 s66, s66, 0xffff
    s_add_u32 s67, s67, 8192
    v_mfma_f32_16x16x32_bf16 v[92:95], v[60:63], v[44:47], v[92:95]
    s_cmp_eq_u32 s67, 81920
    s_cselect_b32 s67, 0, s67
    v_mfma_f32_16x16x32_bf16 v[84:87], v[36:39], v[16:19], v[84:87]
    v_mfma_f32_16x16x32_bf16 v[84:87], v[60:63], v[40:43], v[84:87]
    s_waitcnt lgkmcnt(0)
    v_mfma_f32_16x16x32_bf16 v[80:83], v[160:163], v[144:147], v[80:83]
    s_barrier
    v_mfma_f32_16x16x32_bf16 v[80:83], v[184:187], v[168:171], v[80:83]
    ds_read_b64_tr_b16 v[32:33], v246 offset:0
    ds_read_b64_tr_b16 v[34:35], v246 offset:2048
    v_mfma_f32_16x16x32_bf16 v[88:91], v[160:163], v[148:151], v[88:91]
    ds_read_b128 v[16:19], v242 offset:0
    ds_read_b64_tr_b16 v[56:57], v246 offset:4096
    v_mfma_f32_16x16x32_bf16 v[88:91], v[184:187], v[172:175], v[88:91]
    ds_read_b64_tr_b16 v[58:59], v246 offset:6144
    ds_read_b128 v[40:43], v242 offset:1024
    v_mfma_f32_16x16x32_bf16 v[96:99], v[160:163], v[152:155], v[96:99]
    ds_read_b128 v[20:23], v242 offset:2048
    ds_read_b128 v[44:47], v242 offset:3072
    v_mfma_f32_16x16x32_bf16 v[96:99], v[184:187], v[176:179], v[96:99]
    ds_read_b128 v[24:27], v242 offset:4096
    v_mfma_f32_16x16x32_bf16 v[104:107], v[160:163], v[156:159], v[104:107]
    ds_read_b128 v[48:51], v242 offset:5120
    v_mfma_f32_16x16x32_bf16 v[104:107], v[184:187], v[180:183], v[104:107]
    ds_read_b128 v[28:31], v242 offset:6144
    v_mfma_f32_16x16x32_bf16 v[108:111], v[164:167], v[156:159], v[108:111]
    ds_read_b128 v[52:55], v242 offset:7168
    v_mfma_f32_16x16x32_bf16 v[108:111], v[188:191], v[180:183], v[108:111]
    ds_read_b64_tr_b16 v[36:37], v247 offset:0
    ds_read_b64_tr_b16 v[38:39], v247 offset:2048
    v_mfma_f32_16x16x32_bf16 v[100:103], v[164:167], v[152:155], v[100:103]
    ds_read_b64_tr_b16 v[60:61], v247 offset:4096
    ds_read_b64_tr_b16 v[62:63], v247 offset:6144
    v_mfma_f32_16x16x32_bf16 v[100:103], v[188:191], v[176:179], v[100:103]
    v_add_u32 v242, s66, v254
    v_add_u32_e64 v246, s67, v255
    v_mfma_f32_16x16x32_bf16 v[92:95], v[164:167], v[148:151], v[92:95]
    v_xor_b32_e64 v247, 32, v246
    s_add_u32 s66, s66, 16384
    s_and_b32 s66, s66, 0xffff
    s_add_u32 s67, s67, 8192
    v_mfma_f32_16x16x32_bf16 v[92:95], v[188:191], v[172:175], v[92:95]
    s_cmp_eq_u32 s67, 81920
    s_cselect_b32 s67, 0, s67
    v_mfma_f32_16x16x32_bf16 v[84:87], v[164:167], v[144:147], v[84:87]
    s_sub_u32 s68, s68, 1
    s_cmp_lg_u32 s68, 0
    v_mfma_f32_16x16x32_bf16 v[84:87], v[188:191], v[168:171], v[84:87]
    s_cbranch_scc1 .cl_169
    s_waitcnt lgkmcnt(0)
    v_mfma_f32_16x16x32_bf16 v[80:83], v[32:35], v[16:19], v[80:83]
    s_barrier
    v_mfma_f32_16x16x32_bf16 v[80:83], v[56:59], v[40:43], v[80:83]
    ds_read_b64_tr_b16 v[160:161], v246 offset:0
    ds_read_b64_tr_b16 v[162:163], v246 offset:2048
    v_mfma_f32_16x16x32_bf16 v[88:91], v[32:35], v[20:23], v[88:91]
    ds_read_b128 v[144:147], v242 offset:0
    ds_read_b64_tr_b16 v[184:185], v246 offset:4096
    v_mfma_f32_16x16x32_bf16 v[88:91], v[56:59], v[44:47], v[88:91]
    ds_read_b64_tr_b16 v[186:187], v246 offset:6144
    ds_read_b128 v[168:171], v242 offset:1024
    v_mfma_f32_16x16x32_bf16 v[96:99], v[32:35], v[24:27], v[96:99]
    ds_read_b128 v[148:151], v242 offset:2048
    ds_read_b128 v[172:175], v242 offset:3072
    v_mfma_f32_16x16x32_bf16 v[96:99], v[56:59], v[48:51], v[96:99]
    ds_read_b128 v[152:155], v242 offset:4096
    v_mfma_f32_16x16x32_bf16 v[104:107], v[32:35], v[28:31], v[104:107]
    ds_read_b128 v[176:179], v242 offset:5120
    v_mfma_f32_16x16x32_bf16 v[104:107], v[56:59], v[52:55], v[104:107]
    ds_read_b128 v[156:159], v242 offset:6144
    v_mfma_f32_16x16x32_bf16 v[108:111], v[36:39], v[28:31], v[108:111]
    ds_read_b128 v[180:183], v242 offset:7168
    v_mfma_f32_16x16x32_bf16 v[108:111], v[60:63], v[52:55], v[108:111]
    ds_read_b64_tr_b16 v[164:165], v247 offset:0
    ds_read_b64_tr_b16 v[166:167], v247 offset:2048
    v_mfma_f32_16x16x32_bf16 v[100:103], v[36:39], v[24:27], v[100:103]
    ds_read_b64_tr_b16 v[188:189], v247 offset:4096
    ds_read_b64_tr_b16 v[190:191], v247 offset:6144
    v_mfma_f32_16x16x32_bf16 v[100:103], v[60:63], v[48:51], v[100:103]
    v_add_u32 v242, s66, v254
    v_add_u32 v246, s67, v255
    v_mfma_f32_16x16x32_bf16 v[92:95], v[36:39], v[20:23], v[92:95]
    v_xor_b32_e64 v247, 32, v246
    s_add_u32 s66, s66, 16384
    s_and_b32 s66, s66, 0xffff
    s_add_u32 s67, s67, 8192
    v_mfma_f32_16x16x32_bf16 v[92:95], v[60:63], v[44:47], v[92:95]
    s_cmp_eq_u32 s67, 81920
    s_cselect_b32 s67, 0, s67
    v_mfma_f32_16x16x32_bf16 v[84:87], v[36:39], v[16:19], v[84:87]
    v_mfma_f32_16x16x32_bf16 v[84:87], v[60:63], v[40:43], v[84:87]
    s_waitcnt lgkmcnt(0)
    v_mfma_f32_16x16x32_bf16 v[80:83], v[160:163], v[144:147], v[80:83]
    s_barrier
    v_mfma_f32_16x16x32_bf16 v[80:83], v[184:187], v[168:171], v[80:83]
    v_mfma_f32_16x16x32_bf16 v[84:87], v[164:167], v[144:147], v[84:87]
    v_mfma_f32_16x16x32_bf16 v[84:87], v[188:191], v[168:171], v[84:87]
    v_mfma_f32_16x16x32_bf16 v[88:91], v[160:163], v[148:151], v[88:91]
    v_mfma_f32_16x16x32_bf16 v[88:91], v[184:187], v[172:175], v[88:91]
    v_mfma_f32_16x16x32_bf16 v[92:95], v[164:167], v[148:151], v[92:95]
    s_nop 2
    v_cvt_pk_bf16_f32 v208, v80, v81
    v_cvt_pk_bf16_f32 v209, v82, v83
    v_mfma_f32_16x16x32_bf16 v[92:95], v[188:191], v[172:175], v[92:95]
    v_cvt_pk_bf16_f32 v210, v84, v85
    v_cvt_pk_bf16_f32 v211, v86, v87
    v_mfma_f32_16x16x32_bf16 v[96:99], v[160:163], v[152:155], v[96:99]
    buffer_store_dwordx4 v[208:211], v249, s[72:75], 0 offen offset:0 sc1
    v_mfma_f32_16x16x32_bf16 v[96:99], v[184:187], v[176:179], v[96:99]
    v_mfma_f32_16x16x32_bf16 v[100:103], v[164:167], v[152:155], v[100:103]
    v_cvt_pk_bf16_f32 v212, v88, v89
    v_cvt_pk_bf16_f32 v213, v90, v91
    v_mfma_f32_16x16x32_bf16 v[100:103], v[188:191], v[176:179], v[100:103]
    v_cvt_pk_bf16_f32 v214, v92, v93
    v_cvt_pk_bf16_f32 v215, v94, v95
    v_mfma_f32_16x16x32_bf16 v[104:107], v[160:163], v[156:159], v[104:107]
    buffer_store_dwordx4 v[212:215], v249, s[72:75], 0 offen offset:2048 sc1
    v_mfma_f32_16x16x32_bf16 v[104:107], v[184:187], v[180:183], v[104:107]
    v_mfma_f32_16x16x32_bf16 v[108:111], v[164:167], v[156:159], v[108:111]
    v_cvt_pk_bf16_f32 v216, v96, v97
    v_cvt_pk_bf16_f32 v217, v98, v99
    v_mfma_f32_16x16x32_bf16 v[108:111], v[188:191], v[180:183], v[108:111]
    v_cvt_pk_bf16_f32 v218, v100, v101
    v_cvt_pk_bf16_f32 v219, v102, v103
    buffer_store_dwordx4 v[216:219], v249, s[72:75], s30 offen offset:0 sc1
    s_nop 0
    v_cvt_pk_bf16_f32 v220, v104, v105
    v_cvt_pk_bf16_f32 v221, v106, v107
    s_nop 1
    v_cvt_pk_bf16_f32 v222, v108, v109
    v_cvt_pk_bf16_f32 v223, v110, v111
    buffer_store_dwordx4 v[220:223], v249, s[72:75], s30 offen offset:2048 sc1
    v_dot2_f32_bf16 v112, v208, v12, 0
    v_dot2_f32_bf16 v113, v208, v208, 0
    v_dot2_f32_bf16 v114, v212, v12, 0
    v_dot2_f32_bf16 v115, v212, v212, 0
    v_dot2_f32_bf16 v116, v216, v12, 0
    v_dot2_f32_bf16 v117, v216, v216, 0
    v_dot2_f32_bf16 v118, v220, v12, 0
    v_dot2_f32_bf16 v119, v220, v220, 0
    v_dot2_f32_bf16 v112, v209, v12, v112
    v_dot2_f32_bf16 v113, v209, v209, v113
    v_dot2_f32_bf16 v114, v213, v12, v114
    v_dot2_f32_bf16 v115, v213, v213, v115
    v_dot2_f32_bf16 v116, v217, v12, v116
    v_dot2_f32_bf16 v117, v217, v217, v117
    v_dot2_f32_bf16 v118, v221, v12, v118
    v_dot2_f32_bf16 v119, v221, v221, v119
    v_dot2_f32_bf16 v112, v210, v12, v112
    v_dot2_f32_bf16 v113, v210, v210, v113
    v_dot2_f32_bf16 v114, v214, v12, v114
    v_dot2_f32_bf16 v115, v214, v214, v115
    v_dot2_f32_bf16 v116, v218, v12, v116
    v_dot2_f32_bf16 v117, v218, v218, v117
    v_dot2_f32_bf16 v118, v222, v12, v118
    v_dot2_f32_bf16 v119, v222, v222, v119
    v_dot2_f32_bf16 v112, v211, v12, v112
    v_dot2_f32_bf16 v113, v211, v211, v113
    v_dot2_f32_bf16 v114, v215, v12, v114
    v_dot2_f32_bf16 v115, v215, v215, v115
    v_dot2_f32_bf16 v116, v219, v12, v116
    v_dot2_f32_bf16 v117, v219, v219, v117
    v_dot2_f32_bf16 v118, v223, v12, v118
    v_dot2_f32_bf16 v119, v223, v223, v119
    s_lshl2_add_u32 s28, s33, s64
    s_lshl_b32 s28, s28, 8
    v_lshl_add_u32 v120, v8, 2, s28
    v_lshl_add_u32 v120, v9, 9, v120
    v_permlane32_swap_b32 v112, v113
    v_permlane32_swap_b32 v114, v115
    v_permlane32_swap_b32 v116, v117
    v_permlane32_swap_b32 v118, v119
    v_add_f32 v112, v112, v113
    v_add_f32 v114, v114, v115
    v_add_f32 v116, v116, v117
    v_add_f32 v118, v118, v119
    v_permlane16_swap_b32 v112, v114
    s_nop 0
    v_permlane16_swap_b32 v116, v118
    v_add_f32 v112, v112, v114
    v_add_f32_e64 v116, v116, v118
    buffer_atomic_add_f32 v112, v120, s[60:63], 0 offen offset:0 sc1
    buffer_atomic_add_f32 v116, v120, s[60:63], 0 offen offset:128 sc1
    s_waitcnt vmcnt(2)
    s_barrier
    s_cmp_lg_u32 s32, 0
    s_cbranch_scc1 .ho_171
    s_nop 0
    s_lshl_b32 s28, s33, 11
    s_atomic_add s40, s[52:53], s28 offset:65536
    s_atomic_add s40, s[52:53], s28 offset:65664
    s_atomic_add s40, s[52:53], s28 offset:65792
    s_atomic_add s40, s[52:53], s28 offset:65920
.ho_171:
    v_mov_b32 v2, 151040
    v_mov_b32 v3, 1
    s_mov_b64 exec, 1
    s_waitcnt vmcnt(0)
    ds_add_rtn_u32 v4, v2, v3
    s_waitcnt lgkmcnt(0)
    v_readfirstlane_b32 s28, v4
    s_mov_b64 exec, -1
    s_cmp_lg_u32 s28, 3
    s_cbranch_scc1 .arr_173
    s_lshl_b32 s28, s33, 11
    s_atomic_add s40, s[52:53], s28 offset:0
    s_atomic_add s40, s[52:53], s28 offset:128
    s_atomic_add s40, s[52:53], s28 offset:256
    s_atomic_add s40, s[52:53], s28 offset:384
.arr_173:
.nh_172:
    s_cmp_ge_u32 s35, 14
    s_cbranch_scc1 .helper_job
    s_branch .pg_4
.p2align 12
.pad_4:
    s_nop 0
    s_setpc_b64 s[44:45]
.pg_4:
    s_lshl_b32 s28, s64, 13
    v_lshl_add_u32 v242, v1, 4, s28
    v_lshrrev_b32 v4, 2, v10
    v_lshl_add_u32 v4, v11, 2, v4
    v_bfe_u32 v5, v4, 1, 2
    v_lshlrev_b32_e64 v4, 7, v4
    v_lshl_add_u32 v4, v5, 5, v4
    v_and_b32_e64 v5, 3, v1
    v_lshl_add_u32 v4, v5, 3, v4
    s_lshl_b32 s28, s65, 13
    s_add_u32 s28, s28, 65536
    v_add_u32 v244, s28, v4
    v_xor_b32 v245, 32, v244
    v_xor_b32 v246, 64, v244
    v_xor_b32 v247, 96, v244
    v_mov_b32 v254, v242
    v_mov_b32 v255, v244
    s_mov_b32 s66, 0
    s_mov_b32 s67, 0
    s_lshl1_add_u32 s28, s33, s64
    s_lshl_b32 s28, s28, 7
    s_add_u32 s76, s18, s28
    s_addc_u32 s77, s19, 0
    s_mov_b32 s78, 128
    s_mov_b32 s79, 0x20000
    v_lshlrev_b32 v121, 1, v10
    s_lshl_b32 s28, s64, 7
    s_add_u32 s28, s28, 159744
    v_lshl_add_u32 v2, v10, 1, s28
    ds_read_u16 v224, v2 offset:0
    ds_read_u16 v228, v2 offset:32
    ds_read_u16 v240, v2 offset:64
    ds_read_u16 v241, v2 offset:96
    v_mov_b64 v[144:145], 0
    v_mov_b64 v[146:147], 0
    v_mov_b64 v[148:149], 0
    v_mov_b64 v[150:151], 0
    v_mov_b64 v[152:153], 0
    v_mov_b64 v[154:155], 0
    v_mov_b64 v[156:157], 0
    v_mov_b64 v[158:159], 0
    v_mov_b64 v[160:161], 0
    v_mov_b64 v[162:163], 0
    v_mov_b64 v[164:165], 0
    v_mov_b64 v[166:167], 0
    v_mov_b64 v[168:169], 0
    v_mov_b64 v[170:171], 0
    v_mov_b64 v[172:173], 0
    v_mov_b64 v[174:175], 0
    v_mov_b64 v[176:177], 0
    v_mov_b64 v[178:179], 0
    v_mov_b64 v[180:181], 0
    v_mov_b64 v[182:183], 0
    v_mov_b64 v[184:185], 0
    v_mov_b64 v[186:187], 0
    v_mov_b64 v[188:189], 0
    v_mov_b64 v[190:191], 0
    v_mov_b64 v[192:193], 0
    v_mov_b64 v[194:195], 0
    v_mov_b64 v[196:197], 0
    v_mov_b64 v[198:199], 0
    v_mov_b64 v[200:201], 0
    v_mov_b64 v[202:203], 0
    v_mov_b64 v[204:205], 0
    v_mov_b64 v[206:207], 0
    s_lshl_b32 s28, s64, 10
    s_add_u32 s28, s28, 151552
    v_lshl_add_u32 v250, v10, 4, s28
    s_lshl_b32 s28, s65, 8
    s_add_u32 s28, s28, 148480
    v_lshl_add_u32 v251, v11, 4, s28
    s_lshl_b32 s28, s64, 8
    s_add_u32 s28, s28, 149504
    v_lshl_add_u32 v252, v10, 2, s28
    s_lshl2_add_u32 s28, s33, s64
    s_lshl_b32 s28, s28, 8
    s_add_u32 s28, s28, 16384
    v_lshl_add_u32 v253, v8, 2, s28
    v_lshl_add_u32 v253, v9, 9, v253
    s_lshl1_add_u32 s29, s33, s64
    s_lshl_b32 s28, s35, 5
    s_add_u32 s28, s28, s29
    s_lshl1_add_u32 s28, s28, s65
    s_lshl_b32 s28, s28, 13
    s_add_u32 s82, s28, 8388608
    s_add_u32 s80, s26, s82
    s_addc_u32 s81, s27, 0
    s_mov_b32 s82, 8192
    s_mov_b32 s83, 0x20000
    v_lshlrev_b32 v248, 2, v9
    v_xor_b32 v248, v248, v10
    v_lshlrev_b32_e64 v248, 4, v248
    v_lshl_add_u32 v248, v9, 10, v248
    v_and_b32_e64 v4, 1, v11
    v_lshl_add_u32 v248, v4, 11, v248
    s_mov_b32 s84, 4096
    s_lshl1_add_u32 s29, s35, s65
    s_mul_i32 s28, s33, 28
    s_add_u32 s28, s28, s29
    s_lshl_b32 s28, s28, 14
    s_add_u32 s74, s28, 16777216
    s_add_u32 s72, s26, s74
    s_addc_u32 s73, s27, 0
    s_mov_b32 s74, 16384
    s_mov_b32 s75, 0x20000
    s_lshl_b32 s28, s64, 13
    v_lshl_add_u32 v249, v1, 4, s28
    s_waitcnt lgkmcnt(0)
    s_nop 0
    s_barrier
    ds_read_b64_tr_b16 v[32:33], v244 offset:0
    ds_read_b64_tr_b16 v[34:35], v244 offset:2048
    ds_read_b128 v[16:19], v242 offset:0
    ds_read_b128 v[20:23], v242 offset:2048
    ds_read_b128 v[24:27], v242 offset:4096
    ds_read_b128 v[28:31], v242 offset:6144
    ds_read_b64_tr_b16 v[36:37], v245 offset:0
    ds_read_b64_tr_b16 v[38:39], v245 offset:2048
    ds_read_b64_tr_b16 v[40:41], v246 offset:0
    ds_read_b64_tr_b16 v[42:43], v246 offset:2048
    ds_read_b64_tr_b16 v[44:45], v247 offset:0
    ds_read_b64_tr_b16 v[46:47], v247 offset:2048
    s_add_u32 s66, s66, 16384
    s_and_b32 s66, s66, 0xffff
    s_add_u32 s67, s67, 16384
    s_cmp_eq_u32 s67, 81920
    s_cselect_b32 s67, 0, s67
    s_mov_b32 s68, 15
.p2align 6
.cl_174:
    s_waitcnt lgkmcnt(6)
    v_mfma_f32_16x16x32_bf16 v[144:147], v[32:35], v[16:19], v[144:147]
    ds_read_b64_tr_b16 v[64:65], v244 offset:4096
    v_mfma_f32_16x16x32_bf16 v[160:163], v[32:35], v[20:23], v[160:163]
    ds_read_b64_tr_b16 v[66:67], v244 offset:6144
    v_mfma_f32_16x16x32_bf16 v[176:179], v[32:35], v[24:27], v[176:179]
    ds_read_b128 v[48:51], v242 offset:1024
    v_mfma_f32_16x16x32_bf16 v[192:195], v[32:35], v[28:31], v[192:195]
    ds_read_b128 v[52:55], v242 offset:3072
    s_waitcnt lgkmcnt(4)
    v_mfma_f32_16x16x32_bf16 v[196:199], v[36:39], v[28:31], v[196:199]
    ds_read_b128 v[56:59], v242 offset:5120
    v_mfma_f32_16x16x32_bf16 v[180:183], v[36:39], v[24:27], v[180:183]
    ds_read_b128 v[60:63], v242 offset:7168
    v_mfma_f32_16x16x32_bf16 v[164:167], v[36:39], v[20:23], v[164:167]
    ds_read_b64_tr_b16 v[68:69], v245 offset:4096
    v_mfma_f32_16x16x32_bf16 v[148:151], v[36:39], v[16:19], v[148:151]
    ds_read_b64_tr_b16 v[70:71], v245 offset:6144
    v_mfma_f32_16x16x32_bf16 v[152:155], v[40:43], v[16:19], v[152:155]
    ds_read_b64_tr_b16 v[72:73], v246 offset:4096
    v_mfma_f32_16x16x32_bf16 v[168:171], v[40:43], v[20:23], v[168:171]
    ds_read_b64_tr_b16 v[74:75], v246 offset:6144
    v_mfma_f32_16x16x32_bf16 v[184:187], v[40:43], v[24:27], v[184:187]
    ds_read_b64_tr_b16 v[76:77], v247 offset:4096
    v_mfma_f32_16x16x32_bf16 v[200:203], v[40:43], v[28:31], v[200:203]
    ds_read_b64_tr_b16 v[78:79], v247 offset:6144
    v_mfma_f32_16x16x32_bf16 v[204:207], v[44:47], v[28:31], v[204:207]
    v_add_u32_e64 v242, s66, v254
    v_mfma_f32_16x16x32_bf16 v[188:191], v[44:47], v[24:27], v[188:191]
    v_add_u32_e64 v244, s67, v255
    v_mfma_f32_16x16x32_bf16 v[172:175], v[44:47], v[20:23], v[172:175]
    v_xor_b32_e64 v245, 32, v244
    v_mfma_f32_16x16x32_bf16 v[156:159], v[44:47], v[16:19], v[156:159]
    v_xor_b32_e64 v246, 64, v244
    v_xor_b32 v247, 96, v244
    s_waitcnt lgkmcnt(0)
    v_mfma_f32_16x16x32_bf16 v[144:147], v[64:67], v[48:51], v[144:147]
    s_barrier
    v_mfma_f32_16x16x32_bf16 v[160:163], v[64:67], v[52:55], v[160:163]
    ds_read_b64_tr_b16 v[32:33], v244 offset:0
    v_mfma_f32_16x16x32_bf16 v[176:179], v[64:67], v[56:59], v[176:179]
    ds_read_b64_tr_b16 v[34:35], v244 offset:2048
    v_mfma_f32_16x16x32_bf16 v[192:195], v[64:67], v[60:63], v[192:195]
    ds_read_b128 v[16:19], v242 offset:0
    v_mfma_f32_16x16x32_bf16 v[196:199], v[68:71], v[60:63], v[196:199]
    ds_read_b128 v[20:23], v242 offset:2048
    v_mfma_f32_16x16x32_bf16 v[180:183], v[68:71], v[56:59], v[180:183]
    ds_read_b128 v[24:27], v242 offset:4096
    s_add_u32 s66, s66, 16384
    v_mfma_f32_16x16x32_bf16 v[164:167], v[68:71], v[52:55], v[164:167]
    ds_read_b128 v[28:31], v242 offset:6144
    s_and_b32 s66, s66, 0xffff
    v_mfma_f32_16x16x32_bf16 v[148:151], v[68:71], v[48:51], v[148:151]
    ds_read_b64_tr_b16 v[36:37], v245 offset:0
    s_add_u32 s67, s67, 16384
    v_mfma_f32_16x16x32_bf16 v[152:155], v[72:75], v[48:51], v[152:155]
    ds_read_b64_tr_b16 v[38:39], v245 offset:2048
    s_cmp_eq_u32 s67, 81920
    v_mfma_f32_16x16x32_bf16 v[168:171], v[72:75], v[52:55], v[168:171]
    ds_read_b64_tr_b16 v[40:41], v246 offset:0
    s_cselect_b32 s67, 0, s67
    v_mfma_f32_16x16x32_bf16 v[184:187], v[72:75], v[56:59], v[184:187]
    ds_read_b64_tr_b16 v[42:43], v246 offset:2048
    v_mfma_f32_16x16x32_bf16 v[200:203], v[72:75], v[60:63], v[200:203]
    ds_read_b64_tr_b16 v[44:45], v247 offset:0
    v_mfma_f32_16x16x32_bf16 v[204:207], v[76:79], v[60:63], v[204:207]
    ds_read_b64_tr_b16 v[46:47], v247 offset:2048
    v_mfma_f32_16x16x32_bf16 v[188:191], v[76:79], v[56:59], v[188:191]
    s_sub_u32 s68, s68, 1
    v_mfma_f32_16x16x32_bf16 v[172:175], v[76:79], v[52:55], v[172:175]
    s_cmp_lg_u32 s68, 0
    v_mfma_f32_16x16x32_bf16 v[156:159], v[76:79], v[48:51], v[156:159]
    s_cbranch_scc1 .cl_174
.code_c3:
    s_waitcnt lgkmcnt(6)
    v_mfma_f32_16x16x32_bf16 v[144:147], v[32:35], v[16:19], v[144:147]
    ds_read_b64_tr_b16 v[64:65], v244 offset:4096
    v_mfma_f32_16x16x32_bf16 v[160:163], v[32:35], v[20:23], v[160:163]
    ds_read_b64_tr_b16 v[66:67], v244 offset:6144
    v_mfma_f32_16x16x32_bf16 v[176:179], v[32:35], v[24:27], v[176:179]
    ds_read_b128 v[48:51], v242 offset:1024
    v_mfma_f32_16x16x32_bf16 v[192:195], v[32:35], v[28:31], v[192:195]
    ds_read_b128 v[52:55], v242 offset:3072
    s_waitcnt lgkmcnt(4)
    v_mfma_f32_16x16x32_bf16 v[196:199], v[36:39], v[28:31], v[196:199]
    ds_read_b128 v[56:59], v242 offset:5120
    v_mfma_f32_16x16x32_bf16 v[180:183], v[36:39], v[24:27], v[180:183]
    ds_read_b128 v[60:63], v242 offset:7168
    v_mfma_f32_16x16x32_bf16 v[164:167], v[36:39], v[20:23], v[164:167]
    ds_read_b64_tr_b16 v[68:69], v245 offset:4096
    v_mfma_f32_16x16x32_bf16 v[148:151], v[36:39], v[16:19], v[148:151]
    ds_read_b64_tr_b16 v[70:71], v245 offset:6144
    v_mfma_f32_16x16x32_bf16 v[152:155], v[40:43], v[16:19], v[152:155]
    ds_read_b64_tr_b16 v[72:73], v246 offset:4096
    v_mfma_f32_16x16x32_bf16 v[168:171], v[40:43], v[20:23], v[168:171]
    ds_read_b64_tr_b16 v[74:75], v246 offset:6144
    v_mfma_f32_16x16x32_bf16 v[184:187], v[40:43], v[24:27], v[184:187]
    ds_read_b64_tr_b16 v[76:77], v247 offset:4096
    v_mfma_f32_16x16x32_bf16 v[200:203], v[40:43], v[28:31], v[200:203]
    ds_read_b64_tr_b16 v[78:79], v247 offset:6144
    v_mfma_f32_16x16x32_bf16 v[204:207], v[44:47], v[28:31], v[204:207]
    v_mfma_f32_16x16x32_bf16 v[188:191], v[44:47], v[24:27], v[188:191]
    v_mfma_f32_16x16x32_bf16 v[172:175], v[44:47], v[20:23], v[172:175]
    v_mfma_f32_16x16x32_bf16 v[156:159], v[44:47], v[16:19], v[156:159]
    s_waitcnt lgkmcnt(0)
    v_mfma_f32_16x16x32_bf16 v[144:147], v[64:67], v[48:51], v[144:147]
    s_barrier
    s_nop 0
    v_mfma_f32_16x16x32_bf16 v[160:163], v[64:67], v[52:55], v[160:163]
    ds_read_b128 v[16:19], v251 offset:0
    v_mfma_f32_16x16x32_bf16 v[176:179], v[64:67], v[56:59], v[176:179]
    ds_read_b128 v[20:23], v251 offset:64
    v_mfma_f32_16x16x32_bf16 v[192:195], v[64:67], v[60:63], v[192:195]
    ds_read_b128 v[24:27], v251 offset:128
    v_mfma_f32_16x16x32_bf16 v[196:199], v[68:71], v[60:63], v[196:199]
    ds_read_b128 v[28:31], v251 offset:192
    v_mfma_f32_16x16x32_bf16 v[180:183], v[68:71], v[56:59], v[180:183]
    ds_read_b128 v[32:35], v250 offset:0
    v_mfma_f32_16x16x32_bf16 v[164:167], v[68:71], v[52:55], v[164:167]
    ds_read_b128 v[36:39], v250 offset:256
    v_mfma_f32_16x16x32_bf16 v[148:151], v[68:71], v[48:51], v[148:151]
    ds_read_b128 v[40:43], v250 offset:512
    v_mfma_f32_16x16x32_bf16 v[152:155], v[72:75], v[48:51], v[152:155]
    ds_read_b128 v[44:47], v250 offset:768
    v_mfma_f32_16x16x32_bf16 v[168:171], v[72:75], v[52:55], v[168:171]
    s_mov_b32 s66, 0
    s_mov_b32 s67, 0
    v_mfma_f32_16x16x32_bf16 v[184:187], v[72:75], v[56:59], v[184:187]
    v_add_u32 v242, s66, v254
    v_mfma_f32_16x16x32_bf16 v[200:203], v[72:75], v[60:63], v[200:203]
    v_add_u32_e64 v244, s67, v255
    v_mfma_f32_16x16x32_bf16 v[204:207], v[76:79], v[60:63], v[204:207]
    v_xor_b32_e64 v245, 32, v244
    v_mfma_f32_16x16x32_bf16 v[188:191], v[76:79], v[56:59], v[188:191]
    v_xor_b32_e64 v246, 64, v244
    v_mfma_f32_16x16x32_bf16 v[172:175], v[76:79], v[52:55], v[172:175]
    v_xor_b32 v247, 96, v244
    v_mfma_f32_16x16x32_bf16 v[156:159], v[76:79], v[48:51], v[156:159]
    s_nop 0
    s_waitcnt lgkmcnt(0)
    v_pk_fma_f32 v[144:145], v[16:17], v[32:33], v[144:145] op_sel:[0,1,0] op_sel_hi:[1,1,1]
    v_pk_fma_f32 v[146:147], v[18:19], v[32:33], v[146:147] op_sel:[0,1,0] op_sel_hi:[1,1,1]
    v_pk_fma_f32 v[148:149], v[20:21], v[32:33], v[148:149] op_sel:[0,1,0] op_sel_hi:[1,1,1]
    v_pk_fma_f32 v[150:151], v[22:23], v[32:33], v[150:151] op_sel:[0,1,0] op_sel_hi:[1,1,1]
    v_pk_fma_f32 v[152:153], v[24:25], v[32:33], v[152:153] op_sel:[0,1,0] op_sel_hi:[1,1,1]
    v_pk_fma_f32 v[154:155], v[26:27], v[32:33], v[154:155] op_sel:[0,1,0] op_sel_hi:[1,1,1]
    s_nop 0
    s_nop 0
    v_pk_fma_f32 v[156:157], v[28:29], v[32:33], v[156:157] op_sel:[0,1,0] op_sel_hi:[1,1,1]
    v_pk_fma_f32 v[158:159], v[30:31], v[32:33], v[158:159] op_sel:[0,1,0] op_sel_hi:[1,1,1]
    v_pk_mul_f32 v[48:49], v[144:145], v[144:145]
    v_pk_mul_f32 v[50:51], v[146:147], v[146:147]
    v_pk_mul_f32 v[52:53], v[148:149], v[148:149]
    v_pk_mul_f32 v[54:55], v[150:151], v[150:151]
    v_pk_mul_f32 v[56:57], v[152:153], v[152:153]
    v_pk_mul_f32 v[58:59], v[154:155], v[154:155]
    v_pk_mul_f32 v[60:61], v[156:157], v[156:157]
    v_pk_mul_f32 v[62:63], v[158:159], v[158:159]
    v_pk_fma_f32 v[48:49], v[48:49], v[34:35], v[34:35] op_sel:[0,0,1] op_sel_hi:[1,0,1]
    v_pk_fma_f32 v[50:51], v[50:51], v[34:35], v[34:35] op_sel:[0,0,1] op_sel_hi:[1,0,1]
    v_pk_fma_f32 v[52:53], v[52:53], v[34:35], v[34:35] op_sel:[0,0,1] op_sel_hi:[1,0,1]
    v_pk_fma_f32 v[54:55], v[54:55], v[34:35], v[34:35] op_sel:[0,0,1] op_sel_hi:[1,0,1]
    v_pk_fma_f32 v[56:57], v[56:57], v[34:35], v[34:35] op_sel:[0,0,1] op_sel_hi:[1,0,1]
    v_pk_fma_f32 v[58:59], v[58:59], v[34:35], v[34:35] op_sel:[0,0,1] op_sel_hi:[1,0,1]
    v_pk_fma_f32 v[60:61], v[60:61], v[34:35], v[34:35] op_sel:[0,0,1] op_sel_hi:[1,0,1]
    v_pk_fma_f32 v[62:63], v[62:63], v[34:35], v[34:35] op_sel:[0,0,1] op_sel_hi:[1,0,1]
    v_pk_mul_f32 v[48:49], v[48:49], v[144:145]
    v_pk_mul_f32 v[50:51], v[50:51], v[146:147]
    v_pk_mul_f32 v[52:53], v[52:53], v[148:149]
    v_pk_mul_f32 v[54:55], v[54:55], v[150:151]
    v_pk_mul_f32 v[56:57], v[56:57], v[152:153]
    v_pk_mul_f32 v[58:59], v[58:59], v[154:155]
    v_pk_mul_f32 v[60:61], v[60:61], v[156:157]
    v_pk_mul_f32 v[62:63], v[62:63], v[158:159]
    v_exp_f32 v48, v48
    v_exp_f32 v49, v49
    v_exp_f32 v50, v50
    v_exp_f32 v51, v51
    v_exp_f32 v52, v52
    v_exp_f32 v53, v53
    v_exp_f32 v54, v54
    v_exp_f32 v55, v55
    v_exp_f32 v56, v56
    v_exp_f32 v57, v57
    v_exp_f32 v58, v58
    v_exp_f32 v59, v59
    v_exp_f32 v60, v60
    v_exp_f32 v61, v61
    v_exp_f32 v62, v62
    v_exp_f32 v63, v63
    v_pk_fma_f32 v[48:49], v[48:49], v[32:33], v[32:33] op_sel_hi:[1,0,0]
    v_pk_fma_f32 v[50:51], v[50:51], v[32:33], v[32:33] op_sel_hi:[1,0,0]
    v_pk_fma_f32 v[52:53], v[52:53], v[32:33], v[32:33] op_sel_hi:[1,0,0]
    v_pk_fma_f32 v[54:55], v[54:55], v[32:33], v[32:33] op_sel_hi:[1,0,0]
    v_pk_fma_f32 v[56:57], v[56:57], v[32:33], v[32:33] op_sel_hi:[1,0,0]
    v_pk_fma_f32 v[58:59], v[58:59], v[32:33], v[32:33] op_sel_hi:[1,0,0]
    v_pk_fma_f32 v[60:61], v[60:61], v[32:33], v[32:33] op_sel_hi:[1,0,0]
    v_pk_fma_f32 v[62:63], v[62:63], v[32:33], v[32:33] op_sel_hi:[1,0,0]
    v_rcp_f32 v48, v48
    v_rcp_f32 v49, v49
    v_rcp_f32 v50, v50
    v_rcp_f32 v51, v51
    v_rcp_f32 v52, v52
    v_rcp_f32 v53, v53
    v_rcp_f32 v54, v54
    v_rcp_f32 v55, v55
    v_rcp_f32 v56, v56
    v_rcp_f32 v57, v57
    v_rcp_f32 v58, v58
    v_rcp_f32 v59, v59
    v_rcp_f32 v60, v60
    v_rcp_f32 v61, v61
    v_rcp_f32 v62, v62
    v_rcp_f32 v63, v63
    v_pk_mul_f32 v[144:145], v[144:145], v[48:49]
    v_pk_mul_f32 v[146:147], v[146:147], v[50:51]
    v_pk_mul_f32 v[148:149], v[148:149], v[52:53]
    v_pk_mul_f32 v[150:151], v[150:151], v[54:55]
    v_pk_mul_f32 v[152:153], v[152:153], v[56:57]
    v_pk_mul_f32 v[154:155], v[154:155], v[58:59]
    v_pk_mul_f32 v[156:157], v[156:157], v[60:61]
    v_pk_mul_f32 v[158:159], v[158:159], v[62:63]
    v_pk_add_f32 v[48:49], v[144:145], v[146:147]
    v_pk_mul_f32 v[50:51], v[144:145], v[144:145]
    v_pk_fma_f32 v[50:51], v[146:147], v[146:147], v[50:51]
    v_pk_add_f32 v[48:49], v[48:49], v[148:149]
    v_pk_fma_f32 v[50:51], v[148:149], v[148:149], v[50:51]
    v_pk_add_f32 v[48:49], v[48:49], v[150:151]
    v_pk_fma_f32 v[50:51], v[150:151], v[150:151], v[50:51]
    v_pk_add_f32 v[48:49], v[48:49], v[152:153]
    v_pk_fma_f32 v[50:51], v[152:153], v[152:153], v[50:51]
    v_pk_add_f32 v[48:49], v[48:49], v[154:155]
    v_pk_fma_f32 v[50:51], v[154:155], v[154:155], v[50:51]
    v_pk_add_f32 v[48:49], v[48:49], v[156:157]
    v_pk_fma_f32 v[50:51], v[156:157], v[156:157], v[50:51]
    v_pk_add_f32 v[48:49], v[48:49], v[158:159]
    v_pk_fma_f32 v[50:51], v[158:159], v[158:159], v[50:51]
    v_add_f32 v64, v48, v49
    v_add_f32 v65, v50, v51
    v_pk_fma_f32 v[160:161], v[16:17], v[36:37], v[160:161] op_sel:[0,1,0] op_sel_hi:[1,1,1]
    v_pk_fma_f32 v[162:163], v[18:19], v[36:37], v[162:163] op_sel:[0,1,0] op_sel_hi:[1,1,1]
    v_pk_fma_f32 v[164:165], v[20:21], v[36:37], v[164:165] op_sel:[0,1,0] op_sel_hi:[1,1,1]
    v_pk_fma_f32 v[166:167], v[22:23], v[36:37], v[166:167] op_sel:[0,1,0] op_sel_hi:[1,1,1]
    v_pk_fma_f32 v[168:169], v[24:25], v[36:37], v[168:169] op_sel:[0,1,0] op_sel_hi:[1,1,1]
    v_pk_fma_f32 v[170:171], v[26:27], v[36:37], v[170:171] op_sel:[0,1,0] op_sel_hi:[1,1,1]
    v_pk_fma_f32 v[172:173], v[28:29], v[36:37], v[172:173] op_sel:[0,1,0] op_sel_hi:[1,1,1]
    v_pk_fma_f32 v[174:175], v[30:31], v[36:37], v[174:175] op_sel:[0,1,0] op_sel_hi:[1,1,1]
    v_pk_mul_f32 v[48:49], v[160:161], v[160:161]
    v_pk_mul_f32 v[50:51], v[162:163], v[162:163]
    v_pk_mul_f32 v[52:53], v[164:165], v[164:165]
    v_pk_mul_f32 v[54:55], v[166:167], v[166:167]
    v_pk_mul_f32 v[56:57], v[168:169], v[168:169]
    v_pk_mul_f32 v[58:59], v[170:171], v[170:171]
    v_pk_mul_f32 v[60:61], v[172:173], v[172:173]
    v_pk_mul_f32 v[62:63], v[174:175], v[174:175]
    v_pk_fma_f32 v[48:49], v[48:49], v[38:39], v[38:39] op_sel:[0,0,1] op_sel_hi:[1,0,1]
    v_pk_fma_f32 v[50:51], v[50:51], v[38:39], v[38:39] op_sel:[0,0,1] op_sel_hi:[1,0,1]
    v_pk_fma_f32 v[52:53], v[52:53], v[38:39], v[38:39] op_sel:[0,0,1] op_sel_hi:[1,0,1]
    v_pk_fma_f32 v[54:55], v[54:55], v[38:39], v[38:39] op_sel:[0,0,1] op_sel_hi:[1,0,1]
    v_pk_fma_f32 v[56:57], v[56:57], v[38:39], v[38:39] op_sel:[0,0,1] op_sel_hi:[1,0,1]
    v_pk_fma_f32 v[58:59], v[58:59], v[38:39], v[38:39] op_sel:[0,0,1] op_sel_hi:[1,0,1]
    v_pk_fma_f32 v[60:61], v[60:61], v[38:39], v[38:39] op_sel:[0,0,1] op_sel_hi:[1,0,1]
    v_pk_fma_f32 v[62:63], v[62:63], v[38:39], v[38:39] op_sel:[0,0,1] op_sel_hi:[1,0,1]
    v_pk_mul_f32 v[48:49], v[48:49], v[160:161]
    v_pk_mul_f32 v[50:51], v[50:51], v[162:163]
    v_pk_mul_f32 v[52:53], v[52:53], v[164:165]
    v_pk_mul_f32 v[54:55], v[54:55], v[166:167]
    v_pk_mul_f32 v[56:57], v[56:57], v[168:169]
    v_pk_mul_f32 v[58:59], v[58:59], v[170:171]
    v_pk_mul_f32 v[60:61], v[60:61], v[172:173]
    v_pk_mul_f32 v[62:63], v[62:63], v[174:175]
    v_exp_f32 v48, v48
    v_exp_f32 v49, v49
    v_exp_f32 v50, v50
    v_exp_f32 v51, v51
    v_exp_f32 v52, v52
    v_exp_f32 v53, v53
    v_exp_f32 v54, v54
    v_exp_f32 v55, v55
    v_exp_f32 v56, v56
    v_exp_f32 v57, v57
    v_exp_f32 v58, v58
    v_exp_f32 v59, v59
    v_exp_f32 v60, v60
    v_exp_f32 v61, v61
    v_exp_f32 v62, v62
    v_exp_f32 v63, v63
    v_pk_fma_f32 v[48:49], v[48:49], v[36:37], v[36:37] op_sel_hi:[1,0,0]
    v_pk_fma_f32 v[50:51], v[50:51], v[36:37], v[36:37] op_sel_hi:[1,0,0]
    v_pk_fma_f32 v[52:53], v[52:53], v[36:37], v[36:37] op_sel_hi:[1,0,0]
    v_pk_fma_f32 v[54:55], v[54:55], v[36:37], v[36:37] op_sel_hi:[1,0,0]
    v_pk_fma_f32 v[56:57], v[56:57], v[36:37], v[36:37] op_sel_hi:[1,0,0]
    v_pk_fma_f32 v[58:59], v[58:59], v[36:37], v[36:37] op_sel_hi:[1,0,0]
    v_pk_fma_f32 v[60:61], v[60:61], v[36:37], v[36:37] op_sel_hi:[1,0,0]
    v_pk_fma_f32 v[62:63], v[62:63], v[36:37], v[36:37] op_sel_hi:[1,0,0]
    v_rcp_f32 v48, v48
    v_rcp_f32 v49, v49
    v_rcp_f32 v50, v50
    v_rcp_f32 v51, v51
    v_rcp_f32 v52, v52
    v_rcp_f32 v53, v53
    v_rcp_f32 v54, v54
    v_rcp_f32 v55, v55
    v_rcp_f32 v56, v56
    v_rcp_f32 v57, v57
    v_rcp_f32 v58, v58
    v_rcp_f32 v59, v59
    v_rcp_f32 v60, v60
    v_rcp_f32 v61, v61
    v_rcp_f32 v62, v62
    v_rcp_f32 v63, v63
    v_pk_mul_f32 v[160:161], v[160:161], v[48:49]
    v_pk_mul_f32 v[162:163], v[162:163], v[50:51]
    v_pk_mul_f32 v[164:165], v[164:165], v[52:53]
    v_pk_mul_f32 v[166:167], v[166:167], v[54:55]
    v_pk_mul_f32 v[168:169], v[168:169], v[56:57]
    v_pk_mul_f32 v[170:171], v[170:171], v[58:59]
    v_pk_mul_f32 v[172:173], v[172:173], v[60:61]
    v_pk_mul_f32 v[174:175], v[174:175], v[62:63]
    v_pk_add_f32 v[48:49], v[160:161], v[162:163]
    v_pk_mul_f32 v[50:51], v[160:161], v[160:161]
    v_pk_fma_f32 v[50:51], v[162:163], v[162:163], v[50:51]
    v_pk_add_f32 v[48:49], v[48:49], v[164:165]
    v_pk_fma_f32 v[50:51], v[164:165], v[164:165], v[50:51]
    v_pk_add_f32 v[48:49], v[48:49], v[166:167]
    v_pk_fma_f32 v[50:51], v[166:167], v[166:167], v[50:51]
    v_pk_add_f32 v[48:49], v[48:49], v[168:169]
    v_pk_fma_f32 v[50:51], v[168:169], v[168:169], v[50:51]
    v_pk_add_f32 v[48:49], v[48:49], v[170:171]
    v_pk_fma_f32 v[50:51], v[170:171], v[170:171], v[50:51]
    v_pk_add_f32 v[48:49], v[48:49], v[172:173]
    v_pk_fma_f32 v[50:51], v[172:173], v[172:173], v[50:51]
    v_pk_add_f32 v[48:49], v[48:49], v[174:175]
    v_pk_fma_f32 v[50:51], v[174:175], v[174:175], v[50:51]
    v_add_f32 v66, v48, v49
    v_add_f32 v67, v50, v51
    v_pk_fma_f32 v[176:177], v[16:17], v[40:41], v[176:177] op_sel:[0,1,0] op_sel_hi:[1,1,1]
    v_pk_fma_f32 v[178:179], v[18:19], v[40:41], v[178:179] op_sel:[0,1,0] op_sel_hi:[1,1,1]
    v_pk_fma_f32 v[180:181], v[20:21], v[40:41], v[180:181] op_sel:[0,1,0] op_sel_hi:[1,1,1]
    v_pk_fma_f32 v[182:183], v[22:23], v[40:41], v[182:183] op_sel:[0,1,0] op_sel_hi:[1,1,1]
    v_pk_fma_f32 v[184:185], v[24:25], v[40:41], v[184:185] op_sel:[0,1,0] op_sel_hi:[1,1,1]
    v_pk_fma_f32 v[186:187], v[26:27], v[40:41], v[186:187] op_sel:[0,1,0] op_sel_hi:[1,1,1]
    v_pk_fma_f32 v[188:189], v[28:29], v[40:41], v[188:189] op_sel:[0,1,0] op_sel_hi:[1,1,1]
    v_pk_fma_f32 v[190:191], v[30:31], v[40:41], v[190:191] op_sel:[0,1,0] op_sel_hi:[1,1,1]
    v_pk_mul_f32 v[48:49], v[176:177], v[176:177]
    v_pk_mul_f32 v[50:51], v[178:179], v[178:179]
    v_pk_mul_f32 v[52:53], v[180:181], v[180:181]
    v_pk_mul_f32 v[54:55], v[182:183], v[182:183]
    v_pk_mul_f32 v[56:57], v[184:185], v[184:185]
    v_pk_mul_f32 v[58:59], v[186:187], v[186:187]
    v_pk_mul_f32 v[60:61], v[188:189], v[188:189]
    v_pk_mul_f32 v[62:63], v[190:191], v[190:191]
    v_pk_fma_f32 v[48:49], v[48:49], v[42:43], v[42:43] op_sel:[0,0,1] op_sel_hi:[1,0,1]
    v_pk_fma_f32 v[50:51], v[50:51], v[42:43], v[42:43] op_sel:[0,0,1] op_sel_hi:[1,0,1]
    v_pk_fma_f32 v[52:53], v[52:53], v[42:43], v[42:43] op_sel:[0,0,1] op_sel_hi:[1,0,1]
    v_pk_fma_f32 v[54:55], v[54:55], v[42:43], v[42:43] op_sel:[0,0,1] op_sel_hi:[1,0,1]
    v_pk_fma_f32 v[56:57], v[56:57], v[42:43], v[42:43] op_sel:[0,0,1] op_sel_hi:[1,0,1]
    v_pk_fma_f32 v[58:59], v[58:59], v[42:43], v[42:43] op_sel:[0,0,1] op_sel_hi:[1,0,1]
    v_pk_fma_f32 v[60:61], v[60:61], v[42:43], v[42:43] op_sel:[0,0,1] op_sel_hi:[1,0,1]
    v_pk_fma_f32 v[62:63], v[62:63], v[42:43], v[42:43] op_sel:[0,0,1] op_sel_hi:[1,0,1]
    v_pk_mul_f32 v[48:49], v[48:49], v[176:177]
    v_pk_mul_f32 v[50:51], v[50:51], v[178:179]
    v_pk_mul_f32 v[52:53], v[52:53], v[180:181]
    v_pk_mul_f32 v[54:55], v[54:55], v[182:183]
    v_pk_mul_f32 v[56:57], v[56:57], v[184:185]
    v_pk_mul_f32 v[58:59], v[58:59], v[186:187]
    v_pk_mul_f32 v[60:61], v[60:61], v[188:189]
    v_pk_mul_f32 v[62:63], v[62:63], v[190:191]
    v_exp_f32 v48, v48
    v_exp_f32 v49, v49
    v_exp_f32 v50, v50
    v_exp_f32 v51, v51
    v_exp_f32 v52, v52
    v_exp_f32 v53, v53
    v_exp_f32 v54, v54
    v_exp_f32 v55, v55
    v_exp_f32 v56, v56
    v_exp_f32 v57, v57
    v_exp_f32 v58, v58
    v_exp_f32 v59, v59
    v_exp_f32 v60, v60
    v_exp_f32 v61, v61
    v_exp_f32 v62, v62
    v_exp_f32 v63, v63
    v_pk_fma_f32 v[48:49], v[48:49], v[40:41], v[40:41] op_sel_hi:[1,0,0]
    v_pk_fma_f32 v[50:51], v[50:51], v[40:41], v[40:41] op_sel_hi:[1,0,0]
    v_pk_fma_f32 v[52:53], v[52:53], v[40:41], v[40:41] op_sel_hi:[1,0,0]
    v_pk_fma_f32 v[54:55], v[54:55], v[40:41], v[40:41] op_sel_hi:[1,0,0]
    v_pk_fma_f32 v[56:57], v[56:57], v[40:41], v[40:41] op_sel_hi:[1,0,0]
    v_pk_fma_f32 v[58:59], v[58:59], v[40:41], v[40:41] op_sel_hi:[1,0,0]
    v_pk_fma_f32 v[60:61], v[60:61], v[40:41], v[40:41] op_sel_hi:[1,0,0]
    v_pk_fma_f32 v[62:63], v[62:63], v[40:41], v[40:41] op_sel_hi:[1,0,0]
    v_rcp_f32 v48, v48
    v_rcp_f32 v49, v49
    v_rcp_f32 v50, v50
    v_rcp_f32 v51, v51
    v_rcp_f32 v52, v52
    v_rcp_f32 v53, v53
    v_rcp_f32 v54, v54
    v_rcp_f32 v55, v55
    v_rcp_f32 v56, v56
    v_rcp_f32 v57, v57
    v_rcp_f32 v58, v58
    v_rcp_f32 v59, v59
    v_rcp_f32 v60, v60
    v_rcp_f32 v61, v61
    v_rcp_f32 v62, v62
    v_rcp_f32 v63, v63
    v_pk_mul_f32 v[176:177], v[176:177], v[48:49]
    v_pk_mul_f32 v[178:179], v[178:179], v[50:51]
    v_pk_mul_f32 v[180:181], v[180:181], v[52:53]
    v_pk_mul_f32 v[182:183], v[182:183], v[54:55]
    v_pk_mul_f32 v[184:185], v[184:185], v[56:57]
    v_pk_mul_f32 v[186:187], v[186:187], v[58:59]
    v_pk_mul_f32 v[188:189], v[188:189], v[60:61]
    v_pk_mul_f32 v[190:191], v[190:191], v[62:63]
    v_pk_add_f32 v[48:49], v[176:177], v[178:179]
    v_pk_mul_f32 v[50:51], v[176:177], v[176:177]
    v_pk_fma_f32 v[50:51], v[178:179], v[178:179], v[50:51]
    v_pk_add_f32 v[48:49], v[48:49], v[180:181]
    v_pk_fma_f32 v[50:51], v[180:181], v[180:181], v[50:51]
    v_pk_add_f32 v[48:49], v[48:49], v[182:183]
    v_pk_fma_f32 v[50:51], v[182:183], v[182:183], v[50:51]
    v_pk_add_f32 v[48:49], v[48:49], v[184:185]
    v_pk_fma_f32 v[50:51], v[184:185], v[184:185], v[50:51]
    v_pk_add_f32 v[48:49], v[48:49], v[186:187]
    v_pk_fma_f32 v[50:51], v[186:187], v[186:187], v[50:51]
    v_pk_add_f32 v[48:49], v[48:49], v[188:189]
    v_pk_fma_f32 v[50:51], v[188:189], v[188:189], v[50:51]
    v_pk_add_f32 v[48:49], v[48:49], v[190:191]
    v_pk_fma_f32 v[50:51], v[190:191], v[190:191], v[50:51]
    v_add_f32 v68, v48, v49
    v_add_f32 v69, v50, v51
    v_pk_fma_f32 v[192:193], v[16:17], v[44:45], v[192:193] op_sel:[0,1,0] op_sel_hi:[1,1,1]
    v_pk_fma_f32 v[194:195], v[18:19], v[44:45], v[194:195] op_sel:[0,1,0] op_sel_hi:[1,1,1]
    v_pk_fma_f32 v[196:197], v[20:21], v[44:45], v[196:197] op_sel:[0,1,0] op_sel_hi:[1,1,1]
    v_pk_fma_f32 v[198:199], v[22:23], v[44:45], v[198:199] op_sel:[0,1,0] op_sel_hi:[1,1,1]
    v_pk_fma_f32 v[200:201], v[24:25], v[44:45], v[200:201] op_sel:[0,1,0] op_sel_hi:[1,1,1]
    v_pk_fma_f32 v[202:203], v[26:27], v[44:45], v[202:203] op_sel:[0,1,0] op_sel_hi:[1,1,1]
    v_pk_fma_f32 v[204:205], v[28:29], v[44:45], v[204:205] op_sel:[0,1,0] op_sel_hi:[1,1,1]
    v_pk_fma_f32 v[206:207], v[30:31], v[44:45], v[206:207] op_sel:[0,1,0] op_sel_hi:[1,1,1]
    v_pk_mul_f32 v[48:49], v[192:193], v[192:193]
    v_pk_mul_f32 v[50:51], v[194:195], v[194:195]
    v_pk_mul_f32 v[52:53], v[196:197], v[196:197]
    v_pk_mul_f32 v[54:55], v[198:199], v[198:199]
    v_pk_mul_f32 v[56:57], v[200:201], v[200:201]
    v_pk_mul_f32 v[58:59], v[202:203], v[202:203]
    v_pk_mul_f32 v[60:61], v[204:205], v[204:205]
    v_pk_mul_f32 v[62:63], v[206:207], v[206:207]
    v_pk_fma_f32 v[48:49], v[48:49], v[46:47], v[46:47] op_sel:[0,0,1] op_sel_hi:[1,0,1]
    v_pk_fma_f32 v[50:51], v[50:51], v[46:47], v[46:47] op_sel:[0,0,1] op_sel_hi:[1,0,1]
    v_pk_fma_f32 v[52:53], v[52:53], v[46:47], v[46:47] op_sel:[0,0,1] op_sel_hi:[1,0,1]
    v_pk_fma_f32 v[54:55], v[54:55], v[46:47], v[46:47] op_sel:[0,0,1] op_sel_hi:[1,0,1]
    v_pk_fma_f32 v[56:57], v[56:57], v[46:47], v[46:47] op_sel:[0,0,1] op_sel_hi:[1,0,1]
    v_pk_fma_f32 v[58:59], v[58:59], v[46:47], v[46:47] op_sel:[0,0,1] op_sel_hi:[1,0,1]
    v_pk_fma_f32 v[60:61], v[60:61], v[46:47], v[46:47] op_sel:[0,0,1] op_sel_hi:[1,0,1]
    v_pk_fma_f32 v[62:63], v[62:63], v[46:47], v[46:47] op_sel:[0,0,1] op_sel_hi:[1,0,1]
    v_pk_mul_f32 v[48:49], v[48:49], v[192:193]
    v_pk_mul_f32 v[50:51], v[50:51], v[194:195]
    v_pk_mul_f32 v[52:53], v[52:53], v[196:197]
    v_pk_mul_f32 v[54:55], v[54:55], v[198:199]
    v_pk_mul_f32 v[56:57], v[56:57], v[200:201]
    v_pk_mul_f32 v[58:59], v[58:59], v[202:203]
    v_pk_mul_f32 v[60:61], v[60:61], v[204:205]
    v_pk_mul_f32 v[62:63], v[62:63], v[206:207]
    v_exp_f32 v48, v48
    v_exp_f32 v49, v49
    v_exp_f32 v50, v50
    v_exp_f32 v51, v51
    v_exp_f32 v52, v52
    v_exp_f32 v53, v53
    v_exp_f32 v54, v54
    v_exp_f32 v55, v55
    v_exp_f32 v56, v56
    v_exp_f32 v57, v57
    v_exp_f32 v58, v58
    v_exp_f32 v59, v59
    v_exp_f32 v60, v60
    v_exp_f32 v61, v61
    v_exp_f32 v62, v62
    v_exp_f32 v63, v63
    v_pk_fma_f32 v[48:49], v[48:49], v[44:45], v[44:45] op_sel_hi:[1,0,0]
    v_pk_fma_f32 v[50:51], v[50:51], v[44:45], v[44:45] op_sel_hi:[1,0,0]
    s_branch .pg_5
.p2align 12
.pad_5:
    s_nop 0
    s_setpc_b64 s[44:45]
.pg_5:
    v_pk_fma_f32 v[52:53], v[52:53], v[44:45], v[44:45] op_sel_hi:[1,0,0]
    v_pk_fma_f32 v[54:55], v[54:55], v[44:45], v[44:45] op_sel_hi:[1,0,0]
    v_pk_fma_f32 v[56:57], v[56:57], v[44:45], v[44:45] op_sel_hi:[1,0,0]
    v_pk_fma_f32 v[58:59], v[58:59], v[44:45], v[44:45] op_sel_hi:[1,0,0]
    v_pk_fma_f32 v[60:61], v[60:61], v[44:45], v[44:45] op_sel_hi:[1,0,0]
    v_pk_fma_f32 v[62:63], v[62:63], v[44:45], v[44:45] op_sel_hi:[1,0,0]
    v_rcp_f32 v48, v48
    v_rcp_f32 v49, v49
    v_rcp_f32 v50, v50
    v_rcp_f32 v51, v51
    v_rcp_f32 v52, v52
    v_rcp_f32 v53, v53
    v_rcp_f32 v54, v54
    v_rcp_f32 v55, v55
    v_rcp_f32 v56, v56
    v_rcp_f32 v57, v57
    v_rcp_f32 v58, v58
    v_rcp_f32 v59, v59
    v_rcp_f32 v60, v60
    v_rcp_f32 v61, v61
    v_rcp_f32 v62, v62
    v_rcp_f32 v63, v63
    v_pk_mul_f32 v[192:193], v[192:193], v[48:49]
    v_pk_mul_f32 v[194:195], v[194:195], v[50:51]
    v_pk_mul_f32 v[196:197], v[196:197], v[52:53]
    v_pk_mul_f32 v[198:199], v[198:199], v[54:55]
    v_pk_mul_f32 v[200:201], v[200:201], v[56:57]
    v_pk_mul_f32 v[202:203], v[202:203], v[58:59]
    v_pk_mul_f32 v[204:205], v[204:205], v[60:61]
    v_pk_mul_f32 v[206:207], v[206:207], v[62:63]
    v_pk_add_f32 v[48:49], v[192:193], v[194:195]
    v_pk_mul_f32 v[50:51], v[192:193], v[192:193]
    v_pk_fma_f32 v[50:51], v[194:195], v[194:195], v[50:51]
    v_pk_add_f32 v[48:49], v[48:49], v[196:197]
    v_pk_fma_f32 v[50:51], v[196:197], v[196:197], v[50:51]
    v_pk_add_f32 v[48:49], v[48:49], v[198:199]
    v_pk_fma_f32 v[50:51], v[198:199], v[198:199], v[50:51]
    v_pk_add_f32 v[48:49], v[48:49], v[200:201]
    v_pk_fma_f32 v[50:51], v[200:201], v[200:201], v[50:51]
    v_pk_add_f32 v[48:49], v[48:49], v[202:203]
    v_pk_fma_f32 v[50:51], v[202:203], v[202:203], v[50:51]
    v_pk_add_f32 v[48:49], v[48:49], v[204:205]
    v_pk_fma_f32 v[50:51], v[204:205], v[204:205], v[50:51]
    v_pk_add_f32 v[48:49], v[48:49], v[206:207]
    v_pk_fma_f32 v[50:51], v[206:207], v[206:207], v[50:51]
    v_add_f32 v70, v48, v49
    v_add_f32 v71, v50, v51
    v_permlane32_swap_b32 v64, v65
    v_permlane32_swap_b32 v66, v67
    v_permlane32_swap_b32 v68, v69
    v_permlane32_swap_b32 v70, v71
    v_add_f32 v64, v64, v65
    v_add_f32 v66, v66, v67
    v_add_f32 v68, v68, v69
    v_add_f32 v70, v70, v71
    v_permlane16_swap_b32 v64, v66
    s_nop 0
    v_permlane16_swap_b32 v68, v70
    v_add_f32 v64, v64, v66
    v_add_f32_e64 v68, v68, v70
    buffer_atomic_add_f32 v64, v253, s[60:63], 0 offen offset:0 sc1
    buffer_atomic_add_f32 v68, v253, s[60:63], 0 offen offset:128 sc1
    s_waitcnt lgkmcnt(0)
    s_barrier
    ds_read_b64_tr_b16 v[32:33], v244 offset:0
    ds_read_b64_tr_b16 v[34:35], v244 offset:2048
    ds_read_b128 v[16:19], v242 offset:0
    ds_read_b128 v[20:23], v242 offset:2048
    ds_read_b128 v[24:27], v242 offset:4096
    ds_read_b128 v[28:31], v242 offset:6144
    ds_read_b64_tr_b16 v[36:37], v245 offset:0
    ds_read_b64_tr_b16 v[38:39], v245 offset:2048
    ds_read_b64_tr_b16 v[40:41], v246 offset:0
    ds_read_b64_tr_b16 v[42:43], v246 offset:2048
    ds_read_b64_tr_b16 v[44:45], v247 offset:0
    ds_read_b64_tr_b16 v[46:47], v247 offset:2048
    s_add_u32 s66, s66, 16384
    s_and_b32 s66, s66, 0xffff
    s_add_u32 s67, s67, 16384
    s_cmp_eq_u32 s67, 81920
    s_cselect_b32 s67, 0, s67
    s_waitcnt lgkmcnt(6)
    v_mfma_f32_16x16x32_bf16 v[80:83], v[32:35], v[16:19], 0
    ds_read_b64_tr_b16 v[64:65], v244 offset:4096
    v_mfma_f32_16x16x32_bf16 v[96:99], v[32:35], v[20:23], 0
    ds_read_b64_tr_b16 v[66:67], v244 offset:6144
    v_mfma_f32_16x16x32_bf16 v[112:115], v[32:35], v[24:27], 0
    ds_read_b128 v[48:51], v242 offset:1024
    v_mfma_f32_16x16x32_bf16 v[128:131], v[32:35], v[28:31], 0
    ds_read_b128 v[52:55], v242 offset:3072
    s_waitcnt lgkmcnt(4)
    v_mfma_f32_16x16x32_bf16 v[132:135], v[36:39], v[28:31], 0
    ds_read_b128 v[56:59], v242 offset:5120
    v_mfma_f32_16x16x32_bf16 v[116:119], v[36:39], v[24:27], 0
    ds_read_b128 v[60:63], v242 offset:7168
    v_mfma_f32_16x16x32_bf16 v[100:103], v[36:39], v[20:23], 0
    ds_read_b64_tr_b16 v[68:69], v245 offset:4096
    v_mfma_f32_16x16x32_bf16 v[84:87], v[36:39], v[16:19], 0
    ds_read_b64_tr_b16 v[70:71], v245 offset:6144
    v_mfma_f32_16x16x32_bf16 v[88:91], v[40:43], v[16:19], 0
    ds_read_b64_tr_b16 v[72:73], v246 offset:4096
    v_mfma_f32_16x16x32_bf16 v[104:107], v[40:43], v[20:23], 0
    ds_read_b64_tr_b16 v[74:75], v246 offset:6144
    v_mfma_f32_16x16x32_bf16 v[120:123], v[40:43], v[24:27], 0
    ds_read_b64_tr_b16 v[76:77], v247 offset:4096
    v_mfma_f32_16x16x32_bf16 v[136:139], v[40:43], v[28:31], 0
    ds_read_b64_tr_b16 v[78:79], v247 offset:6144
    v_mfma_f32_16x16x32_bf16 v[140:143], v[44:47], v[28:31], 0
    v_add_u32 v242, s66, v254
    v_mfma_f32_16x16x32_bf16 v[124:127], v[44:47], v[24:27], 0
    v_add_u32_e64 v244, s67, v255
    v_mfma_f32_16x16x32_bf16 v[108:111], v[44:47], v[20:23], 0
    v_xor_b32_e64 v245, 32, v244
    v_mfma_f32_16x16x32_bf16 v[92:95], v[44:47], v[16:19], 0
    v_xor_b32_e64 v246, 64, v244
    v_xor_b32 v247, 96, v244
    s_waitcnt lgkmcnt(0)
    v_mfma_f32_16x16x32_bf16 v[80:83], v[64:67], v[48:51], v[80:83]
    s_barrier
    v_mfma_f32_16x16x32_bf16 v[96:99], v[64:67], v[52:55], v[96:99]
    ds_read_b64_tr_b16 v[32:33], v244 offset:0
    v_mfma_f32_16x16x32_bf16 v[112:115], v[64:67], v[56:59], v[112:115]
    ds_read_b64_tr_b16 v[34:35], v244 offset:2048
    v_mfma_f32_16x16x32_bf16 v[128:131], v[64:67], v[60:63], v[128:131]
    ds_read_b128 v[16:19], v242 offset:0
    v_mfma_f32_16x16x32_bf16 v[132:135], v[68:71], v[60:63], v[132:135]
    ds_read_b128 v[20:23], v242 offset:2048
    v_mfma_f32_16x16x32_bf16 v[116:119], v[68:71], v[56:59], v[116:119]
    ds_read_b128 v[24:27], v242 offset:4096
    s_add_u32 s66, s66, 16384
    v_mfma_f32_16x16x32_bf16 v[100:103], v[68:71], v[52:55], v[100:103]
    ds_read_b128 v[28:31], v242 offset:6144
    s_and_b32 s66, s66, 0xffff
    v_mfma_f32_16x16x32_bf16 v[84:87], v[68:71], v[48:51], v[84:87]
    ds_read_b64_tr_b16 v[36:37], v245 offset:0
    s_add_u32 s67, s67, 16384
    v_mfma_f32_16x16x32_bf16 v[88:91], v[72:75], v[48:51], v[88:91]
    ds_read_b64_tr_b16 v[38:39], v245 offset:2048
    s_cmp_eq_u32 s67, 81920
    v_mfma_f32_16x16x32_bf16 v[104:107], v[72:75], v[52:55], v[104:107]
    ds_read_b64_tr_b16 v[40:41], v246 offset:0
    s_cselect_b32 s67, 0, s67
    v_mfma_f32_16x16x32_bf16 v[120:123], v[72:75], v[56:59], v[120:123]
    ds_read_b64_tr_b16 v[42:43], v246 offset:2048
    v_mfma_f32_16x16x32_bf16 v[136:139], v[72:75], v[60:63], v[136:139]
    ds_read_b64_tr_b16 v[44:45], v247 offset:0
    v_mfma_f32_16x16x32_bf16 v[140:143], v[76:79], v[60:63], v[140:143]
    ds_read_b64_tr_b16 v[46:47], v247 offset:2048
    v_mfma_f32_16x16x32_bf16 v[124:127], v[76:79], v[56:59], v[124:127]
    v_mfma_f32_16x16x32_bf16 v[108:111], v[76:79], v[52:55], v[108:111]
    v_mfma_f32_16x16x32_bf16 v[92:95], v[76:79], v[48:51], v[92:95]
    s_mov_b32 s68, 6
.p2align 6
.cl_176:
    s_waitcnt lgkmcnt(6)
    v_mfma_f32_16x16x32_bf16 v[80:83], v[32:35], v[16:19], v[80:83]
    ds_read_b64_tr_b16 v[64:65], v244 offset:4096
    v_mfma_f32_16x16x32_bf16 v[96:99], v[32:35], v[20:23], v[96:99]
    ds_read_b64_tr_b16 v[66:67], v244 offset:6144
    v_mfma_f32_16x16x32_bf16 v[112:115], v[32:35], v[24:27], v[112:115]
    ds_read_b128 v[48:51], v242 offset:1024
    v_mfma_f32_16x16x32_bf16 v[128:131], v[32:35], v[28:31], v[128:131]
    ds_read_b128 v[52:55], v242 offset:3072
    s_waitcnt lgkmcnt(4)
    v_mfma_f32_16x16x32_bf16 v[132:135], v[36:39], v[28:31], v[132:135]
    ds_read_b128 v[56:59], v242 offset:5120
    v_mfma_f32_16x16x32_bf16 v[116:119], v[36:39], v[24:27], v[116:119]
    ds_read_b128 v[60:63], v242 offset:7168
    v_mfma_f32_16x16x32_bf16 v[100:103], v[36:39], v[20:23], v[100:103]
    ds_read_b64_tr_b16 v[68:69], v245 offset:4096
    v_mfma_f32_16x16x32_bf16 v[84:87], v[36:39], v[16:19], v[84:87]
    ds_read_b64_tr_b16 v[70:71], v245 offset:6144
    v_mfma_f32_16x16x32_bf16 v[88:91], v[40:43], v[16:19], v[88:91]
    ds_read_b64_tr_b16 v[72:73], v246 offset:4096
    v_mfma_f32_16x16x32_bf16 v[104:107], v[40:43], v[20:23], v[104:107]
    ds_read_b64_tr_b16 v[74:75], v246 offset:6144
    v_mfma_f32_16x16x32_bf16 v[120:123], v[40:43], v[24:27], v[120:123]
    ds_read_b64_tr_b16 v[76:77], v247 offset:4096
    v_mfma_f32_16x16x32_bf16 v[136:139], v[40:43], v[28:31], v[136:139]
    ds_read_b64_tr_b16 v[78:79], v247 offset:6144
    v_mfma_f32_16x16x32_bf16 v[140:143], v[44:47], v[28:31], v[140:143]
    v_add_u32_e64 v242, s66, v254
    v_mfma_f32_16x16x32_bf16 v[124:127], v[44:47], v[24:27], v[124:127]
    v_add_u32_e64 v244, s67, v255
    v_mfma_f32_16x16x32_bf16 v[108:111], v[44:47], v[20:23], v[108:111]
    v_xor_b32_e64 v245, 32, v244
    v_mfma_f32_16x16x32_bf16 v[92:95], v[44:47], v[16:19], v[92:95]
    v_xor_b32_e64 v246, 64, v244
    v_xor_b32 v247, 96, v244
    s_waitcnt lgkmcnt(0)
    v_mfma_f32_16x16x32_bf16 v[80:83], v[64:67], v[48:51], v[80:83]
    s_waitcnt vmcnt(0)
    s_barrier
    v_mfma_f32_16x16x32_bf16 v[96:99], v[64:67], v[52:55], v[96:99]
    ds_read_b64_tr_b16 v[32:33], v244 offset:0
    v_mfma_f32_16x16x32_bf16 v[112:115], v[64:67], v[56:59], v[112:115]
    ds_read_b64_tr_b16 v[34:35], v244 offset:2048
    v_mfma_f32_16x16x32_bf16 v[128:131], v[64:67], v[60:63], v[128:131]
    ds_read_b128 v[16:19], v242 offset:0
    v_mfma_f32_16x16x32_bf16 v[132:135], v[68:71], v[60:63], v[132:135]
    ds_read_b128 v[20:23], v242 offset:2048
    v_mfma_f32_16x16x32_bf16 v[116:119], v[68:71], v[56:59], v[116:119]
    ds_read_b128 v[24:27], v242 offset:4096
    s_add_u32 s66, s66, 16384
    v_mfma_f32_16x16x32_bf16 v[100:103], v[68:71], v[52:55], v[100:103]
    ds_read_b128 v[28:31], v242 offset:6144
    s_and_b32 s66, s66, 0xffff
    v_mfma_f32_16x16x32_bf16 v[84:87], v[68:71], v[48:51], v[84:87]
    ds_read_b64_tr_b16 v[36:37], v245 offset:0
    s_add_u32 s67, s67, 16384
    v_mfma_f32_16x16x32_bf16 v[88:91], v[72:75], v[48:51], v[88:91]
    ds_read_b64_tr_b16 v[38:39], v245 offset:2048
    s_cmp_eq_u32 s67, 81920
    v_mfma_f32_16x16x32_bf16 v[104:107], v[72:75], v[52:55], v[104:107]
    ds_read_b64_tr_b16 v[40:41], v246 offset:0
    s_cselect_b32 s67, 0, s67
    v_mfma_f32_16x16x32_bf16 v[120:123], v[72:75], v[56:59], v[120:123]
    ds_read_b64_tr_b16 v[42:43], v246 offset:2048
    v_mfma_f32_16x16x32_bf16 v[136:139], v[72:75], v[60:63], v[136:139]
    ds_read_b64_tr_b16 v[44:45], v247 offset:0
    v_mfma_f32_16x16x32_bf16 v[140:143], v[76:79], v[60:63], v[140:143]
    ds_read_b64_tr_b16 v[46:47], v247 offset:2048
    v_mfma_f32_16x16x32_bf16 v[124:127], v[76:79], v[56:59], v[124:127]
    s_sub_u32 s68, s68, 1
    v_mfma_f32_16x16x32_bf16 v[108:111], v[76:79], v[52:55], v[108:111]
    s_cmp_lg_u32 s68, 0
    v_mfma_f32_16x16x32_bf16 v[92:95], v[76:79], v[48:51], v[92:95]
    s_cbranch_scc1 .cl_176
    s_waitcnt lgkmcnt(6)
    v_mfma_f32_16x16x32_bf16 v[80:83], v[32:35], v[16:19], v[80:83]
    ds_read_b64_tr_b16 v[64:65], v244 offset:4096
    v_mfma_f32_16x16x32_bf16 v[96:99], v[32:35], v[20:23], v[96:99]
    ds_read_b64_tr_b16 v[66:67], v244 offset:6144
    v_mfma_f32_16x16x32_bf16 v[112:115], v[32:35], v[24:27], v[112:115]
    ds_read_b128 v[48:51], v242 offset:1024
    v_mfma_f32_16x16x32_bf16 v[128:131], v[32:35], v[28:31], v[128:131]
    ds_read_b128 v[52:55], v242 offset:3072
    s_waitcnt lgkmcnt(4)
    v_mfma_f32_16x16x32_bf16 v[132:135], v[36:39], v[28:31], v[132:135]
    ds_read_b128 v[56:59], v242 offset:5120
    v_mfma_f32_16x16x32_bf16 v[116:119], v[36:39], v[24:27], v[116:119]
    ds_read_b128 v[60:63], v242 offset:7168
    v_mfma_f32_16x16x32_bf16 v[100:103], v[36:39], v[20:23], v[100:103]
    ds_read_b64_tr_b16 v[68:69], v245 offset:4096
    v_mfma_f32_16x16x32_bf16 v[84:87], v[36:39], v[16:19], v[84:87]
    ds_read_b64_tr_b16 v[70:71], v245 offset:6144
    v_mfma_f32_16x16x32_bf16 v[88:91], v[40:43], v[16:19], v[88:91]
    ds_read_b64_tr_b16 v[72:73], v246 offset:4096
    v_mfma_f32_16x16x32_bf16 v[104:107], v[40:43], v[20:23], v[104:107]
    ds_read_b64_tr_b16 v[74:75], v246 offset:6144
    v_mfma_f32_16x16x32_bf16 v[120:123], v[40:43], v[24:27], v[120:123]
    ds_read_b64_tr_b16 v[76:77], v247 offset:4096
    v_mfma_f32_16x16x32_bf16 v[136:139], v[40:43], v[28:31], v[136:139]
    ds_read_b64_tr_b16 v[78:79], v247 offset:6144
    v_mfma_f32_16x16x32_bf16 v[140:143], v[44:47], v[28:31], v[140:143]
    v_add_u32 v242, s66, v254
    v_mfma_f32_16x16x32_bf16 v[124:127], v[44:47], v[24:27], v[124:127]
    v_add_u32_e64 v244, s67, v255
    v_mfma_f32_16x16x32_bf16 v[108:111], v[44:47], v[20:23], v[108:111]
    v_xor_b32_e64 v245, 32, v244
    v_mfma_f32_16x16x32_bf16 v[92:95], v[44:47], v[16:19], v[92:95]
    v_xor_b32_e64 v246, 64, v244
    v_xor_b32 v247, 96, v244
    s_waitcnt lgkmcnt(0)
    v_mfma_f32_16x16x32_bf16 v[80:83], v[64:67], v[48:51], v[80:83]
    s_barrier
    v_mfma_f32_16x16x32_bf16 v[96:99], v[64:67], v[52:55], v[96:99]
    ds_read_b64_tr_b16 v[32:33], v244 offset:0
    v_mfma_f32_16x16x32_bf16 v[112:115], v[64:67], v[56:59], v[112:115]
    ds_read_b64_tr_b16 v[34:35], v244 offset:2048
    v_mfma_f32_16x16x32_bf16 v[128:131], v[64:67], v[60:63], v[128:131]
    ds_read_b128 v[16:19], v242 offset:0
    ds_read_b128 v[20:23], v242 offset:2048
    v_mfma_f32_16x16x32_bf16 v[132:135], v[68:71], v[60:63], v[132:135]
    ds_read_b128 v[24:27], v242 offset:4096
    v_mfma_f32_16x16x32_bf16 v[116:119], v[68:71], v[56:59], v[116:119]
    ds_read_b128 v[28:31], v242 offset:6144
    v_mfma_f32_16x16x32_bf16 v[100:103], v[68:71], v[52:55], v[100:103]
    ds_read_b64_tr_b16 v[36:37], v245 offset:0
    ds_read_b64_tr_b16 v[38:39], v245 offset:2048
    v_mfma_f32_16x16x32_bf16 v[84:87], v[68:71], v[48:51], v[84:87]
    ds_read_b64_tr_b16 v[40:41], v246 offset:0
    v_mfma_f32_16x16x32_bf16 v[88:91], v[72:75], v[48:51], v[88:91]
    ds_read_b64_tr_b16 v[42:43], v246 offset:2048
    v_mfma_f32_16x16x32_bf16 v[104:107], v[72:75], v[52:55], v[104:107]
    ds_read_b64_tr_b16 v[44:45], v247 offset:0
    ds_read_b64_tr_b16 v[46:47], v247 offset:2048
    v_mfma_f32_16x16x32_bf16 v[120:123], v[72:75], v[56:59], v[120:123]
    s_add_u32 s66, s66, 16384
    v_mfma_f32_16x16x32_bf16 v[136:139], v[72:75], v[60:63], v[136:139]
    s_and_b32 s66, s66, 0xffff
    v_mfma_f32_16x16x32_bf16 v[140:143], v[76:79], v[60:63], v[140:143]
    s_add_u32 s67, s67, 16384
    s_cmp_eq_u32 s67, 81920
    s_cselect_b32 s67, 0, s67
    v_mfma_f32_16x16x32_bf16 v[124:127], v[76:79], v[56:59], v[124:127]
    ds_read2_b32 v[232:233], v252 offset0:0 offset1:128
    v_mfma_f32_16x16x32_bf16 v[108:111], v[76:79], v[52:55], v[108:111]
    ds_read2_b32 v[234:235], v252 offset0:16 offset1:144
    v_mfma_f32_16x16x32_bf16 v[92:95], v[76:79], v[48:51], v[92:95]
    ds_read2_b32 v[236:237], v252 offset0:32 offset1:160
    ds_read2_b32 v[238:239], v252 offset0:48 offset1:176
    s_waitcnt lgkmcnt(0)
    v_mul_f32 v232, 0xba124925, v232
    v_mul_f32 v233, 0x3a124925, v233
    v_fma_f32 v233, -v232, v232, v233
    v_max_f32_e64 v233, 0, v233
    v_add_f32 v233, 0x3727c5ac, v233
    v_mul_f32 v234, 0xba124925, v234
    v_mul_f32 v235, 0x3a124925, v235
    v_fma_f32 v235, -v234, v234, v235
    v_max_f32_e64 v235, 0, v235
    v_add_f32 v235, 0x3727c5ac, v235
    v_mul_f32 v236, 0xba124925, v236
    v_mul_f32 v237, 0x3a124925, v237
    v_fma_f32 v237, -v236, v236, v237
    v_max_f32_e64 v237, 0, v237
    v_add_f32 v237, 0x3727c5ac, v237
    v_mul_f32 v238, 0xba124925, v238
    v_mul_f32 v239, 0x3a124925, v239
    v_fma_f32 v239, -v238, v238, v239
    v_max_f32_e64 v239, 0, v239
    v_add_f32 v239, 0x3727c5ac, v239
    v_rsq_f32 v233, v233
    v_rsq_f32 v235, v235
    v_rsq_f32 v237, v237
    v_rsq_f32 v239, v239
    v_mul_f32 v232, v232, v233
    v_mul_f32 v234, v234, v235
    v_mul_f32 v236, v236, v237
    v_mul_f32 v238, v238, v239
    v_pk_fma_f32 v[144:145], v[144:145], v[232:233], v[232:233] op_sel:[0,1,0] op_sel_hi:[1,1,0]
    v_pk_fma_f32 v[146:147], v[146:147], v[232:233], v[232:233] op_sel:[0,1,0] op_sel_hi:[1,1,0]
    v_pk_fma_f32 v[148:149], v[148:149], v[232:233], v[232:233] op_sel:[0,1,0] op_sel_hi:[1,1,0]
    v_pk_fma_f32 v[150:151], v[150:151], v[232:233], v[232:233] op_sel:[0,1,0] op_sel_hi:[1,1,0]
    v_pk_fma_f32 v[152:153], v[152:153], v[232:233], v[232:233] op_sel:[0,1,0] op_sel_hi:[1,1,0]
    v_pk_fma_f32 v[154:155], v[154:155], v[232:233], v[232:233] op_sel:[0,1,0] op_sel_hi:[1,1,0]
    v_pk_fma_f32 v[156:157], v[156:157], v[232:233], v[232:233] op_sel:[0,1,0] op_sel_hi:[1,1,0]
    v_pk_fma_f32 v[158:159], v[158:159], v[232:233], v[232:233] op_sel:[0,1,0] op_sel_hi:[1,1,0]
    v_cvt_pk_bf16_f32 v144, v144, v145
    v_cvt_pk_bf16_f32 v145, v146, v147
    v_cvt_pk_bf16_f32 v146, v148, v149
    v_cvt_pk_bf16_f32 v147, v150, v151
    v_cvt_pk_bf16_f32 v148, v152, v153
    v_cvt_pk_bf16_f32 v149, v154, v155
    v_cvt_pk_bf16_f32 v150, v156, v157
    v_cvt_pk_bf16_f32 v151, v158, v159
    v_permlane16_swap_b32 v144, v146
    v_permlane16_swap_b32 v145, v147
    v_permlane16_swap_b32 v148, v150
    v_permlane16_swap_b32 v149, v151
    buffer_store_dwordx4 v[144:147], v248, s[80:83], 0 offen offset:0 sc1
    buffer_store_dwordx4 v[148:151], v248, s[80:83], s84 offen offset:0 sc1
    v_pk_fma_f32 v[160:161], v[160:161], v[234:235], v[234:235] op_sel:[0,1,0] op_sel_hi:[1,1,0]
    v_pk_fma_f32 v[162:163], v[162:163], v[234:235], v[234:235] op_sel:[0,1,0] op_sel_hi:[1,1,0]
    v_pk_fma_f32 v[164:165], v[164:165], v[234:235], v[234:235] op_sel:[0,1,0] op_sel_hi:[1,1,0]
    v_pk_fma_f32 v[166:167], v[166:167], v[234:235], v[234:235] op_sel:[0,1,0] op_sel_hi:[1,1,0]
    v_pk_fma_f32 v[168:169], v[168:169], v[234:235], v[234:235] op_sel:[0,1,0] op_sel_hi:[1,1,0]
    v_pk_fma_f32 v[170:171], v[170:171], v[234:235], v[234:235] op_sel:[0,1,0] op_sel_hi:[1,1,0]
    v_pk_fma_f32 v[172:173], v[172:173], v[234:235], v[234:235] op_sel:[0,1,0] op_sel_hi:[1,1,0]
    v_pk_fma_f32 v[174:175], v[174:175], v[234:235], v[234:235] op_sel:[0,1,0] op_sel_hi:[1,1,0]
    v_cvt_pk_bf16_f32 v160, v160, v161
    v_cvt_pk_bf16_f32 v161, v162, v163
    v_cvt_pk_bf16_f32 v162, v164, v165
    v_cvt_pk_bf16_f32 v163, v166, v167
    v_cvt_pk_bf16_f32 v164, v168, v169
    v_cvt_pk_bf16_f32 v165, v170, v171
    v_cvt_pk_bf16_f32 v166, v172, v173
    v_cvt_pk_bf16_f32 v167, v174, v175
    v_permlane16_swap_b32 v160, v162
    v_permlane16_swap_b32 v161, v163
    v_permlane16_swap_b32 v164, v166
    v_permlane16_swap_b32 v165, v167
    buffer_store_dwordx4 v[160:163], v248, s[80:83], 0 offen offset:256 sc1
    buffer_store_dwordx4 v[164:167], v248, s[80:83], s84 offen offset:256 sc1
    v_pk_fma_f32 v[176:177], v[176:177], v[236:237], v[236:237] op_sel:[0,1,0] op_sel_hi:[1,1,0]
    v_pk_fma_f32 v[178:179], v[178:179], v[236:237], v[236:237] op_sel:[0,1,0] op_sel_hi:[1,1,0]
    v_pk_fma_f32 v[180:181], v[180:181], v[236:237], v[236:237] op_sel:[0,1,0] op_sel_hi:[1,1,0]
    v_pk_fma_f32 v[182:183], v[182:183], v[236:237], v[236:237] op_sel:[0,1,0] op_sel_hi:[1,1,0]
    v_pk_fma_f32 v[184:185], v[184:185], v[236:237], v[236:237] op_sel:[0,1,0] op_sel_hi:[1,1,0]
    v_pk_fma_f32 v[186:187], v[186:187], v[236:237], v[236:237] op_sel:[0,1,0] op_sel_hi:[1,1,0]
    v_pk_fma_f32 v[188:189], v[188:189], v[236:237], v[236:237] op_sel:[0,1,0] op_sel_hi:[1,1,0]
    v_pk_fma_f32 v[190:191], v[190:191], v[236:237], v[236:237] op_sel:[0,1,0] op_sel_hi:[1,1,0]
    v_cvt_pk_bf16_f32 v176, v176, v177
    v_cvt_pk_bf16_f32 v177, v178, v179
    v_cvt_pk_bf16_f32 v178, v180, v181
    v_cvt_pk_bf16_f32 v179, v182, v183
    v_cvt_pk_bf16_f32 v180, v184, v185
    v_cvt_pk_bf16_f32 v181, v186, v187
    v_cvt_pk_bf16_f32 v182, v188, v189
    v_cvt_pk_bf16_f32 v183, v190, v191
    v_permlane16_swap_b32 v176, v178
    v_permlane16_swap_b32 v177, v179
    v_permlane16_swap_b32 v180, v182
    v_permlane16_swap_b32 v181, v183
    buffer_store_dwordx4 v[176:179], v248, s[80:83], 0 offen offset:512 sc1
    buffer_store_dwordx4 v[180:183], v248, s[80:83], s84 offen offset:512 sc1
    v_pk_fma_f32 v[192:193], v[192:193], v[238:239], v[238:239] op_sel:[0,1,0] op_sel_hi:[1,1,0]
    v_pk_fma_f32 v[194:195], v[194:195], v[238:239], v[238:239] op_sel:[0,1,0] op_sel_hi:[1,1,0]
    v_pk_fma_f32 v[196:197], v[196:197], v[238:239], v[238:239] op_sel:[0,1,0] op_sel_hi:[1,1,0]
    v_pk_fma_f32 v[198:199], v[198:199], v[238:239], v[238:239] op_sel:[0,1,0] op_sel_hi:[1,1,0]
    v_pk_fma_f32 v[200:201], v[200:201], v[238:239], v[238:239] op_sel:[0,1,0] op_sel_hi:[1,1,0]
    v_pk_fma_f32 v[202:203], v[202:203], v[238:239], v[238:239] op_sel:[0,1,0] op_sel_hi:[1,1,0]
    v_pk_fma_f32 v[204:205], v[204:205], v[238:239], v[238:239] op_sel:[0,1,0] op_sel_hi:[1,1,0]
    v_pk_fma_f32 v[206:207], v[206:207], v[238:239], v[238:239] op_sel:[0,1,0] op_sel_hi:[1,1,0]
    v_cvt_pk_bf16_f32 v192, v192, v193
    v_cvt_pk_bf16_f32 v193, v194, v195
    v_cvt_pk_bf16_f32 v194, v196, v197
    v_cvt_pk_bf16_f32 v195, v198, v199
    v_cvt_pk_bf16_f32 v196, v200, v201
    v_cvt_pk_bf16_f32 v197, v202, v203
    v_cvt_pk_bf16_f32 v198, v204, v205
    v_cvt_pk_bf16_f32 v199, v206, v207
    v_permlane16_swap_b32 v192, v194
    v_permlane16_swap_b32 v193, v195
    v_permlane16_swap_b32 v196, v198
    v_permlane16_swap_b32 v197, v199
    buffer_store_dwordx4 v[192:195], v248, s[80:83], 0 offen offset:768 sc1
    buffer_store_dwordx4 v[196:199], v248, s[80:83], s84 offen offset:768 sc1
    s_mov_b32 s68, 3
.p2align 6
.cl_178:
    s_waitcnt lgkmcnt(6)
    v_mfma_f32_16x16x32_bf16 v[80:83], v[32:35], v[16:19], v[80:83]
    ds_read_b64_tr_b16 v[64:65], v244 offset:4096
    v_mfma_f32_16x16x32_bf16 v[96:99], v[32:35], v[20:23], v[96:99]
    ds_read_b64_tr_b16 v[66:67], v244 offset:6144
    v_mfma_f32_16x16x32_bf16 v[112:115], v[32:35], v[24:27], v[112:115]
    ds_read_b128 v[48:51], v242 offset:1024
    v_mfma_f32_16x16x32_bf16 v[128:131], v[32:35], v[28:31], v[128:131]
    ds_read_b128 v[52:55], v242 offset:3072
    s_waitcnt lgkmcnt(4)
    v_mfma_f32_16x16x32_bf16 v[132:135], v[36:39], v[28:31], v[132:135]
    ds_read_b128 v[56:59], v242 offset:5120
    v_mfma_f32_16x16x32_bf16 v[116:119], v[36:39], v[24:27], v[116:119]
    ds_read_b128 v[60:63], v242 offset:7168
    v_mfma_f32_16x16x32_bf16 v[100:103], v[36:39], v[20:23], v[100:103]
    ds_read_b64_tr_b16 v[68:69], v245 offset:4096
    v_mfma_f32_16x16x32_bf16 v[84:87], v[36:39], v[16:19], v[84:87]
    ds_read_b64_tr_b16 v[70:71], v245 offset:6144
    v_mfma_f32_16x16x32_bf16 v[88:91], v[40:43], v[16:19], v[88:91]
    ds_read_b64_tr_b16 v[72:73], v246 offset:4096
    v_mfma_f32_16x16x32_bf16 v[104:107], v[40:43], v[20:23], v[104:107]
    ds_read_b64_tr_b16 v[74:75], v246 offset:6144
    v_mfma_f32_16x16x32_bf16 v[120:123], v[40:43], v[24:27], v[120:123]
    ds_read_b64_tr_b16 v[76:77], v247 offset:4096
    v_mfma_f32_16x16x32_bf16 v[136:139], v[40:43], v[28:31], v[136:139]
    ds_read_b64_tr_b16 v[78:79], v247 offset:6144
    v_mfma_f32_16x16x32_bf16 v[140:143], v[44:47], v[28:31], v[140:143]
    v_add_u32_e64 v242, s66, v254
    v_mfma_f32_16x16x32_bf16 v[124:127], v[44:47], v[24:27], v[124:127]
    v_add_u32_e64 v244, s67, v255
    v_mfma_f32_16x16x32_bf16 v[108:111], v[44:47], v[20:23], v[108:111]
    v_xor_b32_e64 v245, 32, v244
    v_mfma_f32_16x16x32_bf16 v[92:95], v[44:47], v[16:19], v[92:95]
    v_xor_b32_e64 v246, 64, v244
    v_xor_b32 v247, 96, v244
    s_waitcnt lgkmcnt(0)
    v_mfma_f32_16x16x32_bf16 v[80:83], v[64:67], v[48:51], v[80:83]
    s_barrier
    v_mfma_f32_16x16x32_bf16 v[96:99], v[64:67], v[52:55], v[96:99]
    ds_read_b64_tr_b16 v[32:33], v244 offset:0
    v_mfma_f32_16x16x32_bf16 v[112:115], v[64:67], v[56:59], v[112:115]
    ds_read_b64_tr_b16 v[34:35], v244 offset:2048
    v_mfma_f32_16x16x32_bf16 v[128:131], v[64:67], v[60:63], v[128:131]
    ds_read_b128 v[16:19], v242 offset:0
    v_mfma_f32_16x16x32_bf16 v[132:135], v[68:71], v[60:63], v[132:135]
    ds_read_b128 v[20:23], v242 offset:2048
    v_mfma_f32_16x16x32_bf16 v[116:119], v[68:71], v[56:59], v[116:119]
    ds_read_b128 v[24:27], v242 offset:4096
    s_add_u32 s66, s66, 16384
    v_mfma_f32_16x16x32_bf16 v[100:103], v[68:71], v[52:55], v[100:103]
    ds_read_b128 v[28:31], v242 offset:6144
    s_and_b32 s66, s66, 0xffff
    v_mfma_f32_16x16x32_bf16 v[84:87], v[68:71], v[48:51], v[84:87]
    ds_read_b64_tr_b16 v[36:37], v245 offset:0
    s_add_u32 s67, s67, 16384
    v_mfma_f32_16x16x32_bf16 v[88:91], v[72:75], v[48:51], v[88:91]
    ds_read_b64_tr_b16 v[38:39], v245 offset:2048
    s_cmp_eq_u32 s67, 81920
    v_mfma_f32_16x16x32_bf16 v[104:107], v[72:75], v[52:55], v[104:107]
    ds_read_b64_tr_b16 v[40:41], v246 offset:0
    s_cselect_b32 s67, 0, s67
    v_mfma_f32_16x16x32_bf16 v[120:123], v[72:75], v[56:59], v[120:123]
    ds_read_b64_tr_b16 v[42:43], v246 offset:2048
    v_mfma_f32_16x16x32_bf16 v[136:139], v[72:75], v[60:63], v[136:139]
    ds_read_b64_tr_b16 v[44:45], v247 offset:0
    v_mfma_f32_16x16x32_bf16 v[140:143], v[76:79], v[60:63], v[140:143]
    ds_read_b64_tr_b16 v[46:47], v247 offset:2048
    v_mfma_f32_16x16x32_bf16 v[124:127], v[76:79], v[56:59], v[124:127]
    s_sub_u32 s68, s68, 1
    v_mfma_f32_16x16x32_bf16 v[108:111], v[76:79], v[52:55], v[108:111]
    s_cmp_lg_u32 s68, 0
    v_mfma_f32_16x16x32_bf16 v[92:95], v[76:79], v[48:51], v[92:95]
    s_cbranch_scc1 .cl_178
    s_mov_b32 s68, 4
    s_branch .pg_6
.p2align 12
.pad_6:
    s_nop 0
    s_setpc_b64 s[44:45]
.pg_6:
.p2align 6
.cl_180:
    s_waitcnt lgkmcnt(6)
    v_mfma_f32_16x16x32_bf16 v[80:83], v[32:35], v[16:19], v[80:83]
    ds_read_b64_tr_b16 v[64:65], v244 offset:4096
    v_mfma_f32_16x16x32_bf16 v[96:99], v[32:35], v[20:23], v[96:99]
    ds_read_b64_tr_b16 v[66:67], v244 offset:6144
    v_mfma_f32_16x16x32_bf16 v[112:115], v[32:35], v[24:27], v[112:115]
    ds_read_b128 v[48:51], v242 offset:1024
    v_mfma_f32_16x16x32_bf16 v[128:131], v[32:35], v[28:31], v[128:131]
    ds_read_b128 v[52:55], v242 offset:3072
    s_waitcnt lgkmcnt(4)
    v_mfma_f32_16x16x32_bf16 v[132:135], v[36:39], v[28:31], v[132:135]
    ds_read_b128 v[56:59], v242 offset:5120
    v_mfma_f32_16x16x32_bf16 v[116:119], v[36:39], v[24:27], v[116:119]
    ds_read_b128 v[60:63], v242 offset:7168
    v_mfma_f32_16x16x32_bf16 v[100:103], v[36:39], v[20:23], v[100:103]
    ds_read_b64_tr_b16 v[68:69], v245 offset:4096
    v_mfma_f32_16x16x32_bf16 v[84:87], v[36:39], v[16:19], v[84:87]
    ds_read_b64_tr_b16 v[70:71], v245 offset:6144
    v_mfma_f32_16x16x32_bf16 v[88:91], v[40:43], v[16:19], v[88:91]
    ds_read_b64_tr_b16 v[72:73], v246 offset:4096
    v_mfma_f32_16x16x32_bf16 v[104:107], v[40:43], v[20:23], v[104:107]
    ds_read_b64_tr_b16 v[74:75], v246 offset:6144
    v_mfma_f32_16x16x32_bf16 v[120:123], v[40:43], v[24:27], v[120:123]
    ds_read_b64_tr_b16 v[76:77], v247 offset:4096
    v_mfma_f32_16x16x32_bf16 v[136:139], v[40:43], v[28:31], v[136:139]
    ds_read_b64_tr_b16 v[78:79], v247 offset:6144
    v_mfma_f32_16x16x32_bf16 v[140:143], v[44:47], v[28:31], v[140:143]
    v_add_u32_e64 v242, s66, v254
    v_mfma_f32_16x16x32_bf16 v[124:127], v[44:47], v[24:27], v[124:127]
    v_add_u32_e64 v244, s67, v255
    v_mfma_f32_16x16x32_bf16 v[108:111], v[44:47], v[20:23], v[108:111]
    v_xor_b32_e64 v245, 32, v244
    v_mfma_f32_16x16x32_bf16 v[92:95], v[44:47], v[16:19], v[92:95]
    v_xor_b32_e64 v246, 64, v244
    v_xor_b32 v247, 96, v244
    s_waitcnt lgkmcnt(0)
    v_mfma_f32_16x16x32_bf16 v[80:83], v[64:67], v[48:51], v[80:83]
    s_waitcnt vmcnt(0)
    s_barrier
    v_mfma_f32_16x16x32_bf16 v[96:99], v[64:67], v[52:55], v[96:99]
    ds_read_b64_tr_b16 v[32:33], v244 offset:0
    v_mfma_f32_16x16x32_bf16 v[112:115], v[64:67], v[56:59], v[112:115]
    ds_read_b64_tr_b16 v[34:35], v244 offset:2048
    v_mfma_f32_16x16x32_bf16 v[128:131], v[64:67], v[60:63], v[128:131]
    ds_read_b128 v[16:19], v242 offset:0
    v_mfma_f32_16x16x32_bf16 v[132:135], v[68:71], v[60:63], v[132:135]
    ds_read_b128 v[20:23], v242 offset:2048
    v_mfma_f32_16x16x32_bf16 v[116:119], v[68:71], v[56:59], v[116:119]
    ds_read_b128 v[24:27], v242 offset:4096
    s_add_u32 s66, s66, 16384
    v_mfma_f32_16x16x32_bf16 v[100:103], v[68:71], v[52:55], v[100:103]
    ds_read_b128 v[28:31], v242 offset:6144
    s_and_b32 s66, s66, 0xffff
    v_mfma_f32_16x16x32_bf16 v[84:87], v[68:71], v[48:51], v[84:87]
    ds_read_b64_tr_b16 v[36:37], v245 offset:0
    s_add_u32 s67, s67, 16384
    v_mfma_f32_16x16x32_bf16 v[88:91], v[72:75], v[48:51], v[88:91]
    ds_read_b64_tr_b16 v[38:39], v245 offset:2048
    s_cmp_eq_u32 s67, 81920
    v_mfma_f32_16x16x32_bf16 v[104:107], v[72:75], v[52:55], v[104:107]
    ds_read_b64_tr_b16 v[40:41], v246 offset:0
    s_cselect_b32 s67, 0, s67
    v_mfma_f32_16x16x32_bf16 v[120:123], v[72:75], v[56:59], v[120:123]
    ds_read_b64_tr_b16 v[42:43], v246 offset:2048
    v_mfma_f32_16x16x32_bf16 v[136:139], v[72:75], v[60:63], v[136:139]
    ds_read_b64_tr_b16 v[44:45], v247 offset:0
    v_mfma_f32_16x16x32_bf16 v[140:143], v[76:79], v[60:63], v[140:143]
    ds_read_b64_tr_b16 v[46:47], v247 offset:2048
    v_mfma_f32_16x16x32_bf16 v[124:127], v[76:79], v[56:59], v[124:127]
    s_sub_u32 s68, s68, 1
    v_mfma_f32_16x16x32_bf16 v[108:111], v[76:79], v[52:55], v[108:111]
    s_cmp_lg_u32 s68, 0
    v_mfma_f32_16x16x32_bf16 v[92:95], v[76:79], v[48:51], v[92:95]
    s_cbranch_scc1 .cl_180
.code_c4:
    s_waitcnt lgkmcnt(6)
    v_mfma_f32_16x16x32_bf16 v[80:83], v[32:35], v[16:19], v[80:83]
    ds_read_b64_tr_b16 v[64:65], v244 offset:4096
    v_mfma_f32_16x16x32_bf16 v[96:99], v[32:35], v[20:23], v[96:99]
    ds_read_b64_tr_b16 v[66:67], v244 offset:6144
    v_mfma_f32_16x16x32_bf16 v[112:115], v[32:35], v[24:27], v[112:115]
    ds_read_b128 v[48:51], v242 offset:1024
    v_mfma_f32_16x16x32_bf16 v[128:131], v[32:35], v[28:31], v[128:131]
    ds_read_b128 v[52:55], v242 offset:3072
    s_waitcnt lgkmcnt(4)
    v_mfma_f32_16x16x32_bf16 v[132:135], v[36:39], v[28:31], v[132:135]
    ds_read_b128 v[56:59], v242 offset:5120
    v_mfma_f32_16x16x32_bf16 v[116:119], v[36:39], v[24:27], v[116:119]
    ds_read_b128 v[60:63], v242 offset:7168
    v_mfma_f32_16x16x32_bf16 v[100:103], v[36:39], v[20:23], v[100:103]
    ds_read_b64_tr_b16 v[68:69], v245 offset:4096
    v_mfma_f32_16x16x32_bf16 v[84:87], v[36:39], v[16:19], v[84:87]
    ds_read_b64_tr_b16 v[70:71], v245 offset:6144
    v_mfma_f32_16x16x32_bf16 v[88:91], v[40:43], v[16:19], v[88:91]
    ds_read_b64_tr_b16 v[72:73], v246 offset:4096
    v_mfma_f32_16x16x32_bf16 v[104:107], v[40:43], v[20:23], v[104:107]
    ds_read_b64_tr_b16 v[74:75], v246 offset:6144
    v_mfma_f32_16x16x32_bf16 v[120:123], v[40:43], v[24:27], v[120:123]
    ds_read_b64_tr_b16 v[76:77], v247 offset:4096
    v_mfma_f32_16x16x32_bf16 v[136:139], v[40:43], v[28:31], v[136:139]
    ds_read_b64_tr_b16 v[78:79], v247 offset:6144
    v_mfma_f32_16x16x32_bf16 v[140:143], v[44:47], v[28:31], v[140:143]
    v_mfma_f32_16x16x32_bf16 v[124:127], v[44:47], v[24:27], v[124:127]
    v_mfma_f32_16x16x32_bf16 v[108:111], v[44:47], v[20:23], v[108:111]
    v_mfma_f32_16x16x32_bf16 v[92:95], v[44:47], v[16:19], v[92:95]
    s_waitcnt lgkmcnt(0)
    v_mfma_f32_16x16x32_bf16 v[80:83], v[64:67], v[48:51], v[80:83]
    s_barrier
    s_nop 0
    v_mfma_f32_16x16x32_bf16 v[96:99], v[64:67], v[52:55], v[96:99]
    ds_read_b128 v[16:19], v251 offset:512
    ds_read_b128 v[20:23], v251 offset:576
    v_mfma_f32_16x16x32_bf16 v[112:115], v[64:67], v[56:59], v[112:115]
    ds_read_b128 v[24:27], v251 offset:640
    v_mfma_f32_16x16x32_bf16 v[128:131], v[64:67], v[60:63], v[128:131]
    ds_read_b128 v[28:31], v251 offset:704
    ds_read_b128 v[32:35], v250 offset:0
    v_mfma_f32_16x16x32_bf16 v[132:135], v[68:71], v[60:63], v[132:135]
    ds_read_b128 v[36:39], v250 offset:256
    v_mfma_f32_16x16x32_bf16 v[116:119], v[68:71], v[56:59], v[116:119]
    ds_read_b128 v[40:43], v250 offset:512
    ds_read_b128 v[44:47], v250 offset:768
    v_mfma_f32_16x16x32_bf16 v[100:103], v[68:71], v[52:55], v[100:103]
    v_lshlrev_b32_e64 v227, 16, v224
    v_mfma_f32_16x16x32_bf16 v[84:87], v[68:71], v[48:51], v[84:87]
    v_lshlrev_b32 v226, 16, v224
    v_lshlrev_b32 v225, 16, v224
    v_mfma_f32_16x16x32_bf16 v[88:91], v[72:75], v[48:51], v[88:91]
    v_lshlrev_b32 v224, 16, v224
    v_lshlrev_b32 v231, 16, v228
    v_mfma_f32_16x16x32_bf16 v[104:107], v[72:75], v[52:55], v[104:107]
    v_lshlrev_b32_e64 v230, 16, v228
    v_mfma_f32_16x16x32_bf16 v[120:123], v[72:75], v[56:59], v[120:123]
    v_lshlrev_b32 v229, 16, v228
    v_lshlrev_b32 v228, 16, v228
    v_mfma_f32_16x16x32_bf16 v[136:139], v[72:75], v[60:63], v[136:139]
    v_lshlrev_b32_e64 v235, 16, v240
    v_mfma_f32_16x16x32_bf16 v[140:143], v[76:79], v[60:63], v[140:143]
    v_lshlrev_b32 v234, 16, v240
    v_lshlrev_b32 v233, 16, v240
    v_mfma_f32_16x16x32_bf16 v[124:127], v[76:79], v[56:59], v[124:127]
    v_lshlrev_b32_e64 v232, 16, v240
    v_mfma_f32_16x16x32_bf16 v[108:111], v[76:79], v[52:55], v[108:111]
    v_lshlrev_b32 v239, 16, v241
    v_lshlrev_b32 v238, 16, v241
    v_mfma_f32_16x16x32_bf16 v[92:95], v[76:79], v[48:51], v[92:95]
    v_lshlrev_b32 v237, 16, v241
    v_lshlrev_b32 v236, 16, v241
    s_lshl_b32 s28, s64, 13
    v_bfe_u32 v4, v10, 1, 3
    v_xor_b32 v4, v4, v11
    v_lshlrev_b32_e64 v4, 4, v4
    v_lshl_add_u32 v4, v10, 7, v4
    v_add_u32 v242, s28, v4
    v_xor_b32 v243, 64, v242
    v_lshrrev_b32_e64 v4, 2, v10
    v_lshl_add_u32 v4, v11, 3, v4
    v_bfe_u32 v5, v1, 1, 1
    v_lshl_add_u32 v4, v5, 2, v4
    v_lshlrev_b32_e64 v4, 4, v4
    v_lshl_add_u32 v4, v5, 10, v4
    v_and_b32_e64 v5, 1, v1
    v_lshl_add_u32 v4, v5, 3, v4
    s_lshl_b32 s28, s65, 13
    s_add_u32 s28, s28, 65536
    v_add_u32 v244, s28, v4
    v_xor_b32 v245, 64, v244
    v_mov_b32 v254, v242
    v_mov_b32 v255, v244
    s_mov_b32 s66, 0
    s_mov_b32 s67, 0
    s_waitcnt lgkmcnt(0)
    v_pk_fma_f32 v[80:81], v[16:17], v[32:33], v[80:81] op_sel:[0,1,0] op_sel_hi:[1,1,1]
    v_pk_fma_f32 v[82:83], v[18:19], v[32:33], v[82:83] op_sel:[0,1,0] op_sel_hi:[1,1,1]
    v_pk_fma_f32 v[84:85], v[20:21], v[32:33], v[84:85] op_sel:[0,1,0] op_sel_hi:[1,1,1]
    v_pk_fma_f32 v[86:87], v[22:23], v[32:33], v[86:87] op_sel:[0,1,0] op_sel_hi:[1,1,1]
    v_pk_fma_f32 v[88:89], v[24:25], v[32:33], v[88:89] op_sel:[0,1,0] op_sel_hi:[1,1,1]
    v_pk_fma_f32 v[90:91], v[26:27], v[32:33], v[90:91] op_sel:[0,1,0] op_sel_hi:[1,1,1]
    v_pk_fma_f32 v[92:93], v[28:29], v[32:33], v[92:93] op_sel:[0,1,0] op_sel_hi:[1,1,1]
    v_pk_fma_f32 v[94:95], v[30:31], v[32:33], v[94:95] op_sel:[0,1,0] op_sel_hi:[1,1,1]
    v_pk_mul_f32 v[48:49], v[80:81], v[80:81]
    v_pk_mul_f32 v[50:51], v[82:83], v[82:83]
    v_pk_mul_f32 v[52:53], v[84:85], v[84:85]
    v_pk_mul_f32 v[54:55], v[86:87], v[86:87]
    v_pk_mul_f32 v[56:57], v[88:89], v[88:89]
    v_pk_mul_f32 v[58:59], v[90:91], v[90:91]
    v_pk_mul_f32 v[60:61], v[92:93], v[92:93]
    v_pk_mul_f32 v[62:63], v[94:95], v[94:95]
    v_pk_fma_f32 v[48:49], v[48:49], v[34:35], v[34:35] op_sel:[0,0,1] op_sel_hi:[1,0,1]
    v_pk_fma_f32 v[50:51], v[50:51], v[34:35], v[34:35] op_sel:[0,0,1] op_sel_hi:[1,0,1]
    v_pk_fma_f32 v[52:53], v[52:53], v[34:35], v[34:35] op_sel:[0,0,1] op_sel_hi:[1,0,1]
    v_pk_fma_f32 v[54:55], v[54:55], v[34:35], v[34:35] op_sel:[0,0,1] op_sel_hi:[1,0,1]
    v_pk_fma_f32 v[56:57], v[56:57], v[34:35], v[34:35] op_sel:[0,0,1] op_sel_hi:[1,0,1]
    v_pk_fma_f32 v[58:59], v[58:59], v[34:35], v[34:35] op_sel:[0,0,1] op_sel_hi:[1,0,1]
    v_pk_fma_f32 v[60:61], v[60:61], v[34:35], v[34:35] op_sel:[0,0,1] op_sel_hi:[1,0,1]
    v_pk_fma_f32 v[62:63], v[62:63], v[34:35], v[34:35] op_sel:[0,0,1] op_sel_hi:[1,0,1]
    v_pk_mul_f32 v[48:49], v[48:49], v[80:81]
    v_pk_mul_f32 v[50:51], v[50:51], v[82:83]
    v_pk_mul_f32 v[52:53], v[52:53], v[84:85]
    v_pk_mul_f32 v[54:55], v[54:55], v[86:87]
    v_pk_mul_f32 v[56:57], v[56:57], v[88:89]
    v_pk_mul_f32 v[58:59], v[58:59], v[90:91]
    v_pk_mul_f32 v[60:61], v[60:61], v[92:93]
    v_pk_mul_f32 v[62:63], v[62:63], v[94:95]
    v_exp_f32 v48, v48
    v_exp_f32 v49, v49
    v_exp_f32 v50, v50
    v_exp_f32 v51, v51
    v_exp_f32 v52, v52
    v_exp_f32 v53, v53
    v_exp_f32 v54, v54
    v_exp_f32 v55, v55
    v_exp_f32 v56, v56
    v_exp_f32 v57, v57
    v_exp_f32 v58, v58
    v_exp_f32 v59, v59
    v_exp_f32 v60, v60
    v_exp_f32 v61, v61
    v_exp_f32 v62, v62
    v_exp_f32 v63, v63
    v_pk_fma_f32 v[48:49], v[48:49], v[32:33], v[32:33] op_sel_hi:[1,0,0]
    v_pk_fma_f32 v[50:51], v[50:51], v[32:33], v[32:33] op_sel_hi:[1,0,0]
    v_pk_fma_f32 v[52:53], v[52:53], v[32:33], v[32:33] op_sel_hi:[1,0,0]
    v_pk_fma_f32 v[54:55], v[54:55], v[32:33], v[32:33] op_sel_hi:[1,0,0]
    v_pk_fma_f32 v[56:57], v[56:57], v[32:33], v[32:33] op_sel_hi:[1,0,0]
    v_pk_fma_f32 v[58:59], v[58:59], v[32:33], v[32:33] op_sel_hi:[1,0,0]
    v_pk_fma_f32 v[60:61], v[60:61], v[32:33], v[32:33] op_sel_hi:[1,0,0]
    v_pk_fma_f32 v[62:63], v[62:63], v[32:33], v[32:33] op_sel_hi:[1,0,0]
    v_rcp_f32 v48, v48
    v_rcp_f32 v49, v49
    v_rcp_f32 v50, v50
    v_rcp_f32 v51, v51
    v_rcp_f32 v52, v52
    v_rcp_f32 v53, v53
    v_rcp_f32 v54, v54
    v_rcp_f32 v55, v55
    v_rcp_f32 v56, v56
    v_rcp_f32 v57, v57
    v_rcp_f32 v58, v58
    v_rcp_f32 v59, v59
    v_rcp_f32 v60, v60
    v_rcp_f32 v61, v61
    v_rcp_f32 v62, v62
    v_rcp_f32 v63, v63
    v_pk_mul_f32 v[80:81], v[80:81], v[48:49]
    v_pk_mul_f32 v[82:83], v[82:83], v[50:51]
    v_pk_mul_f32 v[84:85], v[84:85], v[52:53]
    v_pk_mul_f32 v[86:87], v[86:87], v[54:55]
    v_pk_mul_f32 v[88:89], v[88:89], v[56:57]
    v_pk_mul_f32 v[90:91], v[90:91], v[58:59]
    v_pk_mul_f32 v[92:93], v[92:93], v[60:61]
    v_pk_mul_f32 v[94:95], v[94:95], v[62:63]
    v_pk_fma_f32 v[96:97], v[16:17], v[36:37], v[96:97] op_sel:[0,1,0] op_sel_hi:[1,1,1]
    v_pk_fma_f32 v[98:99], v[18:19], v[36:37], v[98:99] op_sel:[0,1,0] op_sel_hi:[1,1,1]
    v_pk_fma_f32 v[100:101], v[20:21], v[36:37], v[100:101] op_sel:[0,1,0] op_sel_hi:[1,1,1]
    v_pk_fma_f32 v[102:103], v[22:23], v[36:37], v[102:103] op_sel:[0,1,0] op_sel_hi:[1,1,1]
    v_pk_fma_f32 v[104:105], v[24:25], v[36:37], v[104:105] op_sel:[0,1,0] op_sel_hi:[1,1,1]
    v_pk_fma_f32 v[106:107], v[26:27], v[36:37], v[106:107] op_sel:[0,1,0] op_sel_hi:[1,1,1]
    v_pk_fma_f32 v[108:109], v[28:29], v[36:37], v[108:109] op_sel:[0,1,0] op_sel_hi:[1,1,1]
    v_pk_fma_f32 v[110:111], v[30:31], v[36:37], v[110:111] op_sel:[0,1,0] op_sel_hi:[1,1,1]
    v_pk_mul_f32 v[48:49], v[96:97], v[96:97]
    v_pk_mul_f32 v[50:51], v[98:99], v[98:99]
    v_pk_mul_f32 v[52:53], v[100:101], v[100:101]
    v_pk_mul_f32 v[54:55], v[102:103], v[102:103]
    v_pk_mul_f32 v[56:57], v[104:105], v[104:105]
    v_pk_mul_f32 v[58:59], v[106:107], v[106:107]
    v_pk_mul_f32 v[60:61], v[108:109], v[108:109]
    v_pk_mul_f32 v[62:63], v[110:111], v[110:111]
    v_pk_fma_f32 v[48:49], v[48:49], v[38:39], v[38:39] op_sel:[0,0,1] op_sel_hi:[1,0,1]
    v_pk_fma_f32 v[50:51], v[50:51], v[38:39], v[38:39] op_sel:[0,0,1] op_sel_hi:[1,0,1]
    v_pk_fma_f32 v[52:53], v[52:53], v[38:39], v[38:39] op_sel:[0,0,1] op_sel_hi:[1,0,1]
    v_pk_fma_f32 v[54:55], v[54:55], v[38:39], v[38:39] op_sel:[0,0,1] op_sel_hi:[1,0,1]
    v_pk_fma_f32 v[56:57], v[56:57], v[38:39], v[38:39] op_sel:[0,0,1] op_sel_hi:[1,0,1]
    v_pk_fma_f32 v[58:59], v[58:59], v[38:39], v[38:39] op_sel:[0,0,1] op_sel_hi:[1,0,1]
    v_pk_fma_f32 v[60:61], v[60:61], v[38:39], v[38:39] op_sel:[0,0,1] op_sel_hi:[1,0,1]
    v_pk_fma_f32 v[62:63], v[62:63], v[38:39], v[38:39] op_sel:[0,0,1] op_sel_hi:[1,0,1]
    v_pk_mul_f32 v[48:49], v[48:49], v[96:97]
    v_pk_mul_f32 v[50:51], v[50:51], v[98:99]
    v_pk_mul_f32 v[52:53], v[52:53], v[100:101]
    v_pk_mul_f32 v[54:55], v[54:55], v[102:103]
    v_pk_mul_f32 v[56:57], v[56:57], v[104:105]
    v_pk_mul_f32 v[58:59], v[58:59], v[106:107]
    v_pk_mul_f32 v[60:61], v[60:61], v[108:109]
    v_pk_mul_f32 v[62:63], v[62:63], v[110:111]
    v_exp_f32 v48, v48
    v_exp_f32 v49, v49
    v_exp_f32 v50, v50
    v_exp_f32 v51, v51
    v_exp_f32 v52, v52
    v_exp_f32 v53, v53
    v_exp_f32 v54, v54
    v_exp_f32 v55, v55
    v_exp_f32 v56, v56
    v_exp_f32 v57, v57
    v_exp_f32 v58, v58
    v_exp_f32 v59, v59
    v_exp_f32 v60, v60
    v_exp_f32 v61, v61
    v_exp_f32 v62, v62
    v_exp_f32 v63, v63
    v_pk_fma_f32 v[48:49], v[48:49], v[36:37], v[36:37] op_sel_hi:[1,0,0]
    v_pk_fma_f32 v[50:51], v[50:51], v[36:37], v[36:37] op_sel_hi:[1,0,0]
    v_pk_fma_f32 v[52:53], v[52:53], v[36:37], v[36:37] op_sel_hi:[1,0,0]
    v_pk_fma_f32 v[54:55], v[54:55], v[36:37], v[36:37] op_sel_hi:[1,0,0]
    v_pk_fma_f32 v[56:57], v[56:57], v[36:37], v[36:37] op_sel_hi:[1,0,0]
    v_pk_fma_f32 v[58:59], v[58:59], v[36:37], v[36:37] op_sel_hi:[1,0,0]
    v_pk_fma_f32 v[60:61], v[60:61], v[36:37], v[36:37] op_sel_hi:[1,0,0]
    v_pk_fma_f32 v[62:63], v[62:63], v[36:37], v[36:37] op_sel_hi:[1,0,0]
    v_rcp_f32 v48, v48
    v_rcp_f32 v49, v49
    v_rcp_f32 v50, v50
    v_rcp_f32 v51, v51
    v_rcp_f32 v52, v52
    v_rcp_f32 v53, v53
    v_rcp_f32 v54, v54
    v_rcp_f32 v55, v55
    v_rcp_f32 v56, v56
    v_rcp_f32 v57, v57
    v_rcp_f32 v58, v58
    v_rcp_f32 v59, v59
    v_rcp_f32 v60, v60
    v_rcp_f32 v61, v61
    v_rcp_f32 v62, v62
    v_rcp_f32 v63, v63
    v_pk_mul_f32 v[96:97], v[96:97], v[48:49]
    v_pk_mul_f32 v[98:99], v[98:99], v[50:51]
    v_pk_mul_f32 v[100:101], v[100:101], v[52:53]
    v_pk_mul_f32 v[102:103], v[102:103], v[54:55]
    v_pk_mul_f32 v[104:105], v[104:105], v[56:57]
    v_pk_mul_f32 v[106:107], v[106:107], v[58:59]
    v_pk_mul_f32 v[108:109], v[108:109], v[60:61]
    v_pk_mul_f32 v[110:111], v[110:111], v[62:63]
    v_pk_fma_f32 v[112:113], v[16:17], v[40:41], v[112:113] op_sel:[0,1,0] op_sel_hi:[1,1,1]
    v_pk_fma_f32 v[114:115], v[18:19], v[40:41], v[114:115] op_sel:[0,1,0] op_sel_hi:[1,1,1]
    v_pk_fma_f32 v[116:117], v[20:21], v[40:41], v[116:117] op_sel:[0,1,0] op_sel_hi:[1,1,1]
    v_pk_fma_f32 v[118:119], v[22:23], v[40:41], v[118:119] op_sel:[0,1,0] op_sel_hi:[1,1,1]
    v_pk_fma_f32 v[120:121], v[24:25], v[40:41], v[120:121] op_sel:[0,1,0] op_sel_hi:[1,1,1]
    v_pk_fma_f32 v[122:123], v[26:27], v[40:41], v[122:123] op_sel:[0,1,0] op_sel_hi:[1,1,1]
    v_pk_fma_f32 v[124:125], v[28:29], v[40:41], v[124:125] op_sel:[0,1,0] op_sel_hi:[1,1,1]
    v_pk_fma_f32 v[126:127], v[30:31], v[40:41], v[126:127] op_sel:[0,1,0] op_sel_hi:[1,1,1]
    v_pk_mul_f32 v[48:49], v[112:113], v[112:113]
    v_pk_mul_f32 v[50:51], v[114:115], v[114:115]
    v_pk_mul_f32 v[52:53], v[116:117], v[116:117]
    v_pk_mul_f32 v[54:55], v[118:119], v[118:119]
    v_pk_mul_f32 v[56:57], v[120:121], v[120:121]
    v_pk_mul_f32 v[58:59], v[122:123], v[122:123]
    v_pk_mul_f32 v[60:61], v[124:125], v[124:125]
    v_pk_mul_f32 v[62:63], v[126:127], v[126:127]
    v_pk_fma_f32 v[48:49], v[48:49], v[42:43], v[42:43] op_sel:[0,0,1] op_sel_hi:[1,0,1]
    v_pk_fma_f32 v[50:51], v[50:51], v[42:43], v[42:43] op_sel:[0,0,1] op_sel_hi:[1,0,1]
    v_pk_fma_f32 v[52:53], v[52:53], v[42:43], v[42:43] op_sel:[0,0,1] op_sel_hi:[1,0,1]
    v_pk_fma_f32 v[54:55], v[54:55], v[42:43], v[42:43] op_sel:[0,0,1] op_sel_hi:[1,0,1]
    v_pk_fma_f32 v[56:57], v[56:57], v[42:43], v[42:43] op_sel:[0,0,1] op_sel_hi:[1,0,1]
    v_pk_fma_f32 v[58:59], v[58:59], v[42:43], v[42:43] op_sel:[0,0,1] op_sel_hi:[1,0,1]
    v_pk_fma_f32 v[60:61], v[60:61], v[42:43], v[42:43] op_sel:[0,0,1] op_sel_hi:[1,0,1]
    v_pk_fma_f32 v[62:63], v[62:63], v[42:43], v[42:43] op_sel:[0,0,1] op_sel_hi:[1,0,1]
    v_pk_mul_f32 v[48:49], v[48:49], v[112:113]
    v_pk_mul_f32 v[50:51], v[50:51], v[114:115]
    v_pk_mul_f32 v[52:53], v[52:53], v[116:117]
    v_pk_mul_f32 v[54:55], v[54:55], v[118:119]
    v_pk_mul_f32 v[56:57], v[56:57], v[120:121]
    v_pk_mul_f32 v[58:59], v[58:59], v[122:123]
    v_pk_mul_f32 v[60:61], v[60:61], v[124:125]
    v_pk_mul_f32 v[62:63], v[62:63], v[126:127]
    v_exp_f32 v48, v48
    v_exp_f32 v49, v49
    v_exp_f32 v50, v50
    v_exp_f32 v51, v51
    v_exp_f32 v52, v52
    v_exp_f32 v53, v53
    v_exp_f32 v54, v54
    v_exp_f32 v55, v55
    v_exp_f32 v56, v56
    v_exp_f32 v57, v57
    v_exp_f32 v58, v58
    v_exp_f32 v59, v59
    v_exp_f32 v60, v60
    v_exp_f32 v61, v61
    v_exp_f32 v62, v62
    v_exp_f32 v63, v63
    v_pk_fma_f32 v[48:49], v[48:49], v[40:41], v[40:41] op_sel_hi:[1,0,0]
    v_pk_fma_f32 v[50:51], v[50:51], v[40:41], v[40:41] op_sel_hi:[1,0,0]
    v_pk_fma_f32 v[52:53], v[52:53], v[40:41], v[40:41] op_sel_hi:[1,0,0]
    v_pk_fma_f32 v[54:55], v[54:55], v[40:41], v[40:41] op_sel_hi:[1,0,0]
    v_pk_fma_f32 v[56:57], v[56:57], v[40:41], v[40:41] op_sel_hi:[1,0,0]
    v_pk_fma_f32 v[58:59], v[58:59], v[40:41], v[40:41] op_sel_hi:[1,0,0]
    v_pk_fma_f32 v[60:61], v[60:61], v[40:41], v[40:41] op_sel_hi:[1,0,0]
    v_pk_fma_f32 v[62:63], v[62:63], v[40:41], v[40:41] op_sel_hi:[1,0,0]
    v_rcp_f32 v48, v48
    v_rcp_f32 v49, v49
    v_rcp_f32 v50, v50
    v_rcp_f32 v51, v51
    v_rcp_f32 v52, v52
    v_rcp_f32 v53, v53
    v_rcp_f32 v54, v54
    v_rcp_f32 v55, v55
    v_rcp_f32 v56, v56
    v_rcp_f32 v57, v57
    v_rcp_f32 v58, v58
    v_rcp_f32 v59, v59
    v_rcp_f32 v60, v60
    v_rcp_f32 v61, v61
    v_rcp_f32 v62, v62
    v_rcp_f32 v63, v63
    v_pk_mul_f32 v[112:113], v[112:113], v[48:49]
    v_pk_mul_f32 v[114:115], v[114:115], v[50:51]
    v_pk_mul_f32 v[116:117], v[116:117], v[52:53]
    v_pk_mul_f32 v[118:119], v[118:119], v[54:55]
    v_pk_mul_f32 v[120:121], v[120:121], v[56:57]
    v_pk_mul_f32 v[122:123], v[122:123], v[58:59]
    v_pk_mul_f32 v[124:125], v[124:125], v[60:61]
    v_pk_mul_f32 v[126:127], v[126:127], v[62:63]
    v_pk_fma_f32 v[128:129], v[16:17], v[44:45], v[128:129] op_sel:[0,1,0] op_sel_hi:[1,1,1]
    v_pk_fma_f32 v[130:131], v[18:19], v[44:45], v[130:131] op_sel:[0,1,0] op_sel_hi:[1,1,1]
    v_pk_fma_f32 v[132:133], v[20:21], v[44:45], v[132:133] op_sel:[0,1,0] op_sel_hi:[1,1,1]
    v_pk_fma_f32 v[134:135], v[22:23], v[44:45], v[134:135] op_sel:[0,1,0] op_sel_hi:[1,1,1]
    v_pk_fma_f32 v[136:137], v[24:25], v[44:45], v[136:137] op_sel:[0,1,0] op_sel_hi:[1,1,1]
    v_pk_fma_f32 v[138:139], v[26:27], v[44:45], v[138:139] op_sel:[0,1,0] op_sel_hi:[1,1,1]
    v_pk_fma_f32 v[140:141], v[28:29], v[44:45], v[140:141] op_sel:[0,1,0] op_sel_hi:[1,1,1]
    v_pk_fma_f32 v[142:143], v[30:31], v[44:45], v[142:143] op_sel:[0,1,0] op_sel_hi:[1,1,1]
    v_pk_mul_f32 v[48:49], v[128:129], v[128:129]
    v_pk_mul_f32 v[50:51], v[130:131], v[130:131]
    v_pk_mul_f32 v[52:53], v[132:133], v[132:133]
    v_pk_mul_f32 v[54:55], v[134:135], v[134:135]
    v_pk_mul_f32 v[56:57], v[136:137], v[136:137]
    v_pk_mul_f32 v[58:59], v[138:139], v[138:139]
    v_pk_mul_f32 v[60:61], v[140:141], v[140:141]
    v_pk_mul_f32 v[62:63], v[142:143], v[142:143]
    v_pk_fma_f32 v[48:49], v[48:49], v[46:47], v[46:47] op_sel:[0,0,1] op_sel_hi:[1,0,1]
    v_pk_fma_f32 v[50:51], v[50:51], v[46:47], v[46:47] op_sel:[0,0,1] op_sel_hi:[1,0,1]
    v_pk_fma_f32 v[52:53], v[52:53], v[46:47], v[46:47] op_sel:[0,0,1] op_sel_hi:[1,0,1]
    v_pk_fma_f32 v[54:55], v[54:55], v[46:47], v[46:47] op_sel:[0,0,1] op_sel_hi:[1,0,1]
    v_pk_fma_f32 v[56:57], v[56:57], v[46:47], v[46:47] op_sel:[0,0,1] op_sel_hi:[1,0,1]
    v_pk_fma_f32 v[58:59], v[58:59], v[46:47], v[46:47] op_sel:[0,0,1] op_sel_hi:[1,0,1]
    v_pk_fma_f32 v[60:61], v[60:61], v[46:47], v[46:47] op_sel:[0,0,1] op_sel_hi:[1,0,1]
    v_pk_fma_f32 v[62:63], v[62:63], v[46:47], v[46:47] op_sel:[0,0,1] op_sel_hi:[1,0,1]
    v_pk_mul_f32 v[48:49], v[48:49], v[128:129]
    v_pk_mul_f32 v[50:51], v[50:51], v[130:131]
    v_pk_mul_f32 v[52:53], v[52:53], v[132:133]
    v_pk_mul_f32 v[54:55], v[54:55], v[134:135]
    v_pk_mul_f32 v[56:57], v[56:57], v[136:137]
    v_pk_mul_f32 v[58:59], v[58:59], v[138:139]
    v_pk_mul_f32 v[60:61], v[60:61], v[140:141]
    v_pk_mul_f32 v[62:63], v[62:63], v[142:143]
    v_exp_f32 v48, v48
    v_exp_f32 v49, v49
    v_exp_f32 v50, v50
    v_exp_f32 v51, v51
    v_exp_f32 v52, v52
    v_exp_f32 v53, v53
    v_exp_f32 v54, v54
    v_exp_f32 v55, v55
    v_exp_f32 v56, v56
    v_exp_f32 v57, v57
    v_exp_f32 v58, v58
    v_exp_f32 v59, v59
    v_exp_f32 v60, v60
    v_exp_f32 v61, v61
    v_exp_f32 v62, v62
    v_exp_f32 v63, v63
    v_pk_fma_f32 v[48:49], v[48:49], v[44:45], v[44:45] op_sel_hi:[1,0,0]
    v_pk_fma_f32 v[50:51], v[50:51], v[44:45], v[44:45] op_sel_hi:[1,0,0]
    v_pk_fma_f32 v[52:53], v[52:53], v[44:45], v[44:45] op_sel_hi:[1,0,0]
    v_pk_fma_f32 v[54:55], v[54:55], v[44:45], v[44:45] op_sel_hi:[1,0,0]
    v_pk_fma_f32 v[56:57], v[56:57], v[44:45], v[44:45] op_sel_hi:[1,0,0]
    v_pk_fma_f32 v[58:59], v[58:59], v[44:45], v[44:45] op_sel_hi:[1,0,0]
    v_pk_fma_f32 v[60:61], v[60:61], v[44:45], v[44:45] op_sel_hi:[1,0,0]
    v_pk_fma_f32 v[62:63], v[62:63], v[44:45], v[44:45] op_sel_hi:[1,0,0]
    v_rcp_f32 v48, v48
    v_rcp_f32 v49, v49
    v_rcp_f32 v50, v50
    v_rcp_f32 v51, v51
    v_rcp_f32 v52, v52
    v_rcp_f32 v53, v53
    v_rcp_f32 v54, v54
    v_rcp_f32 v55, v55
    v_rcp_f32 v56, v56
    v_rcp_f32 v57, v57
    v_rcp_f32 v58, v58
    v_rcp_f32 v59, v59
    v_rcp_f32 v60, v60
    v_rcp_f32 v61, v61
    v_rcp_f32 v62, v62
    v_rcp_f32 v63, v63
    v_pk_mul_f32 v[128:129], v[128:129], v[48:49]
    v_pk_mul_f32 v[130:131], v[130:131], v[50:51]
    v_pk_mul_f32 v[132:133], v[132:133], v[52:53]
    v_pk_mul_f32 v[134:135], v[134:135], v[54:55]
    v_pk_mul_f32 v[136:137], v[136:137], v[56:57]
    v_pk_mul_f32 v[138:139], v[138:139], v[58:59]
    v_pk_mul_f32 v[140:141], v[140:141], v[60:61]
    v_pk_mul_f32 v[142:143], v[142:143], v[62:63]
    s_waitcnt lgkmcnt(0)
    s_barrier
    ds_read_b64_tr_b16 v[32:33], v244 offset:0
    ds_read_b64_tr_b16 v[34:35], v245 offset:0
    ds_read_b128 v[16:19], v242 offset:0
    ds_read_b128 v[20:23], v242 offset:2048
    ds_read_b128 v[24:27], v242 offset:4096
    ds_read_b128 v[28:31], v242 offset:6144
    ds_read_b64_tr_b16 v[36:37], v244 offset:2048
    ds_read_b64_tr_b16 v[38:39], v245 offset:2048
    ds_read_b64_tr_b16 v[40:41], v244 offset:4096
    ds_read_b64_tr_b16 v[42:43], v245 offset:4096
    ds_read_b64_tr_b16 v[44:45], v244 offset:6144
    ds_read_b64_tr_b16 v[46:47], v245 offset:6144
    s_add_u32 s66, s66, 16384
    s_and_b32 s66, s66, 0xffff
    s_add_u32 s67, s67, 16384
    s_cmp_eq_u32 s67, 81920
    s_cselect_b32 s67, 0, s67
    s_waitcnt lgkmcnt(6)
    v_mfma_f32_16x16x32_bf16 v[144:147], v[32:35], v[16:19], v[224:227]
    ds_read_b64_tr_b16 v[64:65], v244 offset:512
    v_mfma_f32_16x16x32_bf16 v[160:163], v[32:35], v[20:23], v[228:231]
    ds_read_b64_tr_b16 v[66:67], v245 offset:512
    v_mfma_f32_16x16x32_bf16 v[176:179], v[32:35], v[24:27], v[232:235]
    ds_read_b128 v[48:51], v243 offset:0
    v_mfma_f32_16x16x32_bf16 v[192:195], v[32:35], v[28:31], v[236:239]
    ds_read_b128 v[52:55], v243 offset:2048
    s_waitcnt lgkmcnt(4)
    v_mfma_f32_16x16x32_bf16 v[196:199], v[36:39], v[28:31], v[236:239]
    ds_read_b128 v[56:59], v243 offset:4096
    v_mfma_f32_16x16x32_bf16 v[180:183], v[36:39], v[24:27], v[232:235]
    ds_read_b128 v[60:63], v243 offset:6144
    v_mfma_f32_16x16x32_bf16 v[164:167], v[36:39], v[20:23], v[228:231]
    ds_read_b64_tr_b16 v[68:69], v244 offset:2560
    v_mfma_f32_16x16x32_bf16 v[148:151], v[36:39], v[16:19], v[224:227]
    ds_read_b64_tr_b16 v[70:71], v245 offset:2560
    v_mfma_f32_16x16x32_bf16 v[152:155], v[40:43], v[16:19], v[224:227]
    ds_read_b64_tr_b16 v[72:73], v244 offset:4608
    v_mfma_f32_16x16x32_bf16 v[168:171], v[40:43], v[20:23], v[228:231]
    ds_read_b64_tr_b16 v[74:75], v245 offset:4608
    v_mfma_f32_16x16x32_bf16 v[184:187], v[40:43], v[24:27], v[232:235]
    ds_read_b64_tr_b16 v[76:77], v244 offset:6656
    v_mfma_f32_16x16x32_bf16 v[200:203], v[40:43], v[28:31], v[236:239]
    ds_read_b64_tr_b16 v[78:79], v245 offset:6656
    v_mfma_f32_16x16x32_bf16 v[204:207], v[44:47], v[28:31], v[236:239]
    v_add_u32 v242, s66, v254
    v_mfma_f32_16x16x32_bf16 v[188:191], v[44:47], v[24:27], v[232:235]
    v_xor_b32_e64 v243, 64, v242
    v_mfma_f32_16x16x32_bf16 v[172:175], v[44:47], v[20:23], v[228:231]
    v_add_u32_e64 v244, s67, v255
    v_mfma_f32_16x16x32_bf16 v[156:159], v[44:47], v[16:19], v[224:227]
    v_xor_b32 v245, 64, v244
    s_waitcnt lgkmcnt(0)
    v_mfma_f32_16x16x32_bf16 v[144:147], v[64:67], v[48:51], v[144:147]
    s_barrier
    v_mfma_f32_16x16x32_bf16 v[160:163], v[64:67], v[52:55], v[160:163]
    ds_read_b64_tr_b16 v[32:33], v244 offset:0
    v_mfma_f32_16x16x32_bf16 v[176:179], v[64:67], v[56:59], v[176:179]
    ds_read_b64_tr_b16 v[34:35], v245 offset:0
    v_mfma_f32_16x16x32_bf16 v[192:195], v[64:67], v[60:63], v[192:195]
    ds_read_b128 v[16:19], v242 offset:0
    v_mfma_f32_16x16x32_bf16 v[196:199], v[68:71], v[60:63], v[196:199]
    ds_read_b128 v[20:23], v242 offset:2048
    v_mfma_f32_16x16x32_bf16 v[180:183], v[68:71], v[56:59], v[180:183]
    ds_read_b128 v[24:27], v242 offset:4096
    s_add_u32 s66, s66, 16384
    v_mfma_f32_16x16x32_bf16 v[164:167], v[68:71], v[52:55], v[164:167]
    ds_read_b128 v[28:31], v242 offset:6144
    s_and_b32 s66, s66, 0xffff
    v_mfma_f32_16x16x32_bf16 v[148:151], v[68:71], v[48:51], v[148:151]
    ds_read_b64_tr_b16 v[36:37], v244 offset:2048
    s_add_u32 s67, s67, 16384
    v_mfma_f32_16x16x32_bf16 v[152:155], v[72:75], v[48:51], v[152:155]
    ds_read_b64_tr_b16 v[38:39], v245 offset:2048
    s_cmp_eq_u32 s67, 81920
    v_mfma_f32_16x16x32_bf16 v[168:171], v[72:75], v[52:55], v[168:171]
    ds_read_b64_tr_b16 v[40:41], v244 offset:4096
    s_cselect_b32 s67, 0, s67
    v_mfma_f32_16x16x32_bf16 v[184:187], v[72:75], v[56:59], v[184:187]
    ds_read_b64_tr_b16 v[42:43], v245 offset:4096
    v_mfma_f32_16x16x32_bf16 v[200:203], v[72:75], v[60:63], v[200:203]
    ds_read_b64_tr_b16 v[44:45], v244 offset:6144
    v_mfma_f32_16x16x32_bf16 v[204:207], v[76:79], v[60:63], v[204:207]
    ds_read_b64_tr_b16 v[46:47], v245 offset:6144
    v_mfma_f32_16x16x32_bf16 v[188:191], v[76:79], v[56:59], v[188:191]
    v_mfma_f32_16x16x32_bf16 v[172:175], v[76:79], v[52:55], v[172:175]
    v_mfma_f32_16x16x32_bf16 v[156:159], v[76:79], v[48:51], v[156:159]
    s_mov_b32 s68, 30
    s_branch .pg_7
.p2align 12
.pad_7:
    s_nop 0
    s_setpc_b64 s[44:45]
.pg_7:
.p2align 6
.cl_182:
    s_waitcnt lgkmcnt(6)
    v_mfma_f32_16x16x32_bf16 v[144:147], v[32:35], v[16:19], v[144:147]
    ds_read_b64_tr_b16 v[64:65], v244 offset:512
    v_mfma_f32_16x16x32_bf16 v[160:163], v[32:35], v[20:23], v[160:163]
    ds_read_b64_tr_b16 v[66:67], v245 offset:512
    v_mfma_f32_16x16x32_bf16 v[176:179], v[32:35], v[24:27], v[176:179]
    ds_read_b128 v[48:51], v243 offset:0
    v_mfma_f32_16x16x32_bf16 v[192:195], v[32:35], v[28:31], v[192:195]
    ds_read_b128 v[52:55], v243 offset:2048
    s_waitcnt lgkmcnt(4)
    v_mfma_f32_16x16x32_bf16 v[196:199], v[36:39], v[28:31], v[196:199]
    ds_read_b128 v[56:59], v243 offset:4096
    v_mfma_f32_16x16x32_bf16 v[180:183], v[36:39], v[24:27], v[180:183]
    ds_read_b128 v[60:63], v243 offset:6144
    v_mfma_f32_16x16x32_bf16 v[164:167], v[36:39], v[20:23], v[164:167]
    ds_read_b64_tr_b16 v[68:69], v244 offset:2560
    v_mfma_f32_16x16x32_bf16 v[148:151], v[36:39], v[16:19], v[148:151]
    ds_read_b64_tr_b16 v[70:71], v245 offset:2560
    v_mfma_f32_16x16x32_bf16 v[152:155], v[40:43], v[16:19], v[152:155]
    ds_read_b64_tr_b16 v[72:73], v244 offset:4608
    v_mfma_f32_16x16x32_bf16 v[168:171], v[40:43], v[20:23], v[168:171]
    ds_read_b64_tr_b16 v[74:75], v245 offset:4608
    v_mfma_f32_16x16x32_bf16 v[184:187], v[40:43], v[24:27], v[184:187]
    ds_read_b64_tr_b16 v[76:77], v244 offset:6656
    v_mfma_f32_16x16x32_bf16 v[200:203], v[40:43], v[28:31], v[200:203]
    ds_read_b64_tr_b16 v[78:79], v245 offset:6656
    v_mfma_f32_16x16x32_bf16 v[204:207], v[44:47], v[28:31], v[204:207]
    v_add_u32_e64 v242, s66, v254
    v_mfma_f32_16x16x32_bf16 v[188:191], v[44:47], v[24:27], v[188:191]
    v_xor_b32_e64 v243, 64, v242
    v_mfma_f32_16x16x32_bf16 v[172:175], v[44:47], v[20:23], v[172:175]
    v_add_u32_e64 v244, s67, v255
    v_mfma_f32_16x16x32_bf16 v[156:159], v[44:47], v[16:19], v[156:159]
    v_xor_b32 v245, 64, v244
    s_waitcnt lgkmcnt(0)
    v_mfma_f32_16x16x32_bf16 v[144:147], v[64:67], v[48:51], v[144:147]
    s_barrier
    v_mfma_f32_16x16x32_bf16 v[160:163], v[64:67], v[52:55], v[160:163]
    ds_read_b64_tr_b16 v[32:33], v244 offset:0
    v_mfma_f32_16x16x32_bf16 v[176:179], v[64:67], v[56:59], v[176:179]
    ds_read_b64_tr_b16 v[34:35], v245 offset:0
    v_mfma_f32_16x16x32_bf16 v[192:195], v[64:67], v[60:63], v[192:195]
    ds_read_b128 v[16:19], v242 offset:0
    v_mfma_f32_16x16x32_bf16 v[196:199], v[68:71], v[60:63], v[196:199]
    ds_read_b128 v[20:23], v242 offset:2048
    v_mfma_f32_16x16x32_bf16 v[180:183], v[68:71], v[56:59], v[180:183]
    ds_read_b128 v[24:27], v242 offset:4096
    s_add_u32 s66, s66, 16384
    v_mfma_f32_16x16x32_bf16 v[164:167], v[68:71], v[52:55], v[164:167]
    ds_read_b128 v[28:31], v242 offset:6144
    s_and_b32 s66, s66, 0xffff
    v_mfma_f32_16x16x32_bf16 v[148:151], v[68:71], v[48:51], v[148:151]
    ds_read_b64_tr_b16 v[36:37], v244 offset:2048
    s_add_u32 s67, s67, 16384
    v_mfma_f32_16x16x32_bf16 v[152:155], v[72:75], v[48:51], v[152:155]
    ds_read_b64_tr_b16 v[38:39], v245 offset:2048
    s_cmp_eq_u32 s67, 81920
    v_mfma_f32_16x16x32_bf16 v[168:171], v[72:75], v[52:55], v[168:171]
    ds_read_b64_tr_b16 v[40:41], v244 offset:4096
    s_cselect_b32 s67, 0, s67
    v_mfma_f32_16x16x32_bf16 v[184:187], v[72:75], v[56:59], v[184:187]
    ds_read_b64_tr_b16 v[42:43], v245 offset:4096
    v_mfma_f32_16x16x32_bf16 v[200:203], v[72:75], v[60:63], v[200:203]
    ds_read_b64_tr_b16 v[44:45], v244 offset:6144
    v_mfma_f32_16x16x32_bf16 v[204:207], v[76:79], v[60:63], v[204:207]
    ds_read_b64_tr_b16 v[46:47], v245 offset:6144
    v_mfma_f32_16x16x32_bf16 v[188:191], v[76:79], v[56:59], v[188:191]
    s_sub_u32 s68, s68, 1
    v_mfma_f32_16x16x32_bf16 v[172:175], v[76:79], v[52:55], v[172:175]
    s_cmp_lg_u32 s68, 0
    v_mfma_f32_16x16x32_bf16 v[156:159], v[76:79], v[48:51], v[156:159]
    s_cbranch_scc1 .cl_182
.code_c5:
    s_waitcnt lgkmcnt(6)
    v_mfma_f32_16x16x32_bf16 v[144:147], v[32:35], v[16:19], v[144:147]
    ds_read_b64_tr_b16 v[64:65], v244 offset:512
    v_mfma_f32_16x16x32_bf16 v[160:163], v[32:35], v[20:23], v[160:163]
    ds_read_b64_tr_b16 v[66:67], v245 offset:512
    v_mfma_f32_16x16x32_bf16 v[176:179], v[32:35], v[24:27], v[176:179]
    ds_read_b128 v[48:51], v243 offset:0
    v_mfma_f32_16x16x32_bf16 v[192:195], v[32:35], v[28:31], v[192:195]
    ds_read_b128 v[52:55], v243 offset:2048
    s_waitcnt lgkmcnt(4)
    v_mfma_f32_16x16x32_bf16 v[196:199], v[36:39], v[28:31], v[196:199]
    ds_read_b128 v[56:59], v243 offset:4096
    v_mfma_f32_16x16x32_bf16 v[180:183], v[36:39], v[24:27], v[180:183]
    ds_read_b128 v[60:63], v243 offset:6144
    v_mfma_f32_16x16x32_bf16 v[164:167], v[36:39], v[20:23], v[164:167]
    ds_read_b64_tr_b16 v[68:69], v244 offset:2560
    v_mfma_f32_16x16x32_bf16 v[148:151], v[36:39], v[16:19], v[148:151]
    ds_read_b64_tr_b16 v[70:71], v245 offset:2560
    v_mfma_f32_16x16x32_bf16 v[152:155], v[40:43], v[16:19], v[152:155]
    ds_read_b64_tr_b16 v[72:73], v244 offset:4608
    v_mfma_f32_16x16x32_bf16 v[168:171], v[40:43], v[20:23], v[168:171]
    ds_read_b64_tr_b16 v[74:75], v245 offset:4608
    v_mfma_f32_16x16x32_bf16 v[184:187], v[40:43], v[24:27], v[184:187]
    ds_read_b64_tr_b16 v[76:77], v244 offset:6656
    v_mfma_f32_16x16x32_bf16 v[200:203], v[40:43], v[28:31], v[200:203]
    ds_read_b64_tr_b16 v[78:79], v245 offset:6656
    v_mfma_f32_16x16x32_bf16 v[204:207], v[44:47], v[28:31], v[204:207]
    v_mfma_f32_16x16x32_bf16 v[188:191], v[44:47], v[24:27], v[188:191]
    v_mfma_f32_16x16x32_bf16 v[172:175], v[44:47], v[20:23], v[172:175]
    v_mfma_f32_16x16x32_bf16 v[156:159], v[44:47], v[16:19], v[156:159]
    s_waitcnt lgkmcnt(0)
    v_mfma_f32_16x16x32_bf16 v[144:147], v[64:67], v[48:51], v[144:147]
    s_barrier
    v_mfma_f32_16x16x32_bf16 v[148:151], v[68:71], v[48:51], v[148:151]
    v_mfma_f32_16x16x32_bf16 v[152:155], v[72:75], v[48:51], v[152:155]
    v_mfma_f32_16x16x32_bf16 v[156:159], v[76:79], v[48:51], v[156:159]
    v_mfma_f32_16x16x32_bf16 v[160:163], v[64:67], v[52:55], v[160:163]
    v_mfma_f32_16x16x32_bf16 v[164:167], v[68:71], v[52:55], v[164:167]
    v_mfma_f32_16x16x32_bf16 v[168:171], v[72:75], v[52:55], v[168:171]
    s_nop 0
    v_mul_f32 v144, v144, v80
    v_mul_f32 v145, v145, v81
    v_mul_f32_e64 v146, v146, v82
    v_mfma_f32_16x16x32_bf16 v[172:175], v[76:79], v[52:55], v[172:175]
    v_mul_f32 v147, v147, v83
    v_mul_f32 v148, v148, v84
    v_mul_f32_e64 v149, v149, v85
    v_mfma_f32_16x16x32_bf16 v[176:179], v[64:67], v[56:59], v[176:179]
    v_mul_f32 v150, v150, v86
    v_mul_f32 v151, v151, v87
    v_cvt_pk_bf16_f32 v144, v144, v145
    v_mfma_f32_16x16x32_bf16 v[180:183], v[68:71], v[56:59], v[180:183]
    v_cvt_pk_bf16_f32 v145, v146, v147
    v_cvt_pk_bf16_f32 v146, v148, v149
    v_cvt_pk_bf16_f32 v147, v150, v151
    v_mfma_f32_16x16x32_bf16 v[184:187], v[72:75], v[56:59], v[184:187]
    buffer_store_dwordx4 v[144:147], v249, s[72:75], 0 offen offset:0 sc1
    v_mul_f32 v152, v152, v88
    v_mul_f32 v153, v153, v89
    v_mfma_f32_16x16x32_bf16 v[188:191], v[76:79], v[56:59], v[188:191]
    v_mul_f32 v154, v154, v90
    v_mul_f32 v155, v155, v91
    v_mul_f32_e64 v156, v156, v92
    v_mfma_f32_16x16x32_bf16 v[192:195], v[64:67], v[60:63], v[192:195]
    v_mul_f32 v157, v157, v93
    v_mul_f32 v158, v158, v94
    v_mul_f32_e64 v159, v159, v95
    v_mfma_f32_16x16x32_bf16 v[196:199], v[68:71], v[60:63], v[196:199]
    v_cvt_pk_bf16_f32 v152, v152, v153
    v_cvt_pk_bf16_f32 v153, v154, v155
    v_cvt_pk_bf16_f32 v154, v156, v157
    v_mfma_f32_16x16x32_bf16 v[200:203], v[72:75], v[60:63], v[200:203]
    v_cvt_pk_bf16_f32 v155, v158, v159
    buffer_store_dwordx4 v[152:155], v249, s[72:75], 0 offen offset:1024 sc1
    v_pk_mul_f32 v[160:161], v[160:161], v[96:97]
    v_mfma_f32_16x16x32_bf16 v[204:207], v[76:79], v[60:63], v[204:207]
    v_pk_mul_f32 v[162:163], v[162:163], v[98:99]
    v_pk_mul_f32 v[164:165], v[164:165], v[100:101]
    v_pk_mul_f32 v[166:167], v[166:167], v[102:103]
    v_cvt_pk_bf16_f32 v160, v160, v161
    v_cvt_pk_bf16_f32 v161, v162, v163
    v_cvt_pk_bf16_f32 v162, v164, v165
    v_cvt_pk_bf16_f32 v163, v166, v167
    buffer_store_dwordx4 v[160:163], v249, s[72:75], 0 offen offset:2048 sc1
    v_pk_mul_f32 v[168:169], v[168:169], v[104:105]
    v_pk_mul_f32 v[170:171], v[170:171], v[106:107]
    v_pk_mul_f32 v[172:173], v[172:173], v[108:109]
    v_pk_mul_f32 v[174:175], v[174:175], v[110:111]
    v_cvt_pk_bf16_f32 v168, v168, v169
    v_cvt_pk_bf16_f32 v169, v170, v171
    v_cvt_pk_bf16_f32 v170, v172, v173
    v_cvt_pk_bf16_f32 v171, v174, v175
    buffer_store_dwordx4 v[168:171], v249, s[72:75], 0 offen offset:3072 sc1
    v_pk_mul_f32 v[176:177], v[176:177], v[112:113]
    v_pk_mul_f32 v[178:179], v[178:179], v[114:115]
    v_pk_mul_f32 v[180:181], v[180:181], v[116:117]
    v_pk_mul_f32 v[182:183], v[182:183], v[118:119]
    v_cvt_pk_bf16_f32 v176, v176, v177
    v_cvt_pk_bf16_f32 v177, v178, v179
    v_cvt_pk_bf16_f32 v178, v180, v181
    v_cvt_pk_bf16_f32 v179, v182, v183
    buffer_store_dwordx4 v[176:179], v249, s[72:75], s84 offen offset:0 sc1
    v_pk_mul_f32 v[184:185], v[184:185], v[120:121]
    v_pk_mul_f32 v[186:187], v[186:187], v[122:123]
    v_pk_mul_f32 v[188:189], v[188:189], v[124:125]
    v_pk_mul_f32 v[190:191], v[190:191], v[126:127]
    v_cvt_pk_bf16_f32 v184, v184, v185
    v_cvt_pk_bf16_f32 v185, v186, v187
    v_cvt_pk_bf16_f32 v186, v188, v189
    v_cvt_pk_bf16_f32 v187, v190, v191
    buffer_store_dwordx4 v[184:187], v249, s[72:75], s84 offen offset:1024 sc1
    v_pk_mul_f32 v[192:193], v[192:193], v[128:129]
    v_pk_mul_f32 v[194:195], v[194:195], v[130:131]
    v_pk_mul_f32 v[196:197], v[196:197], v[132:133]
    v_pk_mul_f32 v[198:199], v[198:199], v[134:135]
    v_cvt_pk_bf16_f32 v192, v192, v193
    v_cvt_pk_bf16_f32 v193, v194, v195
    v_cvt_pk_bf16_f32 v194, v196, v197
    v_cvt_pk_bf16_f32 v195, v198, v199
    buffer_store_dwordx4 v[192:195], v249, s[72:75], s84 offen offset:2048 sc1
    v_pk_mul_f32 v[200:201], v[200:201], v[136:137]
    v_pk_mul_f32 v[202:203], v[202:203], v[138:139]
    v_pk_mul_f32 v[204:205], v[204:205], v[140:141]
    v_pk_mul_f32 v[206:207], v[206:207], v[142:143]
    v_cvt_pk_bf16_f32 v200, v200, v201
    v_cvt_pk_bf16_f32 v201, v202, v203
    v_cvt_pk_bf16_f32 v202, v204, v205
    v_cvt_pk_bf16_f32 v203, v206, v207
    buffer_store_dwordx4 v[200:203], v249, s[72:75], s84 offen offset:3072 sc1
    s_waitcnt vmcnt(0)
    s_barrier
    s_cmp_lg_u32 s32, 0
    s_cbranch_scc1 .ho_184
    s_lshl_b32 s28, s33, 11
    s_atomic_add s40, s[52:53], s28 offset:131072
    s_atomic_add s40, s[52:53], s28 offset:131200
    s_atomic_add s40, s[52:53], s28 offset:131328
    s_atomic_add s40, s[52:53], s28 offset:131456
.ho_184:
.hret_185:
    s_lshl_b32 s28, s64, 13
    v_lshl_add_u32 v242, v1, 4, s28
    v_lshrrev_b32_e64 v4, 2, v10
    v_lshl_add_u32 v4, v11, 2, v4
    v_bfe_u32 v5, v4, 1, 2
    v_lshlrev_b32_e64 v4, 7, v4
    v_lshl_add_u32 v4, v5, 5, v4
    v_and_b32_e64 v5, 3, v1
    v_lshl_add_u32 v4, v5, 3, v4
    s_lshl_b32 s28, s65, 6
    v_xor_b32 v4, s28, v4
    v_add_u32 v246, 65536, v4
    v_xor_b32 v247, 32, v246
    v_mov_b32 v254, v242
    v_mov_b32 v255, v246
    s_mov_b32 s66, 0
    s_mov_b32 s67, 0
    v_lshlrev_b32 v80, 16, v208
    v_and_b32 v81, 0xffff0000, v208
    v_lshlrev_b32_e64 v82, 16, v209
    v_and_b32 v83, 0xffff0000, v209
    v_lshlrev_b32_e64 v84, 16, v210
    v_and_b32 v85, 0xffff0000, v210
    v_lshlrev_b32_e64 v86, 16, v211
    v_and_b32 v87, 0xffff0000, v211
    v_lshlrev_b32_e64 v88, 16, v212
    v_and_b32 v89, 0xffff0000, v212
    v_lshlrev_b32_e64 v90, 16, v213
    v_and_b32 v91, 0xffff0000, v213
    v_lshlrev_b32_e64 v92, 16, v214
    v_and_b32 v93, 0xffff0000, v214
    v_lshlrev_b32_e64 v94, 16, v215
    v_and_b32 v95, 0xffff0000, v215
    v_lshlrev_b32_e64 v96, 16, v216
    v_and_b32 v97, 0xffff0000, v216
    v_lshlrev_b32_e64 v98, 16, v217
    v_and_b32 v99, 0xffff0000, v217
    v_lshlrev_b32_e64 v100, 16, v218
    v_and_b32 v101, 0xffff0000, v218
    v_lshlrev_b32_e64 v102, 16, v219
    v_and_b32 v103, 0xffff0000, v219
    v_lshlrev_b32_e64 v104, 16, v220
    v_and_b32 v105, 0xffff0000, v220
    v_lshlrev_b32_e64 v106, 16, v221
    v_and_b32 v107, 0xffff0000, v221
    v_lshlrev_b32_e64 v108, 16, v222
    v_and_b32 v109, 0xffff0000, v222
    v_lshlrev_b32_e64 v110, 16, v223
    v_and_b32 v111, 0xffff0000, v223
    s_lshl_b32 s28, s33, 18
    s_add_u32 s72, s22, s28
    s_addc_u32 s73, s23, 0
    s_mov_b32 s74, 262144
    s_mov_b32 s75, 0x20000
    s_lshl_b32 s28, s64, 17
    s_lshl1_add_u32 s29, s34, s65
    s_lshl_b32 s29, s29, 6
    s_add_u32 s28, s28, s29
    v_lshl_add_u32 v248, v10, 11, s28
    v_lshl_add_u32 v248, v9, 4, v248
    v_and_b32 v2, 1, v11
    v_lshl_add_u32 v248, v2, 5, v248
    s_waitcnt lgkmcnt(0)
    s_barrier
    ds_read_b64_tr_b16 v[32:33], v246 offset:0
    ds_read_b64_tr_b16 v[34:35], v246 offset:2048
    ds_read_b128 v[16:19], v242 offset:0
    ds_read_b64_tr_b16 v[56:57], v246 offset:4096
    ds_read_b64_tr_b16 v[58:59], v246 offset:6144
    ds_read_b128 v[40:43], v242 offset:1024
    ds_read_b128 v[20:23], v242 offset:2048
    ds_read_b128 v[44:47], v242 offset:3072
    ds_read_b128 v[24:27], v242 offset:4096
    ds_read_b128 v[48:51], v242 offset:5120
    ds_read_b128 v[28:31], v242 offset:6144
    ds_read_b128 v[52:55], v242 offset:7168
    ds_read_b64_tr_b16 v[36:37], v247 offset:0
    ds_read_b64_tr_b16 v[38:39], v247 offset:2048
    ds_read_b64_tr_b16 v[60:61], v247 offset:4096
    ds_read_b64_tr_b16 v[62:63], v247 offset:6144
    s_add_u32 s66, s66, 16384
    s_and_b32 s66, s66, 0xffff
    s_add_u32 s67, s67, 8192
    s_cmp_eq_u32 s67, 81920
    s_cselect_b32 s67, 0, s67
    v_add_u32 v242, s66, v254
    v_add_u32 v246, s67, v255
    v_xor_b32 v247, 32, v246
    s_add_u32 s66, s66, 16384
    s_and_b32 s66, s66, 0xffff
    s_add_u32 s67, s67, 8192
    s_cmp_eq_u32 s67, 81920
    s_cselect_b32 s67, 0, s67
    s_mov_b32 s68, 13
.p2align 6
.cl_186:
    s_waitcnt lgkmcnt(0)
    v_mfma_f32_16x16x32_bf16 v[80:83], v[32:35], v[16:19], v[80:83]
    s_barrier
    v_mfma_f32_16x16x32_bf16 v[80:83], v[56:59], v[40:43], v[80:83]
    ds_read_b64_tr_b16 v[160:161], v246 offset:0
    ds_read_b64_tr_b16 v[162:163], v246 offset:2048
    v_mfma_f32_16x16x32_bf16 v[88:91], v[32:35], v[20:23], v[88:91]
    ds_read_b128 v[144:147], v242 offset:0
    ds_read_b64_tr_b16 v[184:185], v246 offset:4096
    v_mfma_f32_16x16x32_bf16 v[88:91], v[56:59], v[44:47], v[88:91]
    ds_read_b64_tr_b16 v[186:187], v246 offset:6144
    ds_read_b128 v[168:171], v242 offset:1024
    v_mfma_f32_16x16x32_bf16 v[96:99], v[32:35], v[24:27], v[96:99]
    ds_read_b128 v[148:151], v242 offset:2048
    ds_read_b128 v[172:175], v242 offset:3072
    v_mfma_f32_16x16x32_bf16 v[96:99], v[56:59], v[48:51], v[96:99]
    ds_read_b128 v[152:155], v242 offset:4096
    v_mfma_f32_16x16x32_bf16 v[104:107], v[32:35], v[28:31], v[104:107]
    ds_read_b128 v[176:179], v242 offset:5120
    v_mfma_f32_16x16x32_bf16 v[104:107], v[56:59], v[52:55], v[104:107]
    ds_read_b128 v[156:159], v242 offset:6144
    v_mfma_f32_16x16x32_bf16 v[108:111], v[36:39], v[28:31], v[108:111]
    ds_read_b128 v[180:183], v242 offset:7168
    v_mfma_f32_16x16x32_bf16 v[108:111], v[60:63], v[52:55], v[108:111]
    ds_read_b64_tr_b16 v[164:165], v247 offset:0
    ds_read_b64_tr_b16 v[166:167], v247 offset:2048
    v_mfma_f32_16x16x32_bf16 v[100:103], v[36:39], v[24:27], v[100:103]
    ds_read_b64_tr_b16 v[188:189], v247 offset:4096
    ds_read_b64_tr_b16 v[190:191], v247 offset:6144
    v_mfma_f32_16x16x32_bf16 v[100:103], v[60:63], v[48:51], v[100:103]
    v_add_u32 v242, s66, v254
    v_add_u32 v246, s67, v255
    v_mfma_f32_16x16x32_bf16 v[92:95], v[36:39], v[20:23], v[92:95]
    v_xor_b32_e64 v247, 32, v246
    s_add_u32 s66, s66, 16384
    s_and_b32 s66, s66, 0xffff
    s_add_u32 s67, s67, 8192
    v_mfma_f32_16x16x32_bf16 v[92:95], v[60:63], v[44:47], v[92:95]
    s_cmp_eq_u32 s67, 81920
    s_cselect_b32 s67, 0, s67
    v_mfma_f32_16x16x32_bf16 v[84:87], v[36:39], v[16:19], v[84:87]
    v_mfma_f32_16x16x32_bf16 v[84:87], v[60:63], v[40:43], v[84:87]
    s_waitcnt lgkmcnt(0)
    v_mfma_f32_16x16x32_bf16 v[80:83], v[160:163], v[144:147], v[80:83]
    s_barrier
    v_mfma_f32_16x16x32_bf16 v[80:83], v[184:187], v[168:171], v[80:83]
    ds_read_b64_tr_b16 v[32:33], v246 offset:0
    ds_read_b64_tr_b16 v[34:35], v246 offset:2048
    v_mfma_f32_16x16x32_bf16 v[88:91], v[160:163], v[148:151], v[88:91]
    ds_read_b128 v[16:19], v242 offset:0
    ds_read_b64_tr_b16 v[56:57], v246 offset:4096
    v_mfma_f32_16x16x32_bf16 v[88:91], v[184:187], v[172:175], v[88:91]
    ds_read_b64_tr_b16 v[58:59], v246 offset:6144
    ds_read_b128 v[40:43], v242 offset:1024
    v_mfma_f32_16x16x32_bf16 v[96:99], v[160:163], v[152:155], v[96:99]
    ds_read_b128 v[20:23], v242 offset:2048
    ds_read_b128 v[44:47], v242 offset:3072
    v_mfma_f32_16x16x32_bf16 v[96:99], v[184:187], v[176:179], v[96:99]
    ds_read_b128 v[24:27], v242 offset:4096
    v_mfma_f32_16x16x32_bf16 v[104:107], v[160:163], v[156:159], v[104:107]
    ds_read_b128 v[48:51], v242 offset:5120
    v_mfma_f32_16x16x32_bf16 v[104:107], v[184:187], v[180:183], v[104:107]
    ds_read_b128 v[28:31], v242 offset:6144
    v_mfma_f32_16x16x32_bf16 v[108:111], v[164:167], v[156:159], v[108:111]
    ds_read_b128 v[52:55], v242 offset:7168
    v_mfma_f32_16x16x32_bf16 v[108:111], v[188:191], v[180:183], v[108:111]
    ds_read_b64_tr_b16 v[36:37], v247 offset:0
    ds_read_b64_tr_b16 v[38:39], v247 offset:2048
    v_mfma_f32_16x16x32_bf16 v[100:103], v[164:167], v[152:155], v[100:103]
    ds_read_b64_tr_b16 v[60:61], v247 offset:4096
    ds_read_b64_tr_b16 v[62:63], v247 offset:6144
    v_mfma_f32_16x16x32_bf16 v[100:103], v[188:191], v[176:179], v[100:103]
    v_add_u32 v242, s66, v254
    v_add_u32_e64 v246, s67, v255
    v_mfma_f32_16x16x32_bf16 v[92:95], v[164:167], v[148:151], v[92:95]
    v_xor_b32_e64 v247, 32, v246
    s_add_u32 s66, s66, 16384
    s_and_b32 s66, s66, 0xffff
    s_add_u32 s67, s67, 8192
    v_mfma_f32_16x16x32_bf16 v[92:95], v[188:191], v[172:175], v[92:95]
    s_cmp_eq_u32 s67, 81920
    s_cselect_b32 s67, 0, s67
    v_mfma_f32_16x16x32_bf16 v[84:87], v[164:167], v[144:147], v[84:87]
    s_sub_u32 s68, s68, 1
    s_cmp_lg_u32 s68, 0
    v_mfma_f32_16x16x32_bf16 v[84:87], v[188:191], v[168:171], v[84:87]
    s_cbranch_scc1 .cl_186
    s_waitcnt lgkmcnt(0)
    v_mfma_f32_16x16x32_bf16 v[80:83], v[32:35], v[16:19], v[80:83]
    s_barrier
    v_mfma_f32_16x16x32_bf16 v[80:83], v[56:59], v[40:43], v[80:83]
    ds_read_b64_tr_b16 v[160:161], v246 offset:0
    ds_read_b64_tr_b16 v[162:163], v246 offset:2048
    v_mfma_f32_16x16x32_bf16 v[88:91], v[32:35], v[20:23], v[88:91]
    ds_read_b128 v[144:147], v242 offset:0
    ds_read_b64_tr_b16 v[184:185], v246 offset:4096
    v_mfma_f32_16x16x32_bf16 v[88:91], v[56:59], v[44:47], v[88:91]
    ds_read_b64_tr_b16 v[186:187], v246 offset:6144
    ds_read_b128 v[168:171], v242 offset:1024
    v_mfma_f32_16x16x32_bf16 v[96:99], v[32:35], v[24:27], v[96:99]
    ds_read_b128 v[148:151], v242 offset:2048
    ds_read_b128 v[172:175], v242 offset:3072
    v_mfma_f32_16x16x32_bf16 v[96:99], v[56:59], v[48:51], v[96:99]
    ds_read_b128 v[152:155], v242 offset:4096
    v_mfma_f32_16x16x32_bf16 v[104:107], v[32:35], v[28:31], v[104:107]
    ds_read_b128 v[176:179], v242 offset:5120
    v_mfma_f32_16x16x32_bf16 v[104:107], v[56:59], v[52:55], v[104:107]
    ds_read_b128 v[156:159], v242 offset:6144
    v_mfma_f32_16x16x32_bf16 v[108:111], v[36:39], v[28:31], v[108:111]
    ds_read_b128 v[180:183], v242 offset:7168
    v_mfma_f32_16x16x32_bf16 v[108:111], v[60:63], v[52:55], v[108:111]
    ds_read_b64_tr_b16 v[164:165], v247 offset:0
    ds_read_b64_tr_b16 v[166:167], v247 offset:2048
    v_mfma_f32_16x16x32_bf16 v[100:103], v[36:39], v[24:27], v[100:103]
    ds_read_b64_tr_b16 v[188:189], v247 offset:4096
    ds_read_b64_tr_b16 v[190:191], v247 offset:6144
    v_mfma_f32_16x16x32_bf16 v[100:103], v[60:63], v[48:51], v[100:103]
    v_add_u32 v242, s66, v254
    v_add_u32 v246, s67, v255
    v_mfma_f32_16x16x32_bf16 v[92:95], v[36:39], v[20:23], v[92:95]
    v_xor_b32_e64 v247, 32, v246
    s_add_u32 s66, s66, 16384
    s_and_b32 s66, s66, 0xffff
    s_add_u32 s67, s67, 8192
    v_mfma_f32_16x16x32_bf16 v[92:95], v[60:63], v[44:47], v[92:95]
    s_cmp_eq_u32 s67, 81920
    s_cselect_b32 s67, 0, s67
    v_mfma_f32_16x16x32_bf16 v[84:87], v[36:39], v[16:19], v[84:87]
    v_mfma_f32_16x16x32_bf16 v[84:87], v[60:63], v[40:43], v[84:87]
    s_waitcnt lgkmcnt(0)
    v_mfma_f32_16x16x32_bf16 v[80:83], v[160:163], v[144:147], v[80:83]
    s_barrier
    v_mfma_f32_16x16x32_bf16 v[80:83], v[184:187], v[168:171], v[80:83]
    v_mfma_f32_16x16x32_bf16 v[84:87], v[164:167], v[144:147], v[84:87]
    v_mfma_f32_16x16x32_bf16 v[84:87], v[188:191], v[168:171], v[84:87]
    v_mfma_f32_16x16x32_bf16 v[88:91], v[160:163], v[148:151], v[88:91]
    v_mfma_f32_16x16x32_bf16 v[88:91], v[184:187], v[172:175], v[88:91]
    v_mfma_f32_16x16x32_bf16 v[92:95], v[164:167], v[148:151], v[92:95]
    s_nop 2
    v_cvt_pk_bf16_f32 v208, v80, v81
    v_cvt_pk_bf16_f32 v209, v82, v83
    v_mfma_f32_16x16x32_bf16 v[92:95], v[188:191], v[172:175], v[92:95]
    v_cvt_pk_bf16_f32 v210, v84, v85
    v_cvt_pk_bf16_f32 v211, v86, v87
    v_mfma_f32_16x16x32_bf16 v[96:99], v[160:163], v[152:155], v[96:99]
    s_mov_b32 s28, 0
    v_permlane16_swap_b32 v208, v210
    v_mfma_f32_16x16x32_bf16 v[96:99], v[184:187], v[176:179], v[96:99]
    v_permlane16_swap_b32_e64 v209, v211
    buffer_store_dwordx4 v[208:211], v248, s[72:75], s28 offen sc1
    v_mfma_f32_16x16x32_bf16 v[100:103], v[164:167], v[152:155], v[100:103]
    v_cvt_pk_bf16_f32 v212, v88, v89
    v_cvt_pk_bf16_f32 v213, v90, v91
    v_mfma_f32_16x16x32_bf16 v[100:103], v[188:191], v[176:179], v[100:103]
    v_cvt_pk_bf16_f32 v214, v92, v93
    v_cvt_pk_bf16_f32 v215, v94, v95
    v_mfma_f32_16x16x32_bf16 v[104:107], v[160:163], v[156:159], v[104:107]
    s_mov_b32 s28, 32768
    v_permlane16_swap_b32_e64 v212, v214
    v_mfma_f32_16x16x32_bf16 v[104:107], v[184:187], v[180:183], v[104:107]
    v_permlane16_swap_b32_e64 v213, v215
    buffer_store_dwordx4 v[212:215], v248, s[72:75], s28 offen sc1
    v_mfma_f32_16x16x32_bf16 v[108:111], v[164:167], v[156:159], v[108:111]
    v_cvt_pk_bf16_f32 v216, v96, v97
    v_cvt_pk_bf16_f32 v217, v98, v99
    v_mfma_f32_16x16x32_bf16 v[108:111], v[188:191], v[180:183], v[108:111]
    v_cvt_pk_bf16_f32 v218, v100, v101
    v_cvt_pk_bf16_f32 v219, v102, v103
    s_mov_b32 s28, 65536
    v_permlane16_swap_b32 v216, v218
    v_permlane16_swap_b32 v217, v219
    buffer_store_dwordx4 v[216:219], v248, s[72:75], s28 offen sc1
    v_cvt_pk_bf16_f32 v220, v104, v105
    v_cvt_pk_bf16_f32 v221, v106, v107
    v_cvt_pk_bf16_f32 v222, v108, v109
    v_cvt_pk_bf16_f32 v223, v110, v111
    s_mov_b32 s28, 98304
    v_permlane16_swap_b32 v220, v222
    v_permlane16_swap_b32 v221, v223
    buffer_store_dwordx4 v[220:223], v248, s[72:75], s28 offen sc1
    s_endpgm
    s_nop 0
.pad_8:
    s_nop 0
    s_setpc_b64 s[44:45]
.cont_8:
    s_sub_u32 s29, s33, s36
    s_and_b32 s29, s29, 3
    s_xor_b32 s30, s33, s34
    s_and_b32 s30, s30, 8
    s_sub_u32 s29, 4, s29
    v_add3_u32 v2, v1, s29, -1
    v_lshrrev_b32 v2, 2, v2
    v_add_u32 v3, s29, v1
    v_lshrrev_b32 v3, 2, v3
    v_add_u32 v4, 2, v1
    v_min_u32 v4, 15, v4
    v_add_u32 v4, s29, v4
    v_lshrrev_b32 v4, 2, v4
    v_sub_u32 v4, v4, v2
    v_add_u32 v4, v4, v1
    v_subrev_u32 v5, 2, v1
    v_max_i32 v5, 0, v5
    v_add3_u32 v6, v5, s29, -1
    v_lshrrev_b32 v6, 2, v6
    v_sub_u32 v5, v5, v6
    v_add_u32 v5, v5, v2
    v_cmp_ne_u32 vcc, v3, v2
    s_nop 1
    v_cndmask_b32 v5, v4, v5, vcc
    v_max_u32_e64 v5, 1, v5
    v_writelane_b32 v5, 0, 0
    v_add_u32 v5, 4, v5
    v_and_b32 v5, 15, v5
    v_cmp_gt_u32 vcc, 16, v1
    s_nop 1
    v_cndmask_b32_e64 v5, v1, v5, vcc
    v_add_lshl_u32 v5, v5, 0, 2
    v_add_u32 v6, s30, v1
    v_and_b32 v6, 15, v6
    v_mul_u32_u24 v6, 393216, v6
    ds_permute_b32 v73, v5, v6
    v_lshrrev_b32 v2, 3, v1
    v_lshrrev_b32 v4, 2, v1
    v_and_b32_e64 v4, 4, v4
    v_mul_u32_u24 v2, 6144, v2
    v_and_b32 v3, 7, v1
    v_xor_b32 v3, v3, v4
    v_lshl_add_u32 v24, v3, 4, v2
    v_xor_b32_e64 v25, 32, v24
    v_add_u32 v25, 48128, v25
    v_add_u32 v26, 96256, v24
    v_add_u32 v27, 96256, v25
    v_add_u32 v28, 196608, v24
    v_add_u32 v29, 196608, v25
    v_add_u32 v30, 196608, v26
    v_add_u32 v31, 196608, v27
    s_waitcnt lgkmcnt(0)
    s_lshl_b32 s28, s34, 7
    s_add_u32 s72, s6, s28
    s_addc_u32 s73, s7, 0
    s_mov_b32 s74, 0
    s_mov_b32 s75, 0x20000
    s_sub_u32 s74, 6291456, s28
    s_mov_b32 s64, 65536
    s_mov_b32 s66, 0
    s_mov_b32 m0, s64
    s_waitcnt lgkmcnt(0)
    v_readlane_b32 s65, v73, 0
    s_nop 4
    s_barrier
    s_nop 0
    s_mov_b32 s85, 9
    s_branch .pg_9
.p2align 12
.pad_9:
    s_nop 0
    s_setpc_b64 s[44:45]
.pg_9:
.ll_9:
    buffer_load_dwordx4 v24, s[72:75], s65 offen offset:0 lds
    buffer_load_dwordx4 v25, s[72:75], s65 offen offset:1024 lds
    buffer_load_dwordx4 v26, s[72:75], s65 offen offset:2048 lds
    buffer_load_dwordx4 v27, s[72:75], s65 offen offset:3072 lds
    s_add_u32 m0, m0, 4096
    s_add_u32 s66, s66, 1
    v_readlane_b32 s84, v73, s66
    s_add_u32 s64, s64, 8192
    s_cmp_eq_u32 s64, 147456
    s_cselect_b32 s64, 65536, s64
    s_sub_u32 s85, s85, 1
    s_cmp_lg_u32 s85, 0
    buffer_load_dwordx4 v28, s[72:75], s65 offen offset:0 lds
    buffer_load_dwordx4 v29, s[72:75], s65 offen offset:1024 lds
    buffer_load_dwordx4 v30, s[72:75], s65 offen offset:2048 lds
    buffer_load_dwordx4 v31, s[72:75], s65 offen offset:3072 lds
    s_mov_b32 m0, s64
    s_mov_b32 s65, s84
    s_cbranch_scc1 .ll_9
    s_add_u32 s52, s26, 35651584
    s_addc_u32 s53, s27, 0
    s_mov_b32 s54, 360448
    s_mov_b32 s55, 0x20000
    s_add_u32 s60, s26, 34603008
    s_addc_u32 s61, s27, 0
    s_mov_b32 s62, 86016
    s_mov_b32 s63, 0x20000
    s_mov_b32 s29, s36
    s_and_b32 s30, s33, 15
    s_sub_u32 s29, 8, s29
    v_lshrrev_b32 v72, 1, v1
    v_add3_u32 v2, v72, s29, -1
    v_lshrrev_b32 v2, 3, v2
    v_add_u32 v3, s29, v72
    v_lshrrev_b32 v3, 3, v3
    v_add_u32 v4, 1, v72
    v_min_u32 v4, 7, v4
    v_add_u32 v4, s29, v4
    v_lshrrev_b32 v4, 3, v4
    v_sub_u32 v4, v4, v2
    v_add_u32 v4, v4, v72
    v_subrev_u32 v5, 1, v72
    v_max_i32_e64 v5, 0, v5
    v_add3_u32 v6, v5, s29, -1
    v_lshrrev_b32 v6, 3, v6
    v_sub_u32 v5, v5, v6
    v_add_u32 v5, v5, v2
    v_cmp_ne_u32 vcc, v3, v2
    s_nop 1
    v_cndmask_b32 v5, v4, v5, vcc
    v_and_b32_e64 v3, 1, v1
    v_lshl_add_u32 v5, v5, 1, v3
    v_cmp_gt_u32 vcc, 16, v1
    s_nop 1
    v_cndmask_b32_e64 v5, v1, v5, vcc
    v_add_lshl_u32 v5, v5, 0, 2
    v_add_u32 v6, s30, v1
    v_and_b32 v6, 15, v6
    v_mul_u32_u24 v6, 131072, v6
    ds_permute_b32 v72, v5, v6
    v_lshrrev_b32 v2, 3, v1
    v_and_b32 v4, 6, v2
    v_mul_u32_u24 v2, 2048, v2
    v_and_b32 v3, 7, v1
    v_xor_b32 v3, v3, v4
    v_lshl_add_u32 v8, v3, 4, v2
    v_add_u32 v9, 15360, v8
    v_add_u32 v10, 30720, v8
    v_add_u32 v11, 30720, v9
    v_add_u32 v12, 65536, v8
    v_add_u32 v13, 65536, v9
    v_add_u32 v14, 65536, v10
    v_add_u32 v15, 65536, v11
    s_waitcnt lgkmcnt(0)
    s_lshl_b32 s28, s34, 7
    s_add_u32 s68, s10, s28
    s_addc_u32 s69, s11, 0
    s_mov_b32 s70, 0
    s_mov_b32 s71, 0x20000
    s_sub_u32 s70, 2097152, s28
    s_waitcnt vmcnt(63)
    s_barrier
    s_waitcnt vmcnt(56)
    s_nop 0
    s_barrier
    buffer_load_dwordx4 v24, s[72:75], s65 offen offset:0 lds
    buffer_load_dwordx4 v25, s[72:75], s65 offen offset:1024 lds
    buffer_load_dwordx4 v26, s[72:75], s65 offen offset:2048 lds
    buffer_load_dwordx4 v27, s[72:75], s65 offen offset:3072 lds
    s_add_u32 m0, m0, 4096
    s_nop 0
    s_add_u32 s66, s66, 1
    v_readlane_b32 s84, v73, s66
    s_add_u32 s64, s64, 8192
    s_cmp_eq_u32 s64, 147456
    s_cselect_b32 s64, 65536, s64
    buffer_load_dwordx4 v28, s[72:75], s65 offen offset:0 lds
    s_waitcnt vmcnt(53)
    s_barrier
    buffer_load_dwordx4 v29, s[72:75], s65 offen offset:1024 lds
    buffer_load_dwordx4 v30, s[72:75], s65 offen offset:2048 lds
    buffer_load_dwordx4 v31, s[72:75], s65 offen offset:3072 lds
    s_mov_b32 m0, s64
    s_mov_b32 s65, s84
    buffer_load_dwordx4 v24, s[72:75], s65 offen offset:0 lds
    s_waitcnt vmcnt(49)
    s_barrier
    buffer_load_dwordx4 v25, s[72:75], s65 offen offset:1024 lds
    buffer_load_dwordx4 v26, s[72:75], s65 offen offset:2048 lds
    buffer_load_dwordx4 v27, s[72:75], s65 offen offset:3072 lds
    s_add_u32 m0, m0, 4096
    s_nop 0
    s_add_u32 s66, s66, 1
    v_readlane_b32 s84, v73, s66
    s_add_u32 s64, s64, 8192
    s_cmp_eq_u32 s64, 147456
    s_cselect_b32 s64, 65536, s64
    buffer_load_dwordx4 v28, s[72:75], s65 offen offset:0 lds
    s_waitcnt vmcnt(45)
    s_barrier
    buffer_load_dwordx4 v29, s[72:75], s65 offen offset:1024 lds
    buffer_load_dwordx4 v30, s[72:75], s65 offen offset:2048 lds
    buffer_load_dwordx4 v31, s[72:75], s65 offen offset:3072 lds
    s_mov_b32 m0, s64
    s_mov_b32 s65, s84
    buffer_load_dwordx4 v24, s[72:75], s65 offen offset:0 lds
    buffer_load_dwordx4 v25, s[72:75], s65 offen offset:1024 lds
    s_waitcnt vmcnt(42)
    s_barrier
    buffer_load_dwordx4 v26, s[72:75], s65 offen offset:2048 lds
    buffer_load_dwordx4 v27, s[72:75], s65 offen offset:3072 lds
    s_add_u32 m0, m0, 4096
    s_nop 0
    s_add_u32 s66, s66, 1
    v_readlane_b32 s84, v73, s66
    s_add_u32 s64, s64, 8192
    s_cmp_eq_u32 s64, 147456
    s_cselect_b32 s64, 65536, s64
    buffer_load_dwordx4 v28, s[72:75], s65 offen offset:0 lds
    buffer_load_dwordx4 v29, s[72:75], s65 offen offset:1024 lds
    s_waitcnt vmcnt(38)
    s_barrier
    buffer_load_dwordx4 v30, s[72:75], s65 offen offset:2048 lds
    buffer_load_dwordx4 v31, s[72:75], s65 offen offset:3072 lds
    s_mov_b32 m0, s64
    s_mov_b32 s65, s84
    buffer_load_dwordx4 v24, s[72:75], s65 offen offset:0 lds
    buffer_load_dwordx4 v25, s[72:75], s65 offen offset:1024 lds
    s_waitcnt vmcnt(34)
    s_barrier
    buffer_load_dwordx4 v26, s[72:75], s65 offen offset:2048 lds
    buffer_load_dwordx4 v27, s[72:75], s65 offen offset:3072 lds
    s_add_u32 m0, m0, 4096
    s_nop 0
    s_add_u32 s66, s66, 1
    v_readlane_b32 s84, v73, s66
    s_add_u32 s64, s64, 8192
    s_cmp_eq_u32 s64, 147456
    s_cselect_b32 s64, 65536, s64
    buffer_load_dwordx4 v28, s[72:75], s65 offen offset:0 lds
    buffer_load_dwordx4 v29, s[72:75], s65 offen offset:1024 lds
    buffer_load_dwordx4 v30, s[72:75], s65 offen offset:2048 lds
    s_waitcnt vmcnt(31)
    s_barrier
    buffer_load_dwordx4 v31, s[72:75], s65 offen offset:3072 lds
    s_mov_b32 m0, s64
    s_mov_b32 s65, s84
    buffer_load_dwordx4 v24, s[72:75], s65 offen offset:0 lds
    buffer_load_dwordx4 v25, s[72:75], s65 offen offset:1024 lds
    buffer_load_dwordx4 v26, s[72:75], s65 offen offset:2048 lds
    s_waitcnt vmcnt(27)
    s_barrier
    buffer_load_dwordx4 v27, s[72:75], s65 offen offset:3072 lds
    s_add_u32 m0, m0, 4096
    s_nop 0
    s_add_u32 s66, s66, 1
    v_readlane_b32 s84, v73, s66
    s_add_u32 s64, s64, 8192
    s_cmp_eq_u32 s64, 147456
    s_cselect_b32 s64, 65536, s64
    buffer_load_dwordx4 v28, s[72:75], s65 offen offset:0 lds
    buffer_load_dwordx4 v29, s[72:75], s65 offen offset:1024 lds
    buffer_load_dwordx4 v30, s[72:75], s65 offen offset:2048 lds
    s_waitcnt vmcnt(23)
    s_barrier
    buffer_load_dwordx4 v31, s[72:75], s65 offen offset:3072 lds
    s_mov_b32 m0, s64
    s_mov_b32 s65, s84
    buffer_load_dwordx4 v24, s[72:75], s65 offen offset:0 lds
    buffer_load_dwordx4 v25, s[72:75], s65 offen offset:1024 lds
    buffer_load_dwordx4 v26, s[72:75], s65 offen offset:2048 lds
    buffer_load_dwordx4 v27, s[72:75], s65 offen offset:3072 lds
    s_add_u32 m0, m0, 4096
    s_add_u32 s66, s66, 1
    v_readlane_b32 s84, v73, s66
    s_add_u32 s64, s64, 8192
    s_cmp_eq_u32 s64, 147456
    s_cselect_b32 s64, 65536, s64
    s_waitcnt vmcnt(20)
    s_barrier
    buffer_load_dwordx4 v28, s[72:75], s65 offen offset:0 lds
    buffer_load_dwordx4 v29, s[72:75], s65 offen offset:1024 lds
    buffer_load_dwordx4 v30, s[72:75], s65 offen offset:2048 lds
    buffer_load_dwordx4 v31, s[72:75], s65 offen offset:3072 lds
    s_mov_b32 m0, s64
    s_mov_b32 s65, s84
    s_waitcnt vmcnt(16)
    s_nop 0
    s_barrier
    buffer_load_dwordx4 v24, s[72:75], s65 offen offset:0 lds
    buffer_load_dwordx4 v25, s[72:75], s65 offen offset:1024 lds
    buffer_load_dwordx4 v26, s[72:75], s65 offen offset:2048 lds
    buffer_load_dwordx4 v27, s[72:75], s65 offen offset:3072 lds
    s_add_u32 m0, m0, 4096
    s_add_u32 s66, s66, 1
    v_readlane_b32 s84, v73, s66
    s_add_u32 s64, s64, 8192
    s_cmp_eq_u32 s64, 147456
    s_cselect_b32 s64, 65536, s64
    s_waitcnt vmcnt(12)
    s_barrier
    buffer_load_dwordx4 v28, s[72:75], s65 offen offset:0 lds
    buffer_load_dwordx4 v29, s[72:75], s65 offen offset:1024 lds
    buffer_load_dwordx4 v30, s[72:75], s65 offen offset:2048 lds
    buffer_load_dwordx4 v31, s[72:75], s65 offen offset:3072 lds
    s_mov_b32 m0, s64
    s_mov_b32 s65, s84
    s_waitcnt vmcnt(8)
    s_barrier
    s_waitcnt vmcnt(0)
    s_barrier
    s_mov_b32 s64, 65536
    s_mov_b32 s66, 0
    s_mov_b32 m0, s64
    s_waitcnt lgkmcnt(0)
    v_readlane_b32 s65, v72, 0
    s_nop 4
    s_barrier
    s_nop 0
    s_mov_b32 s85, 4
.ll_10:
    buffer_load_dwordx4 v8, s[68:71], s65 offen offset:0 lds
    buffer_load_dwordx4 v9, s[68:71], s65 offen offset:1024 lds
    buffer_load_dwordx4 v10, s[68:71], s65 offen offset:2048 lds
    buffer_load_dwordx4 v11, s[68:71], s65 offen offset:3072 lds
    s_add_u32 m0, m0, 4096
    s_add_u32 s66, s66, 1
    v_readlane_b32 s84, v72, s66
    s_add_u32 s64, s64, 8192
    s_cmp_eq_u32 s64, 147456
    s_cselect_b32 s64, 65536, s64
    s_sub_u32 s85, s85, 1
    s_cmp_lg_u32 s85, 0
    buffer_load_dwordx4 v12, s[68:71], s65 offen offset:0 lds
    buffer_load_dwordx4 v13, s[68:71], s65 offen offset:1024 lds
    buffer_load_dwordx4 v14, s[68:71], s65 offen offset:2048 lds
    buffer_load_dwordx4 v15, s[68:71], s65 offen offset:3072 lds
    s_mov_b32 m0, s64
    s_mov_b32 s65, s84
    s_cbranch_scc1 .ll_10
    s_barrier
    s_sub_u32 s29, s33, s36
    s_and_b32 s29, s29, 3
    s_and_b32 s30, s33, 8
    s_sub_u32 s29, 4, s29
    v_add3_u32 v2, v1, s29, -1
    v_lshrrev_b32 v2, 2, v2
    v_add_u32 v3, s29, v1
    v_lshrrev_b32 v3, 2, v3
    v_add_u32 v4, 2, v1
    v_min_u32 v4, 15, v4
    v_add_u32 v4, s29, v4
    v_lshrrev_b32 v4, 2, v4
    v_sub_u32 v4, v4, v2
    v_add_u32 v4, v4, v1
    v_subrev_u32 v5, 2, v1
    v_max_i32 v5, 0, v5
    v_add3_u32 v6, v5, s29, -1
    v_lshrrev_b32 v6, 2, v6
    v_sub_u32 v5, v5, v6
    v_add_u32 v5, v5, v2
    v_cmp_ne_u32 vcc, v3, v2
    s_nop 1
    v_cndmask_b32 v5, v4, v5, vcc
    v_cmp_gt_u32 vcc, 16, v1
    s_nop 1
    v_cndmask_b32_e64 v5, v1, v5, vcc
    v_add_lshl_u32 v5, v5, 0, 2
    v_add_u32 v6, s30, v1
    v_and_b32 v6, 15, v6
    v_mul_u32_u24 v6, 458752, v6
    ds_permute_b32 v73, v5, v6
    v_lshrrev_b32 v2, 3, v1
    v_and_b32 v4, 6, v2
    v_mul_u32_u24 v2, 7168, v2
    v_and_b32 v3, 7, v1
    v_xor_b32 v3, v3, v4
    v_lshl_add_u32 v24, v3, 4, v2
    v_add_u32 v25, 56320, v24
    v_add_u32 v26, 112640, v24
    v_add_u32 v27, 112640, v25
    v_add_u32 v28, 229376, v24
    v_add_u32 v29, 229376, v25
    v_add_u32 v30, 229376, v26
    v_add_u32 v31, 229376, v27
    v_add_u32 v32, 128, v24
    v_add_u32 v33, 128, v25
    v_add_u32 v34, 128, v26
    v_add_u32 v35, 128, v27
    v_add_u32 v36, 229504, v24
    v_add_u32 v37, 229504, v25
    v_add_u32 v38, 229504, v26
    v_add_u32 v39, 229504, v27
    s_waitcnt lgkmcnt(0)
    s_lshl_b32 s28, s35, 8
    s_add_u32 s74, s28, 3584
    s_add_u32 s72, s14, s74
    s_addc_u32 s73, s15, 0
    s_mov_b32 s74, 0
    s_mov_b32 s75, 0x20000
    s_sub_u32 s74, 7336448, s28
    s_sub_u32 s29, s33, s36
    s_and_b32 s29, s29, 3
    s_and_b32 s30, s33, 8
    s_sub_u32 s29, 4, s29
    v_add3_u32 v2, v1, s29, -1
    v_lshrrev_b32 v2, 2, v2
    v_add_u32 v3, s29, v1
    v_lshrrev_b32 v3, 2, v3
    v_add_u32 v4, 2, v1
    v_min_u32 v4, 15, v4
    v_add_u32 v4, s29, v4
    v_lshrrev_b32 v4, 2, v4
    v_sub_u32 v4, v4, v2
    v_add_u32 v4, v4, v1
    v_subrev_u32 v5, 2, v1
    v_max_i32 v5, 0, v5
    v_add3_u32 v6, v5, s29, -1
    v_lshrrev_b32 v6, 2, v6
    v_sub_u32 v5, v5, v6
    v_add_u32 v5, v5, v2
    v_cmp_ne_u32 vcc, v3, v2
    s_nop 1
    v_cndmask_b32 v5, v4, v5, vcc
    v_add_u32 v5, 4, v5
    v_and_b32 v5, 15, v5
    v_cmp_gt_u32 vcc, 16, v1
    s_nop 1
    v_cndmask_b32_e64 v5, v1, v5, vcc
    v_add_lshl_u32 v5, v5, 0, 2
    v_add_u32 v6, s30, v1
    v_and_b32 v6, 15, v6
    v_mul_u32_u24 v6, 458752, v6
    ds_permute_b32 v74, v5, v6
    v_lshrrev_b32 v2, 3, v1
    v_and_b32 v4, 6, v2
    v_mul_u32_u24 v2, 7168, v2
    v_and_b32 v3, 7, v1
    v_xor_b32 v3, v3, v4
    v_lshl_add_u32 v40, v3, 4, v2
    v_add_u32 v41, 56320, v40
    v_add_u32 v42, 112640, v40
    v_add_u32 v43, 112640, v41
    v_add_u32 v44, 229376, v40
    v_add_u32 v45, 229376, v41
    v_add_u32 v46, 229376, v42
    v_add_u32 v47, 229376, v43
    v_add_u32 v48, 128, v40
    v_add_u32 v49, 128, v41
    v_add_u32 v50, 128, v42
    v_add_u32 v51, 128, v43
    v_add_u32 v52, 229504, v40
    v_add_u32 v53, 229504, v41
    v_add_u32 v54, 229504, v42
    v_add_u32 v55, 229504, v43
    s_waitcnt lgkmcnt(0)
    s_lshl_b32 s28, s35, 8
    s_add_u32 s76, s14, s28
    s_addc_u32 s77, s15, 0
    s_mov_b32 s78, 0
    s_mov_b32 s79, 0x20000
    s_sub_u32 s78, 7340032, s28
    s_barrier
    s_nop 0
    s_mov_b32 s85, 6
.ll_11:
    buffer_load_dwordx4 v8, s[68:71], s65 offen offset:0 lds
    buffer_load_dwordx4 v9, s[68:71], s65 offen offset:1024 lds
    buffer_load_dwordx4 v10, s[68:71], s65 offen offset:2048 lds
    buffer_load_dwordx4 v11, s[68:71], s65 offen offset:3072 lds
    s_add_u32 m0, m0, 4096
    s_add_u32 s66, s66, 1
    v_readlane_b32 s84, v72, s66
    s_add_u32 s64, s64, 8192
    s_cmp_eq_u32 s64, 147456
    s_cselect_b32 s64, 65536, s64
    s_sub_u32 s85, s85, 1
    s_cmp_lg_u32 s85, 0
    buffer_load_dwordx4 v12, s[68:71], s65 offen offset:0 lds
    buffer_load_dwordx4 v13, s[68:71], s65 offen offset:1024 lds
    buffer_load_dwordx4 v14, s[68:71], s65 offen offset:2048 lds
    buffer_load_dwordx4 v15, s[68:71], s65 offen offset:3072 lds
    s_mov_b32 m0, s64
    s_mov_b32 s65, s84
    s_cbranch_scc1 .ll_11
    s_waitcnt vmcnt(63)
    s_barrier
    s_waitcnt vmcnt(63)
    s_barrier
    buffer_load_dwordx4 v8, s[68:71], s65 offen offset:0 lds
    buffer_load_dwordx4 v9, s[68:71], s65 offen offset:1024 lds
    buffer_load_dwordx4 v10, s[68:71], s65 offen offset:2048 lds
    buffer_load_dwordx4 v11, s[68:71], s65 offen offset:3072 lds
    s_add_u32 m0, m0, 4096
    s_add_u32 s66, s66, 1
    v_readlane_b32 s84, v72, s66
    s_add_u32 s64, s64, 8192
    s_cmp_eq_u32 s64, 147456
    s_cselect_b32 s64, 65536, s64
    s_waitcnt vmcnt(60)
    s_barrier
    buffer_load_dwordx4 v12, s[68:71], s65 offen offset:0 lds
    buffer_load_dwordx4 v13, s[68:71], s65 offen offset:1024 lds
    buffer_load_dwordx4 v14, s[68:71], s65 offen offset:2048 lds
    buffer_load_dwordx4 v15, s[68:71], s65 offen offset:3072 lds
    s_mov_b32 m0, s64
    s_mov_b32 s65, s84
    s_waitcnt vmcnt(56)
    s_nop 0
    s_barrier
    buffer_load_dwordx4 v8, s[68:71], s65 offen offset:0 lds
    buffer_load_dwordx4 v9, s[68:71], s65 offen offset:1024 lds
    buffer_load_dwordx4 v10, s[68:71], s65 offen offset:2048 lds
    buffer_load_dwordx4 v11, s[68:71], s65 offen offset:3072 lds
    s_add_u32 m0, m0, 4096
    s_add_u32 s66, s66, 1
    v_readlane_b32 s84, v72, s66
    s_add_u32 s64, s64, 8192
    s_cmp_eq_u32 s64, 147456
    s_cselect_b32 s64, 65536, s64
    s_waitcnt vmcnt(52)
    s_barrier
    buffer_load_dwordx4 v12, s[68:71], s65 offen offset:0 lds
    buffer_load_dwordx4 v13, s[68:71], s65 offen offset:1024 lds
    buffer_load_dwordx4 v14, s[68:71], s65 offen offset:2048 lds
    s_waitcnt vmcnt(47)
    s_barrier
    buffer_load_dwordx4 v15, s[68:71], s65 offen offset:3072 lds
    s_mov_b32 m0, s64
    s_mov_b32 s65, s84
    buffer_load_dwordx4 v8, s[68:71], s65 offen offset:0 lds
    buffer_load_dwordx4 v9, s[68:71], s65 offen offset:1024 lds
    buffer_load_dwordx4 v10, s[68:71], s65 offen offset:2048 lds
    s_waitcnt vmcnt(43)
    s_barrier
    buffer_load_dwordx4 v11, s[68:71], s65 offen offset:3072 lds
    s_add_u32 m0, m0, 4096
    s_add_u32 s66, s66, 1
    v_readlane_b32 s84, v72, s66
    s_add_u32 s64, s64, 8192
    s_cmp_eq_u32 s64, 147456
    s_cselect_b32 s64, 65536, s64
    buffer_load_dwordx4 v12, s[68:71], s65 offen offset:0 lds
    buffer_load_dwordx4 v13, s[68:71], s65 offen offset:1024 lds
    buffer_load_dwordx4 v14, s[68:71], s65 offen offset:2048 lds
    s_waitcnt vmcnt(39)
    s_barrier
    buffer_load_dwordx4 v15, s[68:71], s65 offen offset:3072 lds
    s_mov_b32 m0, s64
    s_mov_b32 s65, s84
    buffer_load_dwordx4 v8, s[68:71], s65 offen offset:0 lds
    buffer_load_dwordx4 v9, s[68:71], s65 offen offset:1024 lds
    s_waitcnt vmcnt(34)
    s_barrier
    buffer_load_dwordx4 v10, s[68:71], s65 offen offset:2048 lds
    buffer_load_dwordx4 v11, s[68:71], s65 offen offset:3072 lds
    s_add_u32 m0, m0, 4096
    s_nop 0
    s_add_u32 s66, s66, 1
    v_readlane_b32 s84, v72, s66
    s_add_u32 s64, s64, 8192
    s_cmp_eq_u32 s64, 147456
    s_cselect_b32 s64, 65536, s64
    buffer_load_dwordx4 v12, s[68:71], s65 offen offset:0 lds
    buffer_load_dwordx4 v13, s[68:71], s65 offen offset:1024 lds
    s_waitcnt vmcnt(30)
    s_barrier
    buffer_load_dwordx4 v14, s[68:71], s65 offen offset:2048 lds
    buffer_load_dwordx4 v15, s[68:71], s65 offen offset:3072 lds
    s_mov_b32 m0, s64
    s_mov_b32 s65, s84
    buffer_load_dwordx4 v8, s[68:71], s65 offen offset:0 lds
    buffer_load_dwordx4 v9, s[68:71], s65 offen offset:1024 lds
    s_waitcnt vmcnt(26)
    s_barrier
    buffer_load_dwordx4 v10, s[68:71], s65 offen offset:2048 lds
    buffer_load_dwordx4 v11, s[68:71], s65 offen offset:3072 lds
    s_add_u32 m0, m0, 4096
    s_nop 0
    s_add_u32 s66, s66, 1
    v_readlane_b32 s84, v72, s66
    s_add_u32 s64, s64, 8192
    s_cmp_eq_u32 s64, 147456
    s_cselect_b32 s64, 65536, s64
    buffer_load_dwordx4 v12, s[68:71], s65 offen offset:0 lds
    s_waitcnt vmcnt(21)
    s_barrier
    buffer_load_dwordx4 v13, s[68:71], s65 offen offset:1024 lds
    buffer_load_dwordx4 v14, s[68:71], s65 offen offset:2048 lds
    buffer_load_dwordx4 v15, s[68:71], s65 offen offset:3072 lds
    s_mov_b32 m0, s64
    s_mov_b32 s65, s84
    buffer_load_dwordx4 v8, s[68:71], s65 offen offset:0 lds
    s_waitcnt vmcnt(17)
    s_barrier
    buffer_load_dwordx4 v9, s[68:71], s65 offen offset:1024 lds
    buffer_load_dwordx4 v10, s[68:71], s65 offen offset:2048 lds
    buffer_load_dwordx4 v11, s[68:71], s65 offen offset:3072 lds
    s_add_u32 m0, m0, 4096
    s_nop 0
    s_add_u32 s66, s66, 1
    v_readlane_b32 s84, v72, s66
    s_add_u32 s64, s64, 8192
    s_cmp_eq_u32 s64, 147456
    s_cselect_b32 s64, 65536, s64
    buffer_load_dwordx4 v12, s[68:71], s65 offen offset:0 lds
    s_waitcnt vmcnt(13)
    s_barrier
    buffer_load_dwordx4 v13, s[68:71], s65 offen offset:1024 lds
    buffer_load_dwordx4 v14, s[68:71], s65 offen offset:2048 lds
    buffer_load_dwordx4 v15, s[68:71], s65 offen offset:3072 lds
    s_mov_b32 m0, s64
    s_mov_b32 s65, s84
    s_waitcnt vmcnt(8)
    s_barrier
    s_waitcnt vmcnt(0)
    s_barrier
    s_mov_b32 s64, 65536
    s_mov_b32 s66, 0
    s_mov_b32 m0, s64
    s_waitcnt lgkmcnt(0)
    v_readlane_b32 s65, v73, 0
    s_nop 4
    s_barrier
    s_sub_u32 s29, s33, s36
    s_and_b32 s29, s29, 3
    s_and_b32 s30, s33, 12
    s_lshl_b32 s30, s30, 1
    s_sub_u32 s29, 4, s29
    v_lshrrev_b32_e64 v75, 1, v1
    v_add3_u32 v2, v75, s29, -1
    v_lshrrev_b32 v2, 2, v2
    v_add_u32 v3, s29, v75
    v_lshrrev_b32 v3, 2, v3
    v_add_u32 v4, 1, v75
    v_min_u32 v4, 15, v4
    v_add_u32 v4, s29, v4
    v_lshrrev_b32 v4, 2, v4
    v_sub_u32 v4, v4, v2
    v_add_u32 v4, v4, v75
    v_subrev_u32 v5, 1, v75
    v_max_i32_e64 v5, 0, v5
    v_add3_u32 v6, v5, s29, -1
    v_lshrrev_b32 v6, 2, v6
    v_sub_u32 v5, v5, v6
    v_add_u32 v5, v5, v2
    v_cmp_ne_u32 vcc, v3, v2
    s_nop 1
    v_cndmask_b32 v5, v4, v5, vcc
    v_and_b32_e64 v3, 1, v1
    v_lshl_add_u32 v5, v5, 1, v3
    v_cmp_gt_u32 vcc, 32, v1
    s_nop 1
    v_cndmask_b32_e64 v5, v1, v5, vcc
    v_add_lshl_u32 v5, v5, 0, 2
    v_add_u32 v6, s30, v1
    v_and_b32 v6, 31, v6
    v_mul_u32_u24 v6, 16384, v6
    ds_permute_b32 v75, v5, v6
    v_lshlrev_b32_e64 v56, 4, v1
    v_add_u32 v57, 4096, v56
    v_add_u32 v58, 8192, v56
    v_add_u32 v59, 12288, v56
    s_waitcnt lgkmcnt(0)
    s_lshl_b32 s28, s35, 19
    s_add_u32 s82, s28, 8388608
    s_add_u32 s80, s26, s82
    s_addc_u32 s81, s27, 0
    s_mov_b32 s82, 524288
    s_mov_b32 s83, 0x20000
    s_barrier
    s_cmp_ge_u32 s35, 14
    s_cbranch_scc1 .helper_job
    s_mov_b32 s85, 4
.ll_12:
    buffer_load_dwordx4 v24, s[72:75], s65 offen offset:0 lds
    buffer_load_dwordx4 v25, s[72:75], s65 offen offset:1024 lds
    buffer_load_dwordx4 v26, s[72:75], s65 offen offset:2048 lds
    buffer_load_dwordx4 v27, s[72:75], s65 offen offset:3072 lds
    s_add_u32 m0, m0, 4096
    s_add_u32 s64, s64, 16384
    s_cmp_eq_u32 s64, 147456
    s_cselect_b32 s64, 65536, s64
    buffer_load_dwordx4 v28, s[72:75], s65 offen offset:0 lds
    buffer_load_dwordx4 v29, s[72:75], s65 offen offset:1024 lds
    buffer_load_dwordx4 v30, s[72:75], s65 offen offset:2048 lds
    buffer_load_dwordx4 v31, s[72:75], s65 offen offset:3072 lds
    s_add_u32 m0, m0, 4096
    s_add_u32 s66, s66, 1
    v_readlane_b32 s84, v73, s66
    buffer_load_dwordx4 v32, s[72:75], s65 offen offset:0 lds
    buffer_load_dwordx4 v33, s[72:75], s65 offen offset:1024 lds
    buffer_load_dwordx4 v34, s[72:75], s65 offen offset:2048 lds
    buffer_load_dwordx4 v35, s[72:75], s65 offen offset:3072 lds
    s_add_u32 m0, m0, 4096
    s_sub_u32 s85, s85, 1
    s_cmp_lg_u32 s85, 0
    buffer_load_dwordx4 v36, s[72:75], s65 offen offset:0 lds
    buffer_load_dwordx4 v37, s[72:75], s65 offen offset:1024 lds
    buffer_load_dwordx4 v38, s[72:75], s65 offen offset:2048 lds
    buffer_load_dwordx4 v39, s[72:75], s65 offen offset:3072 lds
    s_mov_b32 m0, s64
    s_mov_b32 s65, s84
    s_cbranch_scc1 .ll_12
    s_waitcnt vmcnt(48)
    s_barrier
    s_waitcnt vmcnt(32)
    s_barrier
    buffer_load_dwordx4 v24, s[72:75], s65 offen offset:0 lds
    buffer_load_dwordx4 v25, s[72:75], s65 offen offset:1024 lds
    buffer_load_dwordx4 v26, s[72:75], s65 offen offset:2048 lds
    buffer_load_dwordx4 v27, s[72:75], s65 offen offset:3072 lds
    s_add_u32 m0, m0, 4096
    s_add_u32 s64, s64, 16384
    s_cmp_eq_u32 s64, 147456
    s_cselect_b32 s64, 65536, s64
    buffer_load_dwordx4 v28, s[72:75], s65 offen offset:0 lds
    buffer_load_dwordx4 v29, s[72:75], s65 offen offset:1024 lds
    buffer_load_dwordx4 v30, s[72:75], s65 offen offset:2048 lds
    buffer_load_dwordx4 v31, s[72:75], s65 offen offset:3072 lds
    s_add_u32 m0, m0, 4096
    s_nop 0
    s_add_u32 s66, s66, 1
    v_readlane_b32 s84, v73, s66
    buffer_load_dwordx4 v32, s[72:75], s65 offen offset:0 lds
    buffer_load_dwordx4 v33, s[72:75], s65 offen offset:1024 lds
    buffer_load_dwordx4 v34, s[72:75], s65 offen offset:2048 lds
    buffer_load_dwordx4 v35, s[72:75], s65 offen offset:3072 lds
    s_add_u32 m0, m0, 4096
    s_nop 0
    buffer_load_dwordx4 v36, s[72:75], s65 offen offset:0 lds
    buffer_load_dwordx4 v37, s[72:75], s65 offen offset:1024 lds
    buffer_load_dwordx4 v38, s[72:75], s65 offen offset:2048 lds
    s_waitcnt vmcnt(31)
    s_barrier
    buffer_load_dwordx4 v39, s[72:75], s65 offen offset:3072 lds
    s_mov_b32 m0, s64
    s_nop 0
    s_mov_b32 s65, s84
    buffer_load_dwordx4 v24, s[72:75], s65 offen offset:0 lds
    buffer_load_dwordx4 v25, s[72:75], s65 offen offset:1024 lds
    buffer_load_dwordx4 v26, s[72:75], s65 offen offset:2048 lds
    buffer_load_dwordx4 v27, s[72:75], s65 offen offset:3072 lds
    s_branch .pg_10
.p2align 12
.pad_10:
    s_nop 0
    s_setpc_b64 s[44:45]
.pg_10:
    s_add_u32 m0, m0, 4096
    s_add_u32 s64, s64, 16384
    s_cmp_eq_u32 s64, 147456
    s_cselect_b32 s64, 65536, s64
    buffer_load_dwordx4 v28, s[72:75], s65 offen offset:0 lds
    buffer_load_dwordx4 v29, s[72:75], s65 offen offset:1024 lds
    buffer_load_dwordx4 v30, s[72:75], s65 offen offset:2048 lds
    buffer_load_dwordx4 v31, s[72:75], s65 offen offset:3072 lds
    s_add_u32 m0, m0, 4096
    s_nop 0
    s_add_u32 s66, s66, 1
    v_readlane_b32 s84, v73, s66
    buffer_load_dwordx4 v32, s[72:75], s65 offen offset:0 lds
    buffer_load_dwordx4 v33, s[72:75], s65 offen offset:1024 lds
    buffer_load_dwordx4 v34, s[72:75], s65 offen offset:2048 lds
    buffer_load_dwordx4 v35, s[72:75], s65 offen offset:3072 lds
    s_add_u32 m0, m0, 4096
    s_nop 0
    buffer_load_dwordx4 v36, s[72:75], s65 offen offset:0 lds
    buffer_load_dwordx4 v37, s[72:75], s65 offen offset:1024 lds
    s_waitcnt vmcnt(30)
    s_barrier
    buffer_load_dwordx4 v38, s[72:75], s65 offen offset:2048 lds
    buffer_load_dwordx4 v39, s[72:75], s65 offen offset:3072 lds
    s_mov_b32 m0, s64
    s_nop 0
    s_mov_b32 s65, s84
    buffer_load_dwordx4 v24, s[72:75], s65 offen offset:0 lds
    buffer_load_dwordx4 v25, s[72:75], s65 offen offset:1024 lds
    buffer_load_dwordx4 v26, s[72:75], s65 offen offset:2048 lds
    buffer_load_dwordx4 v27, s[72:75], s65 offen offset:3072 lds
    s_add_u32 m0, m0, 4096
    s_add_u32 s64, s64, 16384
    s_cmp_eq_u32 s64, 147456
    s_cselect_b32 s64, 65536, s64
    buffer_load_dwordx4 v28, s[72:75], s65 offen offset:0 lds
    buffer_load_dwordx4 v29, s[72:75], s65 offen offset:1024 lds
    buffer_load_dwordx4 v30, s[72:75], s65 offen offset:2048 lds
    buffer_load_dwordx4 v31, s[72:75], s65 offen offset:3072 lds
    s_add_u32 m0, m0, 4096
    s_nop 0
    s_add_u32 s66, s66, 1
    v_readlane_b32 s84, v73, s66
    buffer_load_dwordx4 v32, s[72:75], s65 offen offset:0 lds
    buffer_load_dwordx4 v33, s[72:75], s65 offen offset:1024 lds
    buffer_load_dwordx4 v34, s[72:75], s65 offen offset:2048 lds
    buffer_load_dwordx4 v35, s[72:75], s65 offen offset:3072 lds
    s_add_u32 m0, m0, 4096
    s_nop 0
    buffer_load_dwordx4 v36, s[72:75], s65 offen offset:0 lds
    s_waitcnt vmcnt(29)
    s_barrier
    buffer_load_dwordx4 v37, s[72:75], s65 offen offset:1024 lds
    buffer_load_dwordx4 v38, s[72:75], s65 offen offset:2048 lds
    buffer_load_dwordx4 v39, s[72:75], s65 offen offset:3072 lds
    s_mov_b32 m0, s64
    s_nop 0
    s_mov_b32 s65, s84
    buffer_load_dwordx4 v24, s[72:75], s65 offen offset:0 lds
    buffer_load_dwordx4 v25, s[72:75], s65 offen offset:1024 lds
    buffer_load_dwordx4 v26, s[72:75], s65 offen offset:2048 lds
    buffer_load_dwordx4 v27, s[72:75], s65 offen offset:3072 lds
    s_add_u32 m0, m0, 4096
    s_add_u32 s64, s64, 16384
    s_cmp_eq_u32 s64, 147456
    s_cselect_b32 s64, 65536, s64
    buffer_load_dwordx4 v28, s[72:75], s65 offen offset:0 lds
    buffer_load_dwordx4 v29, s[72:75], s65 offen offset:1024 lds
    buffer_load_dwordx4 v30, s[72:75], s65 offen offset:2048 lds
    buffer_load_dwordx4 v31, s[72:75], s65 offen offset:3072 lds
    s_add_u32 m0, m0, 4096
    s_nop 0
    s_add_u32 s66, s66, 1
    v_readlane_b32 s84, v73, s66
    buffer_load_dwordx4 v32, s[72:75], s65 offen offset:0 lds
    buffer_load_dwordx4 v33, s[72:75], s65 offen offset:1024 lds
    buffer_load_dwordx4 v34, s[72:75], s65 offen offset:2048 lds
    buffer_load_dwordx4 v35, s[72:75], s65 offen offset:3072 lds
    s_add_u32 m0, m0, 4096
    s_waitcnt vmcnt(28)
    s_barrier
    buffer_load_dwordx4 v36, s[72:75], s65 offen offset:0 lds
    buffer_load_dwordx4 v37, s[72:75], s65 offen offset:1024 lds
    buffer_load_dwordx4 v38, s[72:75], s65 offen offset:2048 lds
    buffer_load_dwordx4 v39, s[72:75], s65 offen offset:3072 lds
    s_mov_b32 m0, s64
    s_mov_b32 s65, s84
    buffer_load_dwordx4 v24, s[72:75], s65 offen offset:0 lds
    buffer_load_dwordx4 v25, s[72:75], s65 offen offset:1024 lds
    buffer_load_dwordx4 v26, s[72:75], s65 offen offset:2048 lds
    buffer_load_dwordx4 v27, s[72:75], s65 offen offset:3072 lds
    s_add_u32 m0, m0, 4096
    s_add_u32 s64, s64, 16384
    s_cmp_eq_u32 s64, 147456
    s_cselect_b32 s64, 65536, s64
    buffer_load_dwordx4 v28, s[72:75], s65 offen offset:0 lds
    buffer_load_dwordx4 v29, s[72:75], s65 offen offset:1024 lds
    buffer_load_dwordx4 v30, s[72:75], s65 offen offset:2048 lds
    buffer_load_dwordx4 v31, s[72:75], s65 offen offset:3072 lds
    s_add_u32 m0, m0, 4096
    s_add_u32 s66, s66, 1
    v_readlane_b32 s84, v73, s66
    buffer_load_dwordx4 v32, s[72:75], s65 offen offset:0 lds
    buffer_load_dwordx4 v33, s[72:75], s65 offen offset:1024 lds
    s_waitcnt vmcnt(26)
    s_barrier
    buffer_load_dwordx4 v34, s[72:75], s65 offen offset:2048 lds
    buffer_load_dwordx4 v35, s[72:75], s65 offen offset:3072 lds
    s_add_u32 m0, m0, 4096
    s_nop 0
    buffer_load_dwordx4 v36, s[72:75], s65 offen offset:0 lds
    buffer_load_dwordx4 v37, s[72:75], s65 offen offset:1024 lds
    buffer_load_dwordx4 v38, s[72:75], s65 offen offset:2048 lds
    buffer_load_dwordx4 v39, s[72:75], s65 offen offset:3072 lds
    s_mov_b32 m0, s64
    s_mov_b32 s65, s84
    buffer_load_dwordx4 v24, s[72:75], s65 offen offset:0 lds
    buffer_load_dwordx4 v25, s[72:75], s65 offen offset:1024 lds
    buffer_load_dwordx4 v26, s[72:75], s65 offen offset:2048 lds
    buffer_load_dwordx4 v27, s[72:75], s65 offen offset:3072 lds
    s_add_u32 m0, m0, 4096
    s_add_u32 s64, s64, 16384
    s_cmp_eq_u32 s64, 147456
    s_cselect_b32 s64, 65536, s64
    buffer_load_dwordx4 v28, s[72:75], s65 offen offset:0 lds
    buffer_load_dwordx4 v29, s[72:75], s65 offen offset:1024 lds
    buffer_load_dwordx4 v30, s[72:75], s65 offen offset:2048 lds
    buffer_load_dwordx4 v31, s[72:75], s65 offen offset:3072 lds
    s_add_u32 m0, m0, 4096
    s_add_u32 s66, s66, 1
    v_readlane_b32 s84, v73, s66
    buffer_load_dwordx4 v32, s[72:75], s65 offen offset:0 lds
    s_waitcnt vmcnt(25)
    s_barrier
    buffer_load_dwordx4 v33, s[72:75], s65 offen offset:1024 lds
    buffer_load_dwordx4 v34, s[72:75], s65 offen offset:2048 lds
    buffer_load_dwordx4 v35, s[72:75], s65 offen offset:3072 lds
    s_add_u32 m0, m0, 4096
    s_nop 0
    buffer_load_dwordx4 v36, s[72:75], s65 offen offset:0 lds
    buffer_load_dwordx4 v37, s[72:75], s65 offen offset:1024 lds
    buffer_load_dwordx4 v38, s[72:75], s65 offen offset:2048 lds
    buffer_load_dwordx4 v39, s[72:75], s65 offen offset:3072 lds
    s_mov_b32 m0, s64
    s_mov_b32 s65, s84
    buffer_load_dwordx4 v24, s[72:75], s65 offen offset:0 lds
    buffer_load_dwordx4 v25, s[72:75], s65 offen offset:1024 lds
    buffer_load_dwordx4 v26, s[72:75], s65 offen offset:2048 lds
    buffer_load_dwordx4 v27, s[72:75], s65 offen offset:3072 lds
    s_add_u32 m0, m0, 4096
    s_add_u32 s64, s64, 16384
    s_cmp_eq_u32 s64, 147456
    s_cselect_b32 s64, 65536, s64
    buffer_load_dwordx4 v28, s[72:75], s65 offen offset:0 lds
    buffer_load_dwordx4 v29, s[72:75], s65 offen offset:1024 lds
    buffer_load_dwordx4 v30, s[72:75], s65 offen offset:2048 lds
    buffer_load_dwordx4 v31, s[72:75], s65 offen offset:3072 lds
    s_add_u32 m0, m0, 4096
    s_add_u32 s66, s66, 1
    v_readlane_b32 s84, v73, s66
    s_waitcnt vmcnt(24)
    s_nop 0
    s_barrier
    buffer_load_dwordx4 v32, s[72:75], s65 offen offset:0 lds
    buffer_load_dwordx4 v33, s[72:75], s65 offen offset:1024 lds
    buffer_load_dwordx4 v34, s[72:75], s65 offen offset:2048 lds
    buffer_load_dwordx4 v35, s[72:75], s65 offen offset:3072 lds
    s_add_u32 m0, m0, 4096
    s_nop 0
    buffer_load_dwordx4 v36, s[72:75], s65 offen offset:0 lds
    buffer_load_dwordx4 v37, s[72:75], s65 offen offset:1024 lds
    buffer_load_dwordx4 v38, s[72:75], s65 offen offset:2048 lds
    buffer_load_dwordx4 v39, s[72:75], s65 offen offset:3072 lds
    s_mov_b32 m0, s64
    s_nop 0
    s_mov_b32 s65, s84
    buffer_load_dwordx4 v24, s[72:75], s65 offen offset:0 lds
    buffer_load_dwordx4 v25, s[72:75], s65 offen offset:1024 lds
    buffer_load_dwordx4 v26, s[72:75], s65 offen offset:2048 lds
    buffer_load_dwordx4 v27, s[72:75], s65 offen offset:3072 lds
    s_add_u32 m0, m0, 4096
    s_add_u32 s64, s64, 16384
    s_cmp_eq_u32 s64, 147456
    s_cselect_b32 s64, 65536, s64
    buffer_load_dwordx4 v28, s[72:75], s65 offen offset:0 lds
    buffer_load_dwordx4 v29, s[72:75], s65 offen offset:1024 lds
    buffer_load_dwordx4 v30, s[72:75], s65 offen offset:2048 lds
    s_waitcnt vmcnt(23)
    s_barrier
    buffer_load_dwordx4 v31, s[72:75], s65 offen offset:3072 lds
    s_add_u32 m0, m0, 4096
    s_nop 0
    s_add_u32 s66, s66, 1
    v_readlane_b32 s84, v73, s66
    buffer_load_dwordx4 v32, s[72:75], s65 offen offset:0 lds
    buffer_load_dwordx4 v33, s[72:75], s65 offen offset:1024 lds
    buffer_load_dwordx4 v34, s[72:75], s65 offen offset:2048 lds
    buffer_load_dwordx4 v35, s[72:75], s65 offen offset:3072 lds
    s_add_u32 m0, m0, 4096
    s_nop 0
    buffer_load_dwordx4 v36, s[72:75], s65 offen offset:0 lds
    buffer_load_dwordx4 v37, s[72:75], s65 offen offset:1024 lds
    buffer_load_dwordx4 v38, s[72:75], s65 offen offset:2048 lds
    buffer_load_dwordx4 v39, s[72:75], s65 offen offset:3072 lds
    s_mov_b32 m0, s64
    s_nop 0
    s_mov_b32 s65, s84
    buffer_load_dwordx4 v24, s[72:75], s65 offen offset:0 lds
    buffer_load_dwordx4 v25, s[72:75], s65 offen offset:1024 lds
    buffer_load_dwordx4 v26, s[72:75], s65 offen offset:2048 lds
    buffer_load_dwordx4 v27, s[72:75], s65 offen offset:3072 lds
    s_add_u32 m0, m0, 4096
    s_add_u32 s64, s64, 16384
    s_cmp_eq_u32 s64, 147456
    s_cselect_b32 s64, 65536, s64
    buffer_load_dwordx4 v28, s[72:75], s65 offen offset:0 lds
    s_waitcnt vmcnt(21)
    s_barrier
    buffer_load_dwordx4 v29, s[72:75], s65 offen offset:1024 lds
    buffer_load_dwordx4 v30, s[72:75], s65 offen offset:2048 lds
    buffer_load_dwordx4 v31, s[72:75], s65 offen offset:3072 lds
    s_add_u32 m0, m0, 4096
    s_nop 0
    s_add_u32 s66, s66, 1
    v_readlane_b32 s84, v73, s66
    buffer_load_dwordx4 v32, s[72:75], s65 offen offset:0 lds
    buffer_load_dwordx4 v33, s[72:75], s65 offen offset:1024 lds
    buffer_load_dwordx4 v34, s[72:75], s65 offen offset:2048 lds
    buffer_load_dwordx4 v35, s[72:75], s65 offen offset:3072 lds
    s_add_u32 m0, m0, 4096
    s_nop 0
    buffer_load_dwordx4 v36, s[72:75], s65 offen offset:0 lds
    buffer_load_dwordx4 v37, s[72:75], s65 offen offset:1024 lds
    buffer_load_dwordx4 v38, s[72:75], s65 offen offset:2048 lds
    buffer_load_dwordx4 v39, s[72:75], s65 offen offset:3072 lds
    s_mov_b32 m0, s64
    s_nop 0
    s_mov_b32 s65, s84
    buffer_load_dwordx4 v24, s[72:75], s65 offen offset:0 lds
    buffer_load_dwordx4 v25, s[72:75], s65 offen offset:1024 lds
    buffer_load_dwordx4 v26, s[72:75], s65 offen offset:2048 lds
    buffer_load_dwordx4 v27, s[72:75], s65 offen offset:3072 lds
    s_add_u32 m0, m0, 4096
    s_add_u32 s64, s64, 16384
    s_cmp_eq_u32 s64, 147456
    s_cselect_b32 s64, 65536, s64
    s_waitcnt vmcnt(20)
    s_barrier
    buffer_load_dwordx4 v28, s[72:75], s65 offen offset:0 lds
    buffer_load_dwordx4 v29, s[72:75], s65 offen offset:1024 lds
    buffer_load_dwordx4 v30, s[72:75], s65 offen offset:2048 lds
    buffer_load_dwordx4 v31, s[72:75], s65 offen offset:3072 lds
    s_add_u32 m0, m0, 4096
    s_nop 0
    s_add_u32 s66, s66, 1
    v_readlane_b32 s84, v73, s66
    buffer_load_dwordx4 v32, s[72:75], s65 offen offset:0 lds
    buffer_load_dwordx4 v33, s[72:75], s65 offen offset:1024 lds
    buffer_load_dwordx4 v34, s[72:75], s65 offen offset:2048 lds
    buffer_load_dwordx4 v35, s[72:75], s65 offen offset:3072 lds
    s_add_u32 m0, m0, 4096
    s_nop 0
    buffer_load_dwordx4 v36, s[72:75], s65 offen offset:0 lds
    buffer_load_dwordx4 v37, s[72:75], s65 offen offset:1024 lds
    buffer_load_dwordx4 v38, s[72:75], s65 offen offset:2048 lds
    buffer_load_dwordx4 v39, s[72:75], s65 offen offset:3072 lds
    s_mov_b32 m0, s64
    s_mov_b32 s65, s84
    buffer_load_dwordx4 v24, s[72:75], s65 offen offset:0 lds
    buffer_load_dwordx4 v25, s[72:75], s65 offen offset:1024 lds
    buffer_load_dwordx4 v26, s[72:75], s65 offen offset:2048 lds
    s_waitcnt vmcnt(19)
    s_nop 0
    s_barrier
    buffer_load_dwordx4 v27, s[72:75], s65 offen offset:3072 lds
    s_add_u32 m0, m0, 4096
    s_add_u32 s64, s64, 16384
    s_cmp_eq_u32 s64, 147456
    s_cselect_b32 s64, 65536, s64
    buffer_load_dwordx4 v28, s[72:75], s65 offen offset:0 lds
    buffer_load_dwordx4 v29, s[72:75], s65 offen offset:1024 lds
    buffer_load_dwordx4 v30, s[72:75], s65 offen offset:2048 lds
    buffer_load_dwordx4 v31, s[72:75], s65 offen offset:3072 lds
    s_add_u32 m0, m0, 4096
    s_nop 0
    s_add_u32 s66, s66, 1
    v_readlane_b32 s84, v73, s66
    buffer_load_dwordx4 v32, s[72:75], s65 offen offset:0 lds
    buffer_load_dwordx4 v33, s[72:75], s65 offen offset:1024 lds
    buffer_load_dwordx4 v34, s[72:75], s65 offen offset:2048 lds
    buffer_load_dwordx4 v35, s[72:75], s65 offen offset:3072 lds
    s_add_u32 m0, m0, 4096
    s_nop 0
    buffer_load_dwordx4 v36, s[72:75], s65 offen offset:0 lds
    buffer_load_dwordx4 v37, s[72:75], s65 offen offset:1024 lds
    buffer_load_dwordx4 v38, s[72:75], s65 offen offset:2048 lds
    buffer_load_dwordx4 v39, s[72:75], s65 offen offset:3072 lds
    s_mov_b32 m0, s64
    s_mov_b32 s65, s84
    buffer_load_dwordx4 v24, s[72:75], s65 offen offset:0 lds
    buffer_load_dwordx4 v25, s[72:75], s65 offen offset:1024 lds
    s_waitcnt vmcnt(18)
    s_nop 0
    s_barrier
    buffer_load_dwordx4 v26, s[72:75], s65 offen offset:2048 lds
    buffer_load_dwordx4 v27, s[72:75], s65 offen offset:3072 lds
    s_add_u32 m0, m0, 4096
    s_add_u32 s64, s64, 16384
    s_cmp_eq_u32 s64, 147456
    s_cselect_b32 s64, 65536, s64
    buffer_load_dwordx4 v28, s[72:75], s65 offen offset:0 lds
    buffer_load_dwordx4 v29, s[72:75], s65 offen offset:1024 lds
    buffer_load_dwordx4 v30, s[72:75], s65 offen offset:2048 lds
    buffer_load_dwordx4 v31, s[72:75], s65 offen offset:3072 lds
    s_add_u32 m0, m0, 4096
    s_nop 0
    s_add_u32 s66, s66, 1
    v_readlane_b32 s84, v73, s66
    buffer_load_dwordx4 v32, s[72:75], s65 offen offset:0 lds
    buffer_load_dwordx4 v33, s[72:75], s65 offen offset:1024 lds
    buffer_load_dwordx4 v34, s[72:75], s65 offen offset:2048 lds
    buffer_load_dwordx4 v35, s[72:75], s65 offen offset:3072 lds
    s_add_u32 m0, m0, 4096
    s_nop 0
    buffer_load_dwordx4 v36, s[72:75], s65 offen offset:0 lds
    buffer_load_dwordx4 v37, s[72:75], s65 offen offset:1024 lds
    buffer_load_dwordx4 v38, s[72:75], s65 offen offset:2048 lds
    buffer_load_dwordx4 v39, s[72:75], s65 offen offset:3072 lds
    s_mov_b32 m0, s64
    s_mov_b32 s65, s84
    s_waitcnt vmcnt(16)
    s_barrier
    s_waitcnt vmcnt(0)
    s_barrier
    s_mov_b32 s64, 65536
    s_mov_b32 s66, 0
    s_mov_b32 m0, s64
    s_waitcnt lgkmcnt(0)
    v_readlane_b32 s65, v74, 0
    s_nop 4
    s_barrier
    s_nop 0
    s_mov_b32 s85, 5
.ll_13:
    buffer_load_dwordx4 v40, s[76:79], s65 offen offset:0 lds
    buffer_load_dwordx4 v41, s[76:79], s65 offen offset:1024 lds
    buffer_load_dwordx4 v42, s[76:79], s65 offen offset:2048 lds
    buffer_load_dwordx4 v43, s[76:79], s65 offen offset:3072 lds
    s_add_u32 m0, m0, 4096
    s_add_u32 s64, s64, 16384
    s_cmp_eq_u32 s64, 147456
    s_cselect_b32 s64, 65536, s64
    buffer_load_dwordx4 v44, s[76:79], s65 offen offset:0 lds
    buffer_load_dwordx4 v45, s[76:79], s65 offen offset:1024 lds
    buffer_load_dwordx4 v46, s[76:79], s65 offen offset:2048 lds
    buffer_load_dwordx4 v47, s[76:79], s65 offen offset:3072 lds
    s_add_u32 m0, m0, 4096
    s_add_u32 s66, s66, 1
    v_readlane_b32 s84, v74, s66
    buffer_load_dwordx4 v48, s[76:79], s65 offen offset:0 lds
    buffer_load_dwordx4 v49, s[76:79], s65 offen offset:1024 lds
    buffer_load_dwordx4 v50, s[76:79], s65 offen offset:2048 lds
    buffer_load_dwordx4 v51, s[76:79], s65 offen offset:3072 lds
    s_add_u32 m0, m0, 4096
    s_sub_u32 s85, s85, 1
    s_cmp_lg_u32 s85, 0
    buffer_load_dwordx4 v52, s[76:79], s65 offen offset:0 lds
    buffer_load_dwordx4 v53, s[76:79], s65 offen offset:1024 lds
    buffer_load_dwordx4 v54, s[76:79], s65 offen offset:2048 lds
    buffer_load_dwordx4 v55, s[76:79], s65 offen offset:3072 lds
    s_mov_b32 m0, s64
    s_mov_b32 s65, s84
    s_cbranch_scc1 .ll_13
    s_waitcnt vmcnt(63)
    s_barrier
    s_waitcnt vmcnt(48)
    s_barrier
    buffer_load_dwordx4 v40, s[76:79], s65 offen offset:0 lds
    buffer_load_dwordx4 v41, s[76:79], s65 offen offset:1024 lds
    buffer_load_dwordx4 v42, s[76:79], s65 offen offset:2048 lds
    buffer_load_dwordx4 v43, s[76:79], s65 offen offset:3072 lds
    s_add_u32 m0, m0, 4096
    s_add_u32 s64, s64, 16384
    s_cmp_eq_u32 s64, 147456
    s_cselect_b32 s64, 65536, s64
    buffer_load_dwordx4 v44, s[76:79], s65 offen offset:0 lds
    buffer_load_dwordx4 v45, s[76:79], s65 offen offset:1024 lds
    buffer_load_dwordx4 v46, s[76:79], s65 offen offset:2048 lds
    buffer_load_dwordx4 v47, s[76:79], s65 offen offset:3072 lds
    s_add_u32 m0, m0, 4096
    s_nop 0
    s_add_u32 s66, s66, 1
    v_readlane_b32 s84, v74, s66
    buffer_load_dwordx4 v48, s[76:79], s65 offen offset:0 lds
    buffer_load_dwordx4 v49, s[76:79], s65 offen offset:1024 lds
    buffer_load_dwordx4 v50, s[76:79], s65 offen offset:2048 lds
    buffer_load_dwordx4 v51, s[76:79], s65 offen offset:3072 lds
    s_add_u32 m0, m0, 4096
    s_nop 0
    buffer_load_dwordx4 v52, s[76:79], s65 offen offset:0 lds
    buffer_load_dwordx4 v53, s[76:79], s65 offen offset:1024 lds
    s_waitcnt vmcnt(46)
    s_barrier
    buffer_load_dwordx4 v54, s[76:79], s65 offen offset:2048 lds
    buffer_load_dwordx4 v55, s[76:79], s65 offen offset:3072 lds
    s_mov_b32 m0, s64
    s_nop 0
    s_mov_b32 s65, s84
    buffer_load_dwordx4 v40, s[76:79], s65 offen offset:0 lds
    buffer_load_dwordx4 v41, s[76:79], s65 offen offset:1024 lds
    buffer_load_dwordx4 v42, s[76:79], s65 offen offset:2048 lds
    buffer_load_dwordx4 v43, s[76:79], s65 offen offset:3072 lds
    s_add_u32 m0, m0, 4096
    s_add_u32 s64, s64, 16384
    s_cmp_eq_u32 s64, 147456
    s_cselect_b32 s64, 65536, s64
    buffer_load_dwordx4 v44, s[76:79], s65 offen offset:0 lds
    buffer_load_dwordx4 v45, s[76:79], s65 offen offset:1024 lds
    buffer_load_dwordx4 v46, s[76:79], s65 offen offset:2048 lds
    buffer_load_dwordx4 v47, s[76:79], s65 offen offset:3072 lds
    s_add_u32 m0, m0, 4096
    s_nop 0
    s_add_u32 s66, s66, 1
    v_readlane_b32 s84, v74, s66
    buffer_load_dwordx4 v48, s[76:79], s65 offen offset:0 lds
    buffer_load_dwordx4 v49, s[76:79], s65 offen offset:1024 lds
    buffer_load_dwordx4 v50, s[76:79], s65 offen offset:2048 lds
    buffer_load_dwordx4 v51, s[76:79], s65 offen offset:3072 lds
    s_add_u32 m0, m0, 4096
    s_waitcnt vmcnt(44)
    s_barrier
    buffer_load_dwordx4 v52, s[76:79], s65 offen offset:0 lds
    buffer_load_dwordx4 v53, s[76:79], s65 offen offset:1024 lds
    buffer_load_dwordx4 v54, s[76:79], s65 offen offset:2048 lds
    buffer_load_dwordx4 v55, s[76:79], s65 offen offset:3072 lds
    s_mov_b32 m0, s64
    s_mov_b32 s65, s84
    buffer_load_dwordx4 v40, s[76:79], s65 offen offset:0 lds
    buffer_load_dwordx4 v41, s[76:79], s65 offen offset:1024 lds
    buffer_load_dwordx4 v42, s[76:79], s65 offen offset:2048 lds
    buffer_load_dwordx4 v43, s[76:79], s65 offen offset:3072 lds
    s_add_u32 m0, m0, 4096
    s_add_u32 s64, s64, 16384
    s_cmp_eq_u32 s64, 147456
    s_cselect_b32 s64, 65536, s64
    buffer_load_dwordx4 v44, s[76:79], s65 offen offset:0 lds
    buffer_load_dwordx4 v45, s[76:79], s65 offen offset:1024 lds
    buffer_load_dwordx4 v46, s[76:79], s65 offen offset:2048 lds
    buffer_load_dwordx4 v47, s[76:79], s65 offen offset:3072 lds
    s_add_u32 m0, m0, 4096
    s_add_u32 s66, s66, 1
    v_readlane_b32 s84, v74, s66
    buffer_load_dwordx4 v48, s[76:79], s65 offen offset:0 lds
    s_waitcnt vmcnt(41)
    s_barrier
    buffer_load_dwordx4 v49, s[76:79], s65 offen offset:1024 lds
    buffer_load_dwordx4 v50, s[76:79], s65 offen offset:2048 lds
    buffer_load_dwordx4 v51, s[76:79], s65 offen offset:3072 lds
    s_add_u32 m0, m0, 4096
    s_nop 0
    buffer_load_dwordx4 v52, s[76:79], s65 offen offset:0 lds
    buffer_load_dwordx4 v53, s[76:79], s65 offen offset:1024 lds
    buffer_load_dwordx4 v54, s[76:79], s65 offen offset:2048 lds
    buffer_load_dwordx4 v55, s[76:79], s65 offen offset:3072 lds
    s_mov_b32 m0, s64
    s_mov_b32 s65, s84
    buffer_load_dwordx4 v40, s[76:79], s65 offen offset:0 lds
    buffer_load_dwordx4 v41, s[76:79], s65 offen offset:1024 lds
    buffer_load_dwordx4 v42, s[76:79], s65 offen offset:2048 lds
    buffer_load_dwordx4 v43, s[76:79], s65 offen offset:3072 lds
    s_add_u32 m0, m0, 4096
    s_add_u32 s64, s64, 16384
    s_cmp_eq_u32 s64, 147456
    s_cselect_b32 s64, 65536, s64
    buffer_load_dwordx4 v44, s[76:79], s65 offen offset:0 lds
    buffer_load_dwordx4 v45, s[76:79], s65 offen offset:1024 lds
    buffer_load_dwordx4 v46, s[76:79], s65 offen offset:2048 lds
    s_waitcnt vmcnt(39)
    s_barrier
    buffer_load_dwordx4 v47, s[76:79], s65 offen offset:3072 lds
    s_add_u32 m0, m0, 4096
    s_nop 0
    s_add_u32 s66, s66, 1
    v_readlane_b32 s84, v74, s66
    buffer_load_dwordx4 v48, s[76:79], s65 offen offset:0 lds
    buffer_load_dwordx4 v49, s[76:79], s65 offen offset:1024 lds
    buffer_load_dwordx4 v50, s[76:79], s65 offen offset:2048 lds
    buffer_load_dwordx4 v51, s[76:79], s65 offen offset:3072 lds
    s_add_u32 m0, m0, 4096
    s_nop 0
    buffer_load_dwordx4 v52, s[76:79], s65 offen offset:0 lds
    buffer_load_dwordx4 v53, s[76:79], s65 offen offset:1024 lds
    buffer_load_dwordx4 v54, s[76:79], s65 offen offset:2048 lds
    buffer_load_dwordx4 v55, s[76:79], s65 offen offset:3072 lds
    s_mov_b32 m0, s64
    s_nop 0
    s_mov_b32 s65, s84
    buffer_load_dwordx4 v40, s[76:79], s65 offen offset:0 lds
    buffer_load_dwordx4 v41, s[76:79], s65 offen offset:1024 lds
    buffer_load_dwordx4 v42, s[76:79], s65 offen offset:2048 lds
    buffer_load_dwordx4 v43, s[76:79], s65 offen offset:3072 lds
    s_add_u32 m0, m0, 4096
    s_add_u32 s64, s64, 16384
    s_cmp_eq_u32 s64, 147456
    s_cselect_b32 s64, 65536, s64
    s_waitcnt vmcnt(36)
    s_barrier
    buffer_load_dwordx4 v44, s[76:79], s65 offen offset:0 lds
    buffer_load_dwordx4 v45, s[76:79], s65 offen offset:1024 lds
    buffer_load_dwordx4 v46, s[76:79], s65 offen offset:2048 lds
    buffer_load_dwordx4 v47, s[76:79], s65 offen offset:3072 lds
    s_add_u32 m0, m0, 4096
    s_nop 0
    s_add_u32 s66, s66, 1
    v_readlane_b32 s84, v74, s66
    buffer_load_dwordx4 v48, s[76:79], s65 offen offset:0 lds
    buffer_load_dwordx4 v49, s[76:79], s65 offen offset:1024 lds
    buffer_load_dwordx4 v50, s[76:79], s65 offen offset:2048 lds
    buffer_load_dwordx4 v51, s[76:79], s65 offen offset:3072 lds
    s_add_u32 m0, m0, 4096
    s_nop 0
    buffer_load_dwordx4 v52, s[76:79], s65 offen offset:0 lds
    buffer_load_dwordx4 v53, s[76:79], s65 offen offset:1024 lds
    buffer_load_dwordx4 v54, s[76:79], s65 offen offset:2048 lds
    buffer_load_dwordx4 v55, s[76:79], s65 offen offset:3072 lds
    s_mov_b32 m0, s64
    s_mov_b32 s65, s84
    buffer_load_dwordx4 v40, s[76:79], s65 offen offset:0 lds
    buffer_load_dwordx4 v41, s[76:79], s65 offen offset:1024 lds
    s_waitcnt vmcnt(34)
    s_nop 0
    s_barrier
    buffer_load_dwordx4 v42, s[76:79], s65 offen offset:2048 lds
    buffer_load_dwordx4 v43, s[76:79], s65 offen offset:3072 lds
    s_add_u32 m0, m0, 4096
    s_add_u32 s64, s64, 16384
    s_cmp_eq_u32 s64, 147456
    s_cselect_b32 s64, 65536, s64
    buffer_load_dwordx4 v44, s[76:79], s65 offen offset:0 lds
    buffer_load_dwordx4 v45, s[76:79], s65 offen offset:1024 lds
    buffer_load_dwordx4 v46, s[76:79], s65 offen offset:2048 lds
    buffer_load_dwordx4 v47, s[76:79], s65 offen offset:3072 lds
    s_add_u32 m0, m0, 4096
    s_nop 0
    s_add_u32 s66, s66, 1
    v_readlane_b32 s84, v74, s66
    buffer_load_dwordx4 v48, s[76:79], s65 offen offset:0 lds
    buffer_load_dwordx4 v49, s[76:79], s65 offen offset:1024 lds
    buffer_load_dwordx4 v50, s[76:79], s65 offen offset:2048 lds
    buffer_load_dwordx4 v51, s[76:79], s65 offen offset:3072 lds
    s_add_u32 m0, m0, 4096
    s_nop 0
    buffer_load_dwordx4 v52, s[76:79], s65 offen offset:0 lds
    buffer_load_dwordx4 v53, s[76:79], s65 offen offset:1024 lds
    buffer_load_dwordx4 v54, s[76:79], s65 offen offset:2048 lds
    s_waitcnt vmcnt(31)
    s_barrier
    buffer_load_dwordx4 v55, s[76:79], s65 offen offset:3072 lds
    s_mov_b32 m0, s64
    s_nop 0
    s_mov_b32 s65, s84
    buffer_load_dwordx4 v40, s[76:79], s65 offen offset:0 lds
    buffer_load_dwordx4 v41, s[76:79], s65 offen offset:1024 lds
    buffer_load_dwordx4 v42, s[76:79], s65 offen offset:2048 lds
    buffer_load_dwordx4 v43, s[76:79], s65 offen offset:3072 lds
    s_add_u32 m0, m0, 4096
    s_add_u32 s64, s64, 16384
    s_cmp_eq_u32 s64, 147456
    s_cselect_b32 s64, 65536, s64
    buffer_load_dwordx4 v44, s[76:79], s65 offen offset:0 lds
    buffer_load_dwordx4 v45, s[76:79], s65 offen offset:1024 lds
    buffer_load_dwordx4 v46, s[76:79], s65 offen offset:2048 lds
    buffer_load_dwordx4 v47, s[76:79], s65 offen offset:3072 lds
    s_add_u32 m0, m0, 4096
    s_nop 0
    s_add_u32 s66, s66, 1
    v_readlane_b32 s84, v74, s66
    buffer_load_dwordx4 v48, s[76:79], s65 offen offset:0 lds
    buffer_load_dwordx4 v49, s[76:79], s65 offen offset:1024 lds
    buffer_load_dwordx4 v50, s[76:79], s65 offen offset:2048 lds
    buffer_load_dwordx4 v51, s[76:79], s65 offen offset:3072 lds
    s_add_u32 m0, m0, 4096
    s_nop 0
    buffer_load_dwordx4 v52, s[76:79], s65 offen offset:0 lds
    s_waitcnt vmcnt(29)
    s_barrier
    s_branch .pg_11
.p2align 12
.pad_11:
    s_nop 0
    s_setpc_b64 s[44:45]
.pg_11:
    buffer_load_dwordx4 v53, s[76:79], s65 offen offset:1024 lds
    buffer_load_dwordx4 v54, s[76:79], s65 offen offset:2048 lds
    buffer_load_dwordx4 v55, s[76:79], s65 offen offset:3072 lds
    s_mov_b32 m0, s64
    s_mov_b32 s65, s84
    buffer_load_dwordx4 v40, s[76:79], s65 offen offset:0 lds
    buffer_load_dwordx4 v41, s[76:79], s65 offen offset:1024 lds
    buffer_load_dwordx4 v42, s[76:79], s65 offen offset:2048 lds
    buffer_load_dwordx4 v43, s[76:79], s65 offen offset:3072 lds
    s_add_u32 m0, m0, 4096
    s_add_u32 s64, s64, 16384
    s_cmp_eq_u32 s64, 147456
    s_cselect_b32 s64, 65536, s64
    buffer_load_dwordx4 v44, s[76:79], s65 offen offset:0 lds
    buffer_load_dwordx4 v45, s[76:79], s65 offen offset:1024 lds
    buffer_load_dwordx4 v46, s[76:79], s65 offen offset:2048 lds
    buffer_load_dwordx4 v47, s[76:79], s65 offen offset:3072 lds
    s_add_u32 m0, m0, 4096
    s_add_u32 s66, s66, 1
    v_readlane_b32 s84, v74, s66
    buffer_load_dwordx4 v48, s[76:79], s65 offen offset:0 lds
    buffer_load_dwordx4 v49, s[76:79], s65 offen offset:1024 lds
    s_waitcnt vmcnt(26)
    s_barrier
    buffer_load_dwordx4 v50, s[76:79], s65 offen offset:2048 lds
    buffer_load_dwordx4 v51, s[76:79], s65 offen offset:3072 lds
    s_add_u32 m0, m0, 4096
    s_nop 0
    buffer_load_dwordx4 v52, s[76:79], s65 offen offset:0 lds
    buffer_load_dwordx4 v53, s[76:79], s65 offen offset:1024 lds
    buffer_load_dwordx4 v54, s[76:79], s65 offen offset:2048 lds
    buffer_load_dwordx4 v55, s[76:79], s65 offen offset:3072 lds
    s_mov_b32 m0, s64
    s_mov_b32 s65, s84
    buffer_load_dwordx4 v40, s[76:79], s65 offen offset:0 lds
    buffer_load_dwordx4 v41, s[76:79], s65 offen offset:1024 lds
    buffer_load_dwordx4 v42, s[76:79], s65 offen offset:2048 lds
    buffer_load_dwordx4 v43, s[76:79], s65 offen offset:3072 lds
    s_add_u32 m0, m0, 4096
    s_add_u32 s64, s64, 16384
    s_cmp_eq_u32 s64, 147456
    s_cselect_b32 s64, 65536, s64
    buffer_load_dwordx4 v44, s[76:79], s65 offen offset:0 lds
    buffer_load_dwordx4 v45, s[76:79], s65 offen offset:1024 lds
    buffer_load_dwordx4 v46, s[76:79], s65 offen offset:2048 lds
    buffer_load_dwordx4 v47, s[76:79], s65 offen offset:3072 lds
    s_add_u32 m0, m0, 4096
    s_add_u32 s66, s66, 1
    v_readlane_b32 s84, v74, s66
    s_waitcnt vmcnt(24)
    s_nop 0
    s_barrier
    buffer_load_dwordx4 v48, s[76:79], s65 offen offset:0 lds
    buffer_load_dwordx4 v49, s[76:79], s65 offen offset:1024 lds
    buffer_load_dwordx4 v50, s[76:79], s65 offen offset:2048 lds
    buffer_load_dwordx4 v51, s[76:79], s65 offen offset:3072 lds
    s_add_u32 m0, m0, 4096
    s_nop 0
    buffer_load_dwordx4 v52, s[76:79], s65 offen offset:0 lds
    buffer_load_dwordx4 v53, s[76:79], s65 offen offset:1024 lds
    buffer_load_dwordx4 v54, s[76:79], s65 offen offset:2048 lds
    buffer_load_dwordx4 v55, s[76:79], s65 offen offset:3072 lds
    s_mov_b32 m0, s64
    s_nop 0
    s_mov_b32 s65, s84
    buffer_load_dwordx4 v40, s[76:79], s65 offen offset:0 lds
    buffer_load_dwordx4 v41, s[76:79], s65 offen offset:1024 lds
    buffer_load_dwordx4 v42, s[76:79], s65 offen offset:2048 lds
    buffer_load_dwordx4 v43, s[76:79], s65 offen offset:3072 lds
    s_add_u32 m0, m0, 4096
    s_add_u32 s64, s64, 16384
    s_cmp_eq_u32 s64, 147456
    s_cselect_b32 s64, 65536, s64
    buffer_load_dwordx4 v44, s[76:79], s65 offen offset:0 lds
    s_waitcnt vmcnt(21)
    s_barrier
    buffer_load_dwordx4 v45, s[76:79], s65 offen offset:1024 lds
    buffer_load_dwordx4 v46, s[76:79], s65 offen offset:2048 lds
    buffer_load_dwordx4 v47, s[76:79], s65 offen offset:3072 lds
    s_add_u32 m0, m0, 4096
    s_nop 0
    s_add_u32 s66, s66, 1
    v_readlane_b32 s84, v74, s66
    buffer_load_dwordx4 v48, s[76:79], s65 offen offset:0 lds
    buffer_load_dwordx4 v49, s[76:79], s65 offen offset:1024 lds
    buffer_load_dwordx4 v50, s[76:79], s65 offen offset:2048 lds
    buffer_load_dwordx4 v51, s[76:79], s65 offen offset:3072 lds
    s_add_u32 m0, m0, 4096
    s_nop 0
    buffer_load_dwordx4 v52, s[76:79], s65 offen offset:0 lds
    buffer_load_dwordx4 v53, s[76:79], s65 offen offset:1024 lds
    buffer_load_dwordx4 v54, s[76:79], s65 offen offset:2048 lds
    buffer_load_dwordx4 v55, s[76:79], s65 offen offset:3072 lds
    s_mov_b32 m0, s64
    s_mov_b32 s65, s84
    buffer_load_dwordx4 v40, s[76:79], s65 offen offset:0 lds
    buffer_load_dwordx4 v41, s[76:79], s65 offen offset:1024 lds
    buffer_load_dwordx4 v42, s[76:79], s65 offen offset:2048 lds
    s_waitcnt vmcnt(19)
    s_nop 0
    s_barrier
    buffer_load_dwordx4 v43, s[76:79], s65 offen offset:3072 lds
    s_add_u32 m0, m0, 4096
    s_add_u32 s64, s64, 16384
    s_cmp_eq_u32 s64, 147456
    s_cselect_b32 s64, 65536, s64
    buffer_load_dwordx4 v44, s[76:79], s65 offen offset:0 lds
    buffer_load_dwordx4 v45, s[76:79], s65 offen offset:1024 lds
    buffer_load_dwordx4 v46, s[76:79], s65 offen offset:2048 lds
    buffer_load_dwordx4 v47, s[76:79], s65 offen offset:3072 lds
    s_add_u32 m0, m0, 4096
    s_nop 0
    s_add_u32 s66, s66, 1
    v_readlane_b32 s84, v74, s66
    buffer_load_dwordx4 v48, s[76:79], s65 offen offset:0 lds
    buffer_load_dwordx4 v49, s[76:79], s65 offen offset:1024 lds
    buffer_load_dwordx4 v50, s[76:79], s65 offen offset:2048 lds
    buffer_load_dwordx4 v51, s[76:79], s65 offen offset:3072 lds
    s_add_u32 m0, m0, 4096
    s_nop 0
    buffer_load_dwordx4 v52, s[76:79], s65 offen offset:0 lds
    buffer_load_dwordx4 v53, s[76:79], s65 offen offset:1024 lds
    buffer_load_dwordx4 v54, s[76:79], s65 offen offset:2048 lds
    buffer_load_dwordx4 v55, s[76:79], s65 offen offset:3072 lds
    s_mov_b32 m0, s64
    s_mov_b32 s65, s84
    s_waitcnt vmcnt(16)
    s_barrier
    s_waitcnt vmcnt(0)
    s_barrier
    s_mov_b32 s64, 65536
    s_mov_b32 s66, 0
    s_mov_b32 m0, s64
    s_waitcnt lgkmcnt(0)
    v_readlane_b32 s65, v75, 0
    s_nop 4
    s_and_b32 s28, s33, 3
    s_lshl4_add_u32 s28, s35, s28
    s_lshl_b32 s28, s28, 7
    s_load_dword s42, s[52:53], s28 offset:327680 glc
    s_barrier
    s_waitcnt lgkmcnt(0)
    s_cmp_ge_u32 s42, 16
    s_cbranch_scc1 .b5_14
    s_and_b32 s28, s33, 3
    s_lshl4_add_u32 s28, s35, s28
    s_lshl_b32 s28, s28, 7
.poll_15:
    s_load_dword s42, s[52:53], s28 offset:327680 glc
    s_sub_u32 s38, s38, 1
    s_waitcnt lgkmcnt(0)
    s_cbranch_scc1 .pdone_16
    s_cmp_lt_u32 s42, 16
    s_cbranch_scc1 .poll_15
.pdone_16:
    s_max_i32 s38, s38, 0
.b5_14:
    s_mov_b32 s85, 4
.ll_17:
    buffer_load_dwordx4 v56, s[80:83], s65 offen offset:0 sc1 lds
    buffer_load_dwordx4 v56, s[80:83], s65 offen offset:1024 sc1 lds
    buffer_load_dwordx4 v56, s[80:83], s65 offen offset:2048 sc1 lds
    buffer_load_dwordx4 v56, s[80:83], s65 offen offset:3072 sc1 lds
    s_add_u32 m0, m0, 4096
    s_add_u32 s64, s64, 16384
    s_cmp_eq_u32 s64, 147456
    s_cselect_b32 s64, 65536, s64
    buffer_load_dwordx4 v57, s[80:83], s65 offen offset:0 sc1 lds
    buffer_load_dwordx4 v57, s[80:83], s65 offen offset:1024 sc1 lds
    buffer_load_dwordx4 v57, s[80:83], s65 offen offset:2048 sc1 lds
    buffer_load_dwordx4 v57, s[80:83], s65 offen offset:3072 sc1 lds
    s_add_u32 m0, m0, 4096
    s_add_u32 s66, s66, 1
    v_readlane_b32 s84, v75, s66
    buffer_load_dwordx4 v58, s[80:83], s65 offen offset:0 sc1 lds
    buffer_load_dwordx4 v58, s[80:83], s65 offen offset:1024 sc1 lds
    buffer_load_dwordx4 v58, s[80:83], s65 offen offset:2048 sc1 lds
    buffer_load_dwordx4 v58, s[80:83], s65 offen offset:3072 sc1 lds
    s_add_u32 m0, m0, 4096
    s_sub_u32 s85, s85, 1
    s_cmp_lg_u32 s85, 0
    buffer_load_dwordx4 v59, s[80:83], s65 offen offset:0 sc1 lds
    buffer_load_dwordx4 v59, s[80:83], s65 offen offset:1024 sc1 lds
    buffer_load_dwordx4 v59, s[80:83], s65 offen offset:2048 sc1 lds
    buffer_load_dwordx4 v59, s[80:83], s65 offen offset:3072 sc1 lds
    s_mov_b32 m0, s64
    s_mov_b32 s65, s84
    s_cbranch_scc1 .ll_17
    s_waitcnt vmcnt(48)
    s_barrier
    s_waitcnt vmcnt(32)
    s_barrier
    s_mov_b32 s85, 28
.ll_18:
    s_waitcnt vmcnt(16)
    buffer_load_dwordx4 v56, s[80:83], s65 offen offset:0 sc1 lds
    buffer_load_dwordx4 v56, s[80:83], s65 offen offset:1024 sc1 lds
    buffer_load_dwordx4 v56, s[80:83], s65 offen offset:2048 sc1 lds
    s_barrier
    buffer_load_dwordx4 v56, s[80:83], s65 offen offset:3072 sc1 lds
    s_add_u32 m0, m0, 4096
    s_add_u32 s64, s64, 16384
    s_cmp_eq_u32 s64, 147456
    s_cselect_b32 s64, 65536, s64
    buffer_load_dwordx4 v57, s[80:83], s65 offen offset:0 sc1 lds
    buffer_load_dwordx4 v57, s[80:83], s65 offen offset:1024 sc1 lds
    buffer_load_dwordx4 v57, s[80:83], s65 offen offset:2048 sc1 lds
    buffer_load_dwordx4 v57, s[80:83], s65 offen offset:3072 sc1 lds
    s_add_u32 m0, m0, 4096
    s_add_u32 s66, s66, 1
    v_readlane_b32 s84, v75, s66
    buffer_load_dwordx4 v58, s[80:83], s65 offen offset:0 sc1 lds
    buffer_load_dwordx4 v58, s[80:83], s65 offen offset:1024 sc1 lds
    buffer_load_dwordx4 v58, s[80:83], s65 offen offset:2048 sc1 lds
    buffer_load_dwordx4 v58, s[80:83], s65 offen offset:3072 sc1 lds
    s_add_u32 m0, m0, 4096
    s_sub_u32 s85, s85, 1
    s_cmp_lg_u32 s85, 0
    buffer_load_dwordx4 v59, s[80:83], s65 offen offset:0 sc1 lds
    buffer_load_dwordx4 v59, s[80:83], s65 offen offset:1024 sc1 lds
    buffer_load_dwordx4 v59, s[80:83], s65 offen offset:2048 sc1 lds
    buffer_load_dwordx4 v59, s[80:83], s65 offen offset:3072 sc1 lds
    s_mov_b32 m0, s64
    s_mov_b32 s65, s84
    s_cbranch_scc1 .ll_18
    s_waitcnt vmcnt(16)
    s_barrier
    s_waitcnt vmcnt(0)
    s_barrier
    s_barrier
    s_sub_u32 s29, s33, s36
    s_and_b32 s29, s29, 3
    s_and_b32 s30, s33, 0
    s_sub_u32 s29, 4, s29
    v_lshrrev_b32_e64 v72, 1, v1
    v_add3_u32 v2, v72, s29, -1
    v_lshrrev_b32 v2, 2, v2
    v_add_u32 v3, s29, v72
    v_lshrrev_b32 v3, 2, v3
    v_add_u32 v4, 1, v72
    v_min_u32 v4, 13, v4
    v_add_u32 v4, s29, v4
    v_lshrrev_b32 v4, 2, v4
    v_sub_u32 v4, v4, v2
    v_add_u32 v4, v4, v72
    v_subrev_u32 v5, 1, v72
    v_max_i32_e64 v5, 0, v5
    v_add3_u32 v6, v5, s29, -1
    v_lshrrev_b32 v6, 2, v6
    v_sub_u32 v5, v5, v6
    v_add_u32 v5, v5, v2
    v_cmp_ne_u32 vcc, v3, v2
    s_nop 1
    v_cndmask_b32 v5, v4, v5, vcc
    v_and_b32_e64 v3, 1, v1
    v_lshl_add_u32 v5, v5, 1, v3
    v_cmp_gt_u32 vcc, 28, v1
    s_nop 1
    v_cndmask_b32_e64 v5, v1, v5, vcc
    v_add_lshl_u32 v5, v5, 0, 2
    v_add_u32 v6, s30, v1
    v_subrev_u32 v3, 28, v6
    v_min_u32_e64 v6, v6, v3
    v_mul_u32_u24 v6, 131072, v6
    ds_permute_b32 v72, v5, v6
    v_lshrrev_b32 v2, 3, v1
    v_and_b32 v4, 6, v2
    v_mul_u32_u24 v2, 2048, v2
    v_and_b32 v3, 7, v1
    v_xor_b32 v3, v3, v4
    v_lshl_add_u32 v8, v3, 4, v2
    v_add_u32 v9, 15360, v8
    v_add_u32 v10, 30720, v8
    v_add_u32 v11, 30720, v9
    v_add_u32 v12, 65536, v8
    v_add_u32 v13, 65536, v9
    v_add_u32 v14, 65536, v10
    v_add_u32 v15, 65536, v11
    s_waitcnt lgkmcnt(0)
    s_lshl_b32 s28, s34, 7
    s_add_u32 s68, s20, s28
    s_addc_u32 s69, s21, 0
    s_mov_b32 s70, 0
    s_mov_b32 s71, 0x20000
    s_sub_u32 s70, 3670016, s28
    s_mov_b32 s64, 65536
    s_mov_b32 s66, 0
    s_mov_b32 m0, s64
    s_waitcnt lgkmcnt(0)
    v_readlane_b32 s65, v72, 0
    s_nop 4
    s_barrier
    s_branch .hj_21
.hret_20:
    s_sub_u32 s29, s33, s36
    s_and_b32 s29, s29, 3
    s_and_b32 s30, s33, 0
    s_sub_u32 s29, 4, s29
    v_lshrrev_b32 v72, 1, v1
    v_add3_u32 v2, v72, s29, -1
    v_lshrrev_b32 v2, 2, v2
    v_add_u32 v3, s29, v72
    v_lshrrev_b32 v3, 2, v3
    v_add_u32 v4, 1, v72
    v_min_u32 v4, 13, v4
    v_add_u32 v4, s29, v4
    v_lshrrev_b32 v4, 2, v4
    v_sub_u32 v4, v4, v2
    v_add_u32 v4, v4, v72
    v_subrev_u32 v5, 1, v72
    v_max_i32_e64 v5, 0, v5
    v_add3_u32 v6, v5, s29, -1
    v_lshrrev_b32 v6, 2, v6
    v_sub_u32 v5, v5, v6
    v_add_u32 v5, v5, v2
    v_cmp_ne_u32 vcc, v3, v2
    s_nop 1
    v_cndmask_b32 v5, v4, v5, vcc
    v_and_b32_e64 v3, 1, v1
    v_lshl_add_u32 v5, v5, 1, v3
    v_cmp_gt_u32 vcc, 28, v1
    s_nop 1
    v_cndmask_b32_e64 v5, v1, v5, vcc
    v_add_lshl_u32 v5, v5, 0, 2
    v_add_u32 v6, s30, v1
    v_subrev_u32 v3, 28, v6
    v_min_u32_e64 v6, v6, v3
    v_mul_u32_u24 v6, 131072, v6
    ds_permute_b32 v72, v5, v6
    v_lshrrev_b32 v2, 3, v1
    v_and_b32 v4, 6, v2
    v_mul_u32_u24 v2, 2048, v2
    v_and_b32 v3, 7, v1
    v_xor_b32 v3, v3, v4
    v_lshl_add_u32 v8, v3, 4, v2
    v_add_u32 v9, 15360, v8
    v_add_u32 v10, 30720, v8
    v_add_u32 v11, 30720, v9
    v_add_u32 v12, 65536, v8
    v_add_u32 v13, 65536, v9
    v_add_u32 v14, 65536, v10
    v_add_u32 v15, 65536, v11
    s_waitcnt lgkmcnt(0)
    s_lshl_b32 s28, s34, 7
    s_add_u32 s68, s20, s28
    s_addc_u32 s69, s21, 0
    s_mov_b32 s70, 0
    s_mov_b32 s71, 0x20000
    s_sub_u32 s70, 3670016, s28
    s_mov_b32 s64, 65536
    s_mov_b32 s66, 0
    s_mov_b32 m0, s64
    s_waitcnt lgkmcnt(0)
    v_readlane_b32 s65, v72, 0
    s_nop 4
.hj_21:
    s_mov_b32 s85, 10
.ll_22:
    buffer_load_dwordx4 v8, s[68:71], s65 offen offset:0 lds
    buffer_load_dwordx4 v9, s[68:71], s65 offen offset:1024 lds
    buffer_load_dwordx4 v10, s[68:71], s65 offen offset:2048 lds
    buffer_load_dwordx4 v11, s[68:71], s65 offen offset:3072 lds
    s_add_u32 m0, m0, 4096
    s_add_u32 s66, s66, 1
    v_readlane_b32 s84, v72, s66
    s_add_u32 s64, s64, 8192
    s_cmp_eq_u32 s64, 147456
    s_cselect_b32 s64, 65536, s64
    s_sub_u32 s85, s85, 1
    s_cmp_lg_u32 s85, 0
    buffer_load_dwordx4 v12, s[68:71], s65 offen offset:0 lds
    buffer_load_dwordx4 v13, s[68:71], s65 offen offset:1024 lds
    buffer_load_dwordx4 v14, s[68:71], s65 offen offset:2048 lds
    buffer_load_dwordx4 v15, s[68:71], s65 offen offset:3072 lds
    s_mov_b32 m0, s64
    s_mov_b32 s65, s84
    s_cbranch_scc1 .ll_22
    s_waitcnt vmcnt(63)
    s_barrier
    s_waitcnt vmcnt(63)
    s_barrier
    s_mov_b32 s85, 18
.ll_23:
    s_waitcnt vmcnt(56)
    buffer_load_dwordx4 v8, s[68:71], s65 offen offset:0 lds
    buffer_load_dwordx4 v9, s[68:71], s65 offen offset:1024 lds
    buffer_load_dwordx4 v10, s[68:71], s65 offen offset:2048 lds
    s_barrier
    buffer_load_dwordx4 v11, s[68:71], s65 offen offset:3072 lds
    s_add_u32 m0, m0, 4096
    s_add_u32 s66, s66, 1
    v_readlane_b32 s84, v72, s66
    s_add_u32 s64, s64, 8192
    s_cmp_eq_u32 s64, 147456
    s_cselect_b32 s64, 65536, s64
    s_sub_u32 s85, s85, 1
    s_cmp_lg_u32 s85, 0
    buffer_load_dwordx4 v12, s[68:71], s65 offen offset:0 lds
    buffer_load_dwordx4 v13, s[68:71], s65 offen offset:1024 lds
    buffer_load_dwordx4 v14, s[68:71], s65 offen offset:2048 lds
    buffer_load_dwordx4 v15, s[68:71], s65 offen offset:3072 lds
    s_mov_b32 m0, s64
    s_mov_b32 s65, s84
    s_cbranch_scc1 .ll_23
    s_waitcnt vmcnt(56)
    s_barrier
    s_waitcnt vmcnt(48)
    s_barrier
    s_waitcnt vmcnt(40)
    s_barrier
    s_waitcnt vmcnt(32)
    s_barrier
    s_waitcnt vmcnt(24)
    s_barrier
    s_waitcnt vmcnt(16)
    s_barrier
    s_waitcnt vmcnt(8)
    s_barrier
    s_waitcnt vmcnt(0)
    s_barrier
    s_barrier
    s_endpgm
    s_nop 0
.pad_12:
    s_nop 0
    s_setpc_b64 s[44:45]
.cont_26:
    s_lshl_b32 s64, s37, 13
    s_mov_b32 s66, 0
    s_mov_b32 m0, s64
    s_waitcnt lgkmcnt(0)
    v_readlane_b32 s65, v72, 0
    s_nop 4
    s_barrier
    s_add_u32 s52, s26, 35651584
    s_addc_u32 s53, s27, 0
    s_mov_b32 s54, 360448
    s_mov_b32 s55, 0x20000
    s_add_u32 s60, s26, 34603008
    s_addc_u32 s61, s27, 0
    s_mov_b32 s62, 86016
    s_mov_b32 s63, 0x20000
    s_mov_b32 s29, s36
    s_and_b32 s30, s33, 15
    s_sub_u32 s29, 8, s29
    v_lshrrev_b32 v73, 1, v1
    v_add3_u32 v2, v73, s29, -1
    v_lshrrev_b32 v2, 3, v2
    v_add_u32 v3, s29, v73
    v_lshrrev_b32 v3, 3, v3
    v_add_u32 v4, 1, v73
    v_min_u32 v4, 7, v4
    v_add_u32 v4, s29, v4
    v_lshrrev_b32 v4, 3, v4
    v_sub_u32 v4, v4, v2
    v_add_u32 v4, v4, v73
    v_subrev_u32 v5, 1, v73
    v_max_i32_e64 v5, 0, v5
    v_add3_u32 v6, v5, s29, -1
    v_lshrrev_b32 v6, 3, v6
    v_sub_u32 v5, v5, v6
    v_add_u32 v5, v5, v2
    v_cmp_ne_u32 vcc, v3, v2
    s_nop 1
    v_cndmask_b32 v5, v4, v5, vcc
    v_and_b32_e64 v3, 1, v1
    v_lshl_add_u32 v5, v5, 1, v3
    v_cmp_gt_u32 vcc, 16, v1
    s_nop 1
    v_cndmask_b32_e64 v5, v1, v5, vcc
    v_add_lshl_u32 v5, v5, 0, 2
    v_add_u32 v6, s30, v1
    v_and_b32 v6, 15, v6
    v_mul_u32_u24 v6, 16384, v6
    ds_permute_b32 v73, v5, v6
    s_lshl_b32 s28, s37, 13
    v_lshl_add_u32 v24, v1, 4, s28
    v_add_u32 v25, 4096, v24
    s_waitcnt lgkmcnt(0)
    s_mul_i32 s28, s33, 262144
    s_add_u32 s72, s26, s28
    s_addc_u32 s73, s27, 0
    s_mov_b32 s74, 262144
    s_mov_b32 s75, 0x20000
    s_waitcnt vmcnt(24)
    s_barrier
    s_mov_b32 s85, 12
.ll_27:
    s_waitcnt vmcnt(16)
    s_barrier
    buffer_load_dwordx4 v8, s[68:71], s65 offen offset:0 lds
    buffer_load_dwordx4 v9, s[68:71], s65 offen offset:1024 lds
    buffer_load_dwordx4 v10, s[68:71], s65 offen offset:2048 lds
    buffer_load_dwordx4 v11, s[68:71], s65 offen offset:3072 lds
    s_add_u32 m0, m0, 4096
    s_add_u32 s66, s66, 1
    v_readlane_b32 s84, v72, s66
    s_add_u32 s64, s64, 16384
    s_and_b32 s64, s64, 0xffff
    s_sub_u32 s85, s85, 1
    s_cmp_lg_u32 s85, 0
    buffer_load_dwordx4 v12, s[68:71], s65 offen offset:0 lds
    buffer_load_dwordx4 v13, s[68:71], s65 offen offset:1024 lds
    buffer_load_dwordx4 v14, s[68:71], s65 offen offset:2048 lds
    buffer_load_dwordx4 v15, s[68:71], s65 offen offset:3072 lds
    s_mov_b32 m0, s64
    s_mov_b32 s65, s84
    s_cbranch_scc1 .ll_27
    s_waitcnt vmcnt(16)
    s_barrier
    s_waitcnt vmcnt(8)
    s_barrier
    s_waitcnt vmcnt(0)
    s_barrier
    s_lshl_b32 s64, s37, 13
    s_mov_b32 s66, 0
    s_mov_b32 m0, s64
    s_waitcnt lgkmcnt(0)
    v_readlane_b32 s65, v73, 0
    s_nop 4
    s_barrier
    s_barrier
    s_barrier
    s_sub_u32 s29, s33, s36
    s_and_b32 s29, s29, 3
    s_and_b32 s30, s33, 8
    s_sub_u32 s29, 4, s29
    v_add3_u32 v2, v1, s29, -1
    v_lshrrev_b32 v2, 2, v2
    v_add_u32 v3, s29, v1
    v_lshrrev_b32 v3, 2, v3
    v_add_u32 v4, 2, v1
    v_min_u32 v4, 15, v4
    v_add_u32 v4, s29, v4
    v_lshrrev_b32 v4, 2, v4
    v_sub_u32 v4, v4, v2
    v_add_u32 v4, v4, v1
    v_subrev_u32 v5, 2, v1
    v_max_i32 v5, 0, v5
    v_add3_u32 v6, v5, s29, -1
    v_lshrrev_b32 v6, 2, v6
    v_sub_u32 v5, v5, v6
    v_add_u32 v5, v5, v2
    v_cmp_ne_u32 vcc, v3, v2
    s_nop 1
    v_cndmask_b32 v5, v4, v5, vcc
    v_cmp_gt_u32 vcc, 16, v1
    s_nop 1
    v_cndmask_b32_e64 v5, v1, v5, vcc
    v_add_lshl_u32 v5, v5, 0, 2
    v_add_u32 v6, s30, v1
    v_and_b32 v6, 15, v6
    v_mul_u32_u24 v6, 16384, v6
    ds_permute_b32 v74, v5, v6
    s_lshl_b32 s28, s37, 13
    v_lshl_add_u32 v40, v1, 4, s28
    v_add_u32 v41, 4096, v40
    s_waitcnt lgkmcnt(0)
    s_mul_i32 s28, s33, 262144
    s_add_u32 s78, s28, 4194304
    s_add_u32 s76, s26, s78
    s_addc_u32 s77, s27, 0
    s_mov_b32 s78, 262144
    s_mov_b32 s79, 0x20000
    s_sub_u32 s29, s33, s36
    s_and_b32 s29, s29, 3
    s_and_b32 s30, s33, 12
    s_lshl_b32 s30, s30, 1
    s_sub_u32 s29, 4, s29
    v_lshrrev_b32 v75, 1, v1
    v_add3_u32 v2, v75, s29, -1
    v_lshrrev_b32 v2, 2, v2
    v_add_u32 v3, s29, v75
    v_lshrrev_b32 v3, 2, v3
    v_add_u32 v4, 1, v75
    v_min_u32 v4, 15, v4
    v_add_u32 v4, s29, v4
    v_lshrrev_b32 v4, 2, v4
    v_sub_u32 v4, v4, v2
    v_add_u32 v4, v4, v75
    v_subrev_u32 v5, 1, v75
    v_max_i32_e64 v5, 0, v5
    v_add3_u32 v6, v5, s29, -1
    v_lshrrev_b32 v6, 2, v6
    v_sub_u32 v5, v5, v6
    v_add_u32 v5, v5, v2
    v_cmp_ne_u32 vcc, v3, v2
    s_nop 1
    v_cndmask_b32 v5, v4, v5, vcc
    v_and_b32_e64 v3, 1, v1
    v_lshl_add_u32 v5, v5, 1, v3
    v_cmp_gt_u32 vcc, 32, v1
    s_nop 1
    v_cndmask_b32_e64 v5, v1, v5, vcc
    v_add_lshl_u32 v5, v5, 0, 2
    v_add_u32 v6, s30, v1
    v_and_b32 v6, 31, v6
    v_mul_u32_u24 v6, 128, v6
    ds_permute_b32 v75, v5, v6
    v_lshrrev_b32_e64 v2, 3, v1
    v_lshl_add_u32 v2, s37, 6, v2
    v_mul_u32_u24 v2, 4096, v2
    v_lshrrev_b32 v4, 4, v1
    v_and_b32 v3, 7, v1
    v_xor_b32_e64 v3, v3, v4
    v_lshl_add_u32 v56, v3, 4, v2
    v_xor_b32_e64 v57, 64, v56
    v_add_u32 v57, 31744, v57
    v_add_u32 v58, 63488, v56
    v_add_u32 v59, 63488, v57
    v_add_u32 v60, 131072, v56
    v_add_u32 v61, 131072, v57
    v_add_u32 v62, 131072, v58
    v_add_u32 v63, 131072, v59
    s_waitcnt lgkmcnt(0)
    s_mul_i32 s28, s33, 524288
    s_add_u32 s80, s16, s28
    s_addc_u32 s81, s17, 0
    s_mov_b32 s82, 524288
    s_mov_b32 s83, 0x20000
    s_and_b32 s28, s34, 3
    s_lshl4_add_u32 s28, s33, s28
    s_lshl_b32 s28, s28, 7
.poll_28:
    s_load_dword s42, s[52:53], s28 offset:32768 glc
    s_sub_u32 s38, s38, 1
    s_waitcnt lgkmcnt(0)
    s_cbranch_scc1 .pdone_29
    s_cmp_lt_u32 s42, 16
    s_cbranch_scc1 .poll_28
.pdone_29:
    s_max_i32 s38, s38, 0
    s_nop 0
    s_mov_b32 s85, 2
.ll_30:
    buffer_load_dwordx4 v24, s[72:75], s65 offen offset:0 sc1 lds
    buffer_load_dwordx4 v24, s[72:75], s65 offen offset:1024 sc1 lds
    buffer_load_dwordx4 v24, s[72:75], s65 offen offset:2048 sc1 lds
    buffer_load_dwordx4 v24, s[72:75], s65 offen offset:3072 sc1 lds
    s_add_u32 m0, m0, 4096
    s_add_u32 s66, s66, 1
    v_readlane_b32 s84, v73, s66
    s_add_u32 s64, s64, 16384
    s_and_b32 s64, s64, 0xffff
    s_sub_u32 s85, s85, 1
    s_cmp_lg_u32 s85, 0
    buffer_load_dwordx4 v25, s[72:75], s65 offen offset:0 sc1 lds
    buffer_load_dwordx4 v25, s[72:75], s65 offen offset:1024 sc1 lds
    buffer_load_dwordx4 v25, s[72:75], s65 offen offset:2048 sc1 lds
    buffer_load_dwordx4 v25, s[72:75], s65 offen offset:3072 sc1 lds
    s_mov_b32 m0, s64
    s_mov_b32 s65, s84
    s_cbranch_scc1 .ll_30
    s_waitcnt vmcnt(8)
    s_barrier
    buffer_load_dwordx4 v24, s[72:75], s65 offen offset:0 sc1 lds
    buffer_load_dwordx4 v24, s[72:75], s65 offen offset:1024 sc1 lds
    buffer_load_dwordx4 v24, s[72:75], s65 offen offset:2048 sc1 lds
    buffer_load_dwordx4 v24, s[72:75], s65 offen offset:3072 sc1 lds
    s_add_u32 m0, m0, 4096
    s_nop 0
    s_add_u32 s66, s66, 1
    v_readlane_b32 s84, v73, s66
    s_add_u32 s64, s64, 16384
    s_and_b32 s64, s64, 0xffff
    buffer_load_dwordx4 v25, s[72:75], s65 offen offset:0 sc1 lds
    buffer_load_dwordx4 v25, s[72:75], s65 offen offset:1024 sc1 lds
    buffer_load_dwordx4 v25, s[72:75], s65 offen offset:2048 sc1 lds
    buffer_load_dwordx4 v25, s[72:75], s65 offen offset:3072 sc1 lds
    s_mov_b32 m0, s64
    s_mov_b32 s65, s84
    buffer_load_dwordx4 v24, s[72:75], s65 offen offset:0 sc1 lds
    buffer_load_dwordx4 v24, s[72:75], s65 offen offset:1024 sc1 lds
    buffer_load_dwordx4 v24, s[72:75], s65 offen offset:2048 sc1 lds
    buffer_load_dwordx4 v24, s[72:75], s65 offen offset:3072 sc1 lds
    s_add_u32 m0, m0, 4096
    s_nop 0
    s_add_u32 s66, s66, 1
    v_readlane_b32 s84, v73, s66
    s_add_u32 s64, s64, 16384
    s_and_b32 s64, s64, 0xffff
    buffer_load_dwordx4 v25, s[72:75], s65 offen offset:0 sc1 lds
    buffer_load_dwordx4 v25, s[72:75], s65 offen offset:1024 sc1 lds
    buffer_load_dwordx4 v25, s[72:75], s65 offen offset:2048 sc1 lds
    buffer_load_dwordx4 v25, s[72:75], s65 offen offset:3072 sc1 lds
    s_mov_b32 m0, s64
    s_mov_b32 s65, s84
    s_mov_b32 s85, 12
    s_branch .pg_13
.p2align 12
.pad_13:
    s_nop 0
    s_setpc_b64 s[44:45]
.pg_13:
.ll_31:
    s_waitcnt vmcnt(16)
    s_barrier
    buffer_load_dwordx4 v24, s[72:75], s65 offen offset:0 sc1 lds
    buffer_load_dwordx4 v24, s[72:75], s65 offen offset:1024 sc1 lds
    buffer_load_dwordx4 v24, s[72:75], s65 offen offset:2048 sc1 lds
    buffer_load_dwordx4 v24, s[72:75], s65 offen offset:3072 sc1 lds
    s_add_u32 m0, m0, 4096
    s_add_u32 s66, s66, 1
    v_readlane_b32 s84, v73, s66
    s_add_u32 s64, s64, 16384
    s_and_b32 s64, s64, 0xffff
    s_sub_u32 s85, s85, 1
    s_cmp_lg_u32 s85, 0
    buffer_load_dwordx4 v25, s[72:75], s65 offen offset:0 sc1 lds
    buffer_load_dwordx4 v25, s[72:75], s65 offen offset:1024 sc1 lds
    buffer_load_dwordx4 v25, s[72:75], s65 offen offset:2048 sc1 lds
    buffer_load_dwordx4 v25, s[72:75], s65 offen offset:3072 sc1 lds
    s_mov_b32 m0, s64
    s_mov_b32 s65, s84
    s_cbranch_scc1 .ll_31
    s_waitcnt vmcnt(16)
    s_barrier
    s_waitcnt vmcnt(8)
    s_barrier
    s_waitcnt vmcnt(0)
    s_barrier
    s_lshl_b32 s64, s37, 13
    s_mov_b32 s66, 0
    s_mov_b32 m0, s64
    s_waitcnt lgkmcnt(0)
    v_readlane_b32 s65, v74, 0
    s_nop 4
    s_barrier
    s_barrier
    s_cmp_ge_u32 s35, 14
    s_cbranch_scc1 .helper_job
    s_sub_u32 s29, s33, s36
    s_and_b32 s29, s29, 3
    s_and_b32 s30, s33, 0
    s_sub_u32 s29, 4, s29
    v_lshrrev_b32 v72, 1, v1
    v_add3_u32 v2, v72, s29, -1
    v_lshrrev_b32 v2, 2, v2
    v_add_u32 v3, s29, v72
    v_lshrrev_b32 v3, 2, v3
    v_add_u32 v4, 1, v72
    v_min_u32 v4, 13, v4
    v_add_u32 v4, s29, v4
    v_lshrrev_b32 v4, 2, v4
    v_sub_u32 v4, v4, v2
    v_add_u32 v4, v4, v72
    v_subrev_u32 v5, 1, v72
    v_max_i32_e64 v5, 0, v5
    v_add3_u32 v6, v5, s29, -1
    v_lshrrev_b32 v6, 2, v6
    v_sub_u32 v5, v5, v6
    v_add_u32 v5, v5, v2
    v_cmp_ne_u32 vcc, v3, v2
    s_nop 1
    v_cndmask_b32 v5, v4, v5, vcc
    v_and_b32_e64 v3, 1, v1
    v_lshl_add_u32 v5, v5, 1, v3
    v_cmp_gt_u32 vcc, 28, v1
    s_nop 1
    v_cndmask_b32_e64 v5, v1, v5, vcc
    v_add_lshl_u32 v5, v5, 0, 2
    v_add_u32 v6, s30, v1
    v_subrev_u32 v3, 28, v6
    v_min_u32_e64 v6, v6, v3
    v_mul_u32_u24 v6, 16384, v6
    ds_permute_b32 v72, v5, v6
    s_lshl_b32 s28, s37, 13
    v_lshl_add_u32 v8, v1, 4, s28
    v_add_u32 v9, 4096, v8
    s_waitcnt lgkmcnt(0)
    s_mul_i32 s28, s33, 458752
    s_add_u32 s70, s28, 16777216
    s_add_u32 s68, s26, s70
    s_addc_u32 s69, s27, 0
    s_mov_b32 s70, 458752
    s_mov_b32 s71, 0x20000
    s_and_b32 s28, s34, 3
    s_lshl4_add_u32 s28, s33, s28
    s_lshl_b32 s28, s28, 7
.poll_32:
    s_load_dword s42, s[52:53], s28 offset:65536 glc
    s_sub_u32 s38, s38, 1
    s_waitcnt lgkmcnt(0)
    s_cbranch_scc1 .pdone_33
    s_cmp_lt_u32 s42, 16
    s_cbranch_scc1 .poll_32
.pdone_33:
    s_max_i32 s38, s38, 0
    s_mov_b32 s85, 2
.ll_34:
    buffer_load_dwordx4 v40, s[76:79], s65 offen offset:0 sc1 lds
    buffer_load_dwordx4 v40, s[76:79], s65 offen offset:1024 sc1 lds
    buffer_load_dwordx4 v40, s[76:79], s65 offen offset:2048 sc1 lds
    buffer_load_dwordx4 v40, s[76:79], s65 offen offset:3072 sc1 lds
    s_add_u32 m0, m0, 4096
    s_add_u32 s66, s66, 1
    v_readlane_b32 s84, v74, s66
    s_add_u32 s64, s64, 16384
    s_and_b32 s64, s64, 0xffff
    s_sub_u32 s85, s85, 1
    s_cmp_lg_u32 s85, 0
    buffer_load_dwordx4 v41, s[76:79], s65 offen offset:0 sc1 lds
    buffer_load_dwordx4 v41, s[76:79], s65 offen offset:1024 sc1 lds
    buffer_load_dwordx4 v41, s[76:79], s65 offen offset:2048 sc1 lds
    buffer_load_dwordx4 v41, s[76:79], s65 offen offset:3072 sc1 lds
    s_mov_b32 m0, s64
    s_mov_b32 s65, s84
    s_cbranch_scc1 .ll_34
    s_waitcnt vmcnt(8)
    s_barrier
    buffer_load_dwordx4 v40, s[76:79], s65 offen offset:0 sc1 lds
    buffer_load_dwordx4 v40, s[76:79], s65 offen offset:1024 sc1 lds
    buffer_load_dwordx4 v40, s[76:79], s65 offen offset:2048 sc1 lds
    buffer_load_dwordx4 v40, s[76:79], s65 offen offset:3072 sc1 lds
    s_add_u32 m0, m0, 4096
    s_nop 0
    s_add_u32 s66, s66, 1
    v_readlane_b32 s84, v74, s66
    s_add_u32 s64, s64, 16384
    s_and_b32 s64, s64, 0xffff
    buffer_load_dwordx4 v41, s[76:79], s65 offen offset:0 sc1 lds
    buffer_load_dwordx4 v41, s[76:79], s65 offen offset:1024 sc1 lds
    buffer_load_dwordx4 v41, s[76:79], s65 offen offset:2048 sc1 lds
    buffer_load_dwordx4 v41, s[76:79], s65 offen offset:3072 sc1 lds
    s_mov_b32 m0, s64
    s_mov_b32 s65, s84
    buffer_load_dwordx4 v40, s[76:79], s65 offen offset:0 sc1 lds
    buffer_load_dwordx4 v40, s[76:79], s65 offen offset:1024 sc1 lds
    buffer_load_dwordx4 v40, s[76:79], s65 offen offset:2048 sc1 lds
    buffer_load_dwordx4 v40, s[76:79], s65 offen offset:3072 sc1 lds
    s_add_u32 m0, m0, 4096
    s_nop 0
    s_add_u32 s66, s66, 1
    v_readlane_b32 s84, v74, s66
    s_add_u32 s64, s64, 16384
    s_and_b32 s64, s64, 0xffff
    buffer_load_dwordx4 v41, s[76:79], s65 offen offset:0 sc1 lds
    buffer_load_dwordx4 v41, s[76:79], s65 offen offset:1024 sc1 lds
    buffer_load_dwordx4 v41, s[76:79], s65 offen offset:2048 sc1 lds
    buffer_load_dwordx4 v41, s[76:79], s65 offen offset:3072 sc1 lds
    s_mov_b32 m0, s64
    s_mov_b32 s65, s84
    s_waitcnt vmcnt(16)
    s_barrier
    s_mov_b32 s85, 12
.ll_35:
    s_waitcnt vmcnt(8)
    buffer_load_dwordx4 v40, s[76:79], s65 offen offset:0 sc1 lds
    buffer_load_dwordx4 v40, s[76:79], s65 offen offset:1024 sc1 lds
    buffer_load_dwordx4 v40, s[76:79], s65 offen offset:2048 sc1 lds
    s_barrier
    buffer_load_dwordx4 v40, s[76:79], s65 offen offset:3072 sc1 lds
    s_add_u32 m0, m0, 4096
    s_add_u32 s66, s66, 1
    v_readlane_b32 s84, v74, s66
    s_add_u32 s64, s64, 16384
    s_and_b32 s64, s64, 0xffff
    s_sub_u32 s85, s85, 1
    s_cmp_lg_u32 s85, 0
    buffer_load_dwordx4 v41, s[76:79], s65 offen offset:0 sc1 lds
    buffer_load_dwordx4 v41, s[76:79], s65 offen offset:1024 sc1 lds
    buffer_load_dwordx4 v41, s[76:79], s65 offen offset:2048 sc1 lds
    buffer_load_dwordx4 v41, s[76:79], s65 offen offset:3072 sc1 lds
    s_mov_b32 m0, s64
    s_mov_b32 s65, s84
    s_cbranch_scc1 .ll_35
    s_waitcnt vmcnt(8)
    s_barrier
    s_waitcnt vmcnt(0)
    s_barrier
    s_lshl_b32 s64, s37, 13
    s_mov_b32 s66, 0
    s_mov_b32 m0, s64
    s_waitcnt lgkmcnt(0)
    v_readlane_b32 s65, v74, 0
    s_nop 4
    s_barrier
    s_waitcnt vmcnt(24)
    s_barrier
    s_waitcnt vmcnt(16)
    s_barrier
    s_mov_b32 s85, 12
.ll_36:
    s_waitcnt vmcnt(8)
    buffer_load_dwordx4 v40, s[76:79], s65 offen offset:0 sc1 lds
    buffer_load_dwordx4 v40, s[76:79], s65 offen offset:1024 sc1 lds
    buffer_load_dwordx4 v40, s[76:79], s65 offen offset:2048 sc1 lds
    s_barrier
    buffer_load_dwordx4 v40, s[76:79], s65 offen offset:3072 sc1 lds
    s_add_u32 m0, m0, 4096
    s_add_u32 s66, s66, 1
    v_readlane_b32 s84, v74, s66
    s_add_u32 s64, s64, 16384
    s_and_b32 s64, s64, 0xffff
    s_sub_u32 s85, s85, 1
    s_cmp_lg_u32 s85, 0
    buffer_load_dwordx4 v41, s[76:79], s65 offen offset:0 sc1 lds
    buffer_load_dwordx4 v41, s[76:79], s65 offen offset:1024 sc1 lds
    buffer_load_dwordx4 v41, s[76:79], s65 offen offset:2048 sc1 lds
    buffer_load_dwordx4 v41, s[76:79], s65 offen offset:3072 sc1 lds
    s_mov_b32 m0, s64
    s_mov_b32 s65, s84
    s_cbranch_scc1 .ll_36
    s_waitcnt vmcnt(8)
    s_barrier
    s_waitcnt vmcnt(0)
    s_barrier
    s_lshl_b32 s64, s37, 13
    s_mov_b32 s66, 0
    s_mov_b32 m0, s64
    s_waitcnt lgkmcnt(0)
    v_readlane_b32 s65, v75, 0
    s_nop 4
    s_barrier
    s_nop 0
    s_mov_b32 s85, 4
.ll_37:
    buffer_load_dwordx4 v56, s[80:83], s65 offen offset:0 lds
    buffer_load_dwordx4 v57, s[80:83], s65 offen offset:1024 lds
    buffer_load_dwordx4 v58, s[80:83], s65 offen offset:2048 lds
    buffer_load_dwordx4 v59, s[80:83], s65 offen offset:3072 lds
    s_add_u32 m0, m0, 4096
    s_add_u32 s66, s66, 1
    v_readlane_b32 s84, v75, s66
    s_add_u32 s64, s64, 16384
    s_and_b32 s64, s64, 0xffff
    s_sub_u32 s85, s85, 1
    s_cmp_lg_u32 s85, 0
    buffer_load_dwordx4 v60, s[80:83], s65 offen offset:0 lds
    buffer_load_dwordx4 v61, s[80:83], s65 offen offset:1024 lds
    buffer_load_dwordx4 v62, s[80:83], s65 offen offset:2048 lds
    buffer_load_dwordx4 v63, s[80:83], s65 offen offset:3072 lds
    s_mov_b32 m0, s64
    s_mov_b32 s65, s84
    s_cbranch_scc1 .ll_37
    s_waitcnt vmcnt(24)
    s_barrier
    s_waitcnt vmcnt(16)
    s_barrier
    s_mov_b32 s85, 28
.ll_38:
    s_waitcnt vmcnt(8)
    buffer_load_dwordx4 v56, s[80:83], s65 offen offset:0 lds
    buffer_load_dwordx4 v57, s[80:83], s65 offen offset:1024 lds
    buffer_load_dwordx4 v58, s[80:83], s65 offen offset:2048 lds
    s_barrier
    buffer_load_dwordx4 v59, s[80:83], s65 offen offset:3072 lds
    s_add_u32 m0, m0, 4096
    s_add_u32 s66, s66, 1
    v_readlane_b32 s84, v75, s66
    s_add_u32 s64, s64, 16384
    s_and_b32 s64, s64, 0xffff
    s_sub_u32 s85, s85, 1
    s_cmp_lg_u32 s85, 0
    buffer_load_dwordx4 v60, s[80:83], s65 offen offset:0 lds
    buffer_load_dwordx4 v61, s[80:83], s65 offen offset:1024 lds
    buffer_load_dwordx4 v62, s[80:83], s65 offen offset:2048 lds
    buffer_load_dwordx4 v63, s[80:83], s65 offen offset:3072 lds
    s_mov_b32 m0, s64
    s_mov_b32 s65, s84
    s_cbranch_scc1 .ll_38
    s_waitcnt vmcnt(8)
    s_barrier
    s_waitcnt vmcnt(0)
    s_barrier
    s_lshl_b32 s64, s37, 13
    s_mov_b32 s66, 0
    s_mov_b32 m0, s64
    s_waitcnt lgkmcnt(0)
    v_readlane_b32 s65, v72, 0
    s_nop 4
    s_barrier
    s_barrier
    s_branch .hj_40
.hret_39:
    s_sub_u32 s29, s33, s36
    s_and_b32 s29, s29, 3
    s_and_b32 s30, s33, 0
    s_sub_u32 s29, 4, s29
    v_lshrrev_b32 v72, 1, v1
    v_add3_u32 v2, v72, s29, -1
    v_lshrrev_b32 v2, 2, v2
    v_add_u32 v3, s29, v72
    v_lshrrev_b32 v3, 2, v3
    v_add_u32 v4, 1, v72
    v_min_u32 v4, 13, v4
    v_add_u32 v4, s29, v4
    v_lshrrev_b32 v4, 2, v4
    v_sub_u32 v4, v4, v2
    v_add_u32 v4, v4, v72
    v_subrev_u32 v5, 1, v72
    v_max_i32_e64 v5, 0, v5
    v_add3_u32 v6, v5, s29, -1
    v_lshrrev_b32 v6, 2, v6
    v_sub_u32 v5, v5, v6
    v_add_u32 v5, v5, v2
    v_cmp_ne_u32 vcc, v3, v2
    s_nop 1
    v_cndmask_b32 v5, v4, v5, vcc
    v_and_b32_e64 v3, 1, v1
    v_lshl_add_u32 v5, v5, 1, v3
    v_cmp_gt_u32 vcc, 28, v1
    s_nop 1
    v_cndmask_b32_e64 v5, v1, v5, vcc
    v_add_lshl_u32 v5, v5, 0, 2
    v_add_u32 v6, s30, v1
    v_subrev_u32 v3, 28, v6
    v_min_u32_e64 v6, v6, v3
    v_mul_u32_u24 v6, 16384, v6
    ds_permute_b32 v72, v5, v6
    s_lshl_b32 s28, s37, 13
    v_lshl_add_u32 v8, v1, 4, s28
    v_add_u32 v9, 4096, v8
    s_waitcnt lgkmcnt(0)
    s_mul_i32 s28, s33, 458752
    s_add_u32 s70, s28, 16777216
    s_add_u32 s68, s26, s70
    s_addc_u32 s69, s27, 0
    s_mov_b32 s70, 458752
    s_mov_b32 s71, 0x20000
    s_lshl_b32 s64, s37, 13
    s_mov_b32 s66, 0
    s_mov_b32 m0, s64
    s_waitcnt lgkmcnt(0)
    v_readlane_b32 s65, v72, 0
    s_nop 4
.hj_40:
    s_and_b32 s28, s34, 3
    s_lshl4_add_u32 s28, s33, s28
    s_lshl_b32 s28, s28, 7
.poll_41:
    s_load_dword s42, s[52:53], s28 offset:131072 glc
    s_sub_u32 s38, s38, 1
    s_waitcnt lgkmcnt(0)
    s_cbranch_scc1 .pdone_42
    s_cmp_lg_u32 s42, 0
    s_cbranch_scc1 .pz_43
    s_sleep 8
.pz_43:
    s_cmp_lt_u32 s42, 14
    s_cbranch_scc1 .poll_41
.pdone_42:
    s_max_i32 s38, s38, 0
    s_mov_b32 s85, 2
.ll_44:
    buffer_load_dwordx4 v8, s[68:71], s65 offen offset:0 sc1 lds
    buffer_load_dwordx4 v8, s[68:71], s65 offen offset:1024 sc1 lds
    buffer_load_dwordx4 v8, s[68:71], s65 offen offset:2048 sc1 lds
    buffer_load_dwordx4 v8, s[68:71], s65 offen offset:3072 sc1 lds
    s_add_u32 m0, m0, 4096
    s_add_u32 s66, s66, 1
    v_readlane_b32 s84, v72, s66
    s_add_u32 s64, s64, 16384
    s_and_b32 s64, s64, 0xffff
    s_sub_u32 s85, s85, 1
    s_cmp_lg_u32 s85, 0
    buffer_load_dwordx4 v9, s[68:71], s65 offen offset:0 sc1 lds
    buffer_load_dwordx4 v9, s[68:71], s65 offen offset:1024 sc1 lds
    buffer_load_dwordx4 v9, s[68:71], s65 offen offset:2048 sc1 lds
    buffer_load_dwordx4 v9, s[68:71], s65 offen offset:3072 sc1 lds
    s_mov_b32 m0, s64
    s_mov_b32 s65, s84
    s_cbranch_scc1 .ll_44
    s_waitcnt vmcnt(8)
    s_barrier
    buffer_load_dwordx4 v8, s[68:71], s65 offen offset:0 sc1 lds
    buffer_load_dwordx4 v8, s[68:71], s65 offen offset:1024 sc1 lds
    buffer_load_dwordx4 v8, s[68:71], s65 offen offset:2048 sc1 lds
    buffer_load_dwordx4 v8, s[68:71], s65 offen offset:3072 sc1 lds
    s_add_u32 m0, m0, 4096
    s_nop 0
    s_add_u32 s66, s66, 1
    v_readlane_b32 s84, v72, s66
    s_add_u32 s64, s64, 16384
    s_and_b32 s64, s64, 0xffff
    buffer_load_dwordx4 v9, s[68:71], s65 offen offset:0 sc1 lds
    buffer_load_dwordx4 v9, s[68:71], s65 offen offset:1024 sc1 lds
    buffer_load_dwordx4 v9, s[68:71], s65 offen offset:2048 sc1 lds
    buffer_load_dwordx4 v9, s[68:71], s65 offen offset:3072 sc1 lds
    s_mov_b32 m0, s64
    s_mov_b32 s65, s84
    buffer_load_dwordx4 v8, s[68:71], s65 offen offset:0 sc1 lds
    buffer_load_dwordx4 v8, s[68:71], s65 offen offset:1024 sc1 lds
    buffer_load_dwordx4 v8, s[68:71], s65 offen offset:2048 sc1 lds
    buffer_load_dwordx4 v8, s[68:71], s65 offen offset:3072 sc1 lds
    s_add_u32 m0, m0, 4096
    s_nop 0
    s_add_u32 s66, s66, 1
    v_readlane_b32 s84, v72, s66
    s_add_u32 s64, s64, 16384
    s_and_b32 s64, s64, 0xffff
    buffer_load_dwordx4 v9, s[68:71], s65 offen offset:0 sc1 lds
    buffer_load_dwordx4 v9, s[68:71], s65 offen offset:1024 sc1 lds
    buffer_load_dwordx4 v9, s[68:71], s65 offen offset:2048 sc1 lds
    buffer_load_dwordx4 v9, s[68:71], s65 offen offset:3072 sc1 lds
    s_mov_b32 m0, s64
    s_mov_b32 s65, s84
    s_mov_b32 s85, 24
.ll_45:
    s_waitcnt vmcnt(16)
    s_barrier
    buffer_load_dwordx4 v8, s[68:71], s65 offen offset:0 sc1 lds
    buffer_load_dwordx4 v8, s[68:71], s65 offen offset:1024 sc1 lds
    buffer_load_dwordx4 v8, s[68:71], s65 offen offset:2048 sc1 lds
    buffer_load_dwordx4 v8, s[68:71], s65 offen offset:3072 sc1 lds
    s_add_u32 m0, m0, 4096
    s_add_u32 s66, s66, 1
    v_readlane_b32 s84, v72, s66
    s_add_u32 s64, s64, 16384
    s_and_b32 s64, s64, 0xffff
    s_sub_u32 s85, s85, 1
    s_cmp_lg_u32 s85, 0
    buffer_load_dwordx4 v9, s[68:71], s65 offen offset:0 sc1 lds
    buffer_load_dwordx4 v9, s[68:71], s65 offen offset:1024 sc1 lds
    buffer_load_dwordx4 v9, s[68:71], s65 offen offset:2048 sc1 lds
    buffer_load_dwordx4 v9, s[68:71], s65 offen offset:3072 sc1 lds
    s_mov_b32 m0, s64
    s_mov_b32 s65, s84
    s_cbranch_scc1 .ll_45
    s_waitcnt vmcnt(16)
    s_barrier
    s_waitcnt vmcnt(8)
    s_barrier
    s_waitcnt vmcnt(0)
    s_barrier
    s_barrier
    s_endpgm
    s_nop 0
.pad_14:
    s_nop 0
    s_setpc_b64 s[44:45]
.cont_49:
    s_mov_b32 s64, 5
    s_cmp_eq_u32 s64, 0
    s_cbranch_scc1 .nb_50
    s_barrier
    s_sub_u32 s64, s64, 1
.nb_50:
    s_cmp_eq_u32 s64, 0
    s_cbranch_scc1 .nb_51
    s_barrier
    s_sub_u32 s64, s64, 1
.nb_51:
    s_cmp_eq_u32 s64, 0
    s_cbranch_scc1 .nb_52
    s_barrier
    s_sub_u32 s64, s64, 1
.nb_52:
    s_load_dwordx8 s[80:87], s[24:25], 64
    s_cmp_eq_u32 s64, 0
    s_cbranch_scc1 .nb_55
    s_barrier
    s_sub_u32 s64, s64, 1
.nb_55:
    s_cmp_eq_u32 s64, 0
    s_cbranch_scc1 .nb_56
    s_barrier
    s_sub_u32 s64, s64, 1
.nb_56:
    s_waitcnt lgkmcnt(0)
    s_add_u32 s80, s80, s81
    s_add_u32 s80, s80, s82
    s_add_u32 s80, s80, s83
    s_add_u32 s80, s80, s84
    s_add_u32 s80, s80, s85
    s_add_u32 s80, s80, s86
    s_add_u32 s80, s80, s87
    s_cmp_ge_u32 s80, 32
    s_cbranch_scc1 .g0d_54
    s_add_u32 s72, s24, 64
    s_addc_u32 s73, s25, 0
    s_mov_b32 s74, 32
    s_mov_b32 s75, 0x20000
.g0_53:
    buffer_load_dword v3, v153, s[72:75], 0 offen sc1
    s_sub_u32 s38, s38, 1
    s_waitcnt vmcnt(0)
    s_cbranch_scc1 .g0d_54
    v_cmp_le_u32 vcc, 4, v3
    s_nop 0
    s_cmp_eq_u32 vcc_lo, 0xff
    s_cbranch_scc0 .g0_53
.g0d_54:
    s_max_i32 s38, s38, 0
    s_add_u32 s64, s64, 3
.dr_57:
    s_cmp_eq_u32 s64, 0
    s_cbranch_scc1 .dd_58
    s_barrier
    s_sub_u32 s64, s64, 1
    s_branch .dr_57
.dd_58:
    s_mov_b32 s64, 7
    s_lshl_b32 s28, s33, 11
    s_atomic_add s40, s[52:53], s28 offset:0
    s_atomic_add s40, s[52:53], s28 offset:128
    s_atomic_add s40, s[52:53], s28 offset:256
    s_atomic_add s40, s[52:53], s28 offset:384
    s_lshl_b32 s28, s34, 11
    s_atomic_add s40, s[52:53], s28 offset:163840
    s_atomic_add s40, s[52:53], s28 offset:163968
    s_atomic_add s40, s[52:53], s28 offset:164096
    s_atomic_add s40, s[52:53], s28 offset:164224
    s_cmp_eq_u32 s64, 0
    s_cbranch_scc1 .nb_59
    s_barrier
    s_sub_u32 s64, s64, 1
.nb_59:
    s_mov_b32 s31, .code_ck-sequential_preLN__linear_kernel_hedgehog__mixer_gmlp__prompt_kernel
    s_and_b32 s31, s31, 0xfff80
    s_load_dwordx2 s[78:79], s[76:77], s31 offset:60
    s_load_dwordx2 s[78:79], s[76:77], s31 offset:188
    s_load_dwordx2 s[78:79], s[76:77], s31 offset:316
    s_load_dwordx2 s[78:79], s[76:77], s31 offset:444
    s_cmp_eq_u32 s64, 0
    s_cbranch_scc1 .nb_60
    s_barrier
    s_sub_u32 s64, s64, 1
.nb_60:
    s_cmp_eq_u32 s64, 0
    s_cbranch_scc1 .nb_61
    s_barrier
    s_sub_u32 s64, s64, 1
.nb_61:
    s_and_b32 s28, s34, 3
    s_lshl4_add_u32 s28, s33, s28
    s_lshl_b32 s28, s28, 7
    s_and_b32 s30, s33, 3
    s_lshl4_add_u32 s30, s34, s30
    s_lshl_b32 s30, s30, 7
.poll_62:
    s_load_dword s42, s[52:53], s28 offset:0 glc
    s_load_dword s43, s[52:53], s30 offset:163840 glc
    s_cmp_eq_u32 s64, 0
    s_cbranch_scc1 .nb_64
    s_barrier
    s_sub_u32 s64, s64, 1
.nb_64:
    s_sub_u32 s38, s38, 1
    s_waitcnt lgkmcnt(0)
    s_cbranch_scc1 .pdone_63
    s_min_u32 s42, s42, s43
    s_cmp_lt_u32 s42, 16
    s_cbranch_scc1 .poll_62
.pdone_63:
    s_max_i32 s38, s38, 0
.w4_65:
    s_cmp_le_u32 s64, 2
    s_cbranch_scc1 .w4d_66
    s_cmp_eq_u32 s64, 0
    s_cbranch_scc1 .nb_67
    s_barrier
    s_sub_u32 s64, s64, 1
.nb_67:
    s_branch .w4_65
.w4d_66:
    v_lshlrev_b32 v4, 3, v1
    s_lshl_b32 s28, s33, 10
    s_add_u32 s28, s28, 65536
    buffer_load_dwordx2 v[8:9], v4, s[60:63], s28 offen offset:0 sc1
    buffer_load_dwordx2 v[10:11], v4, s[60:63], s28 offen offset:512 sc1
    v_lshlrev_b32 v4, 2, v1
    s_lshl_b32 s28, s34, 9
    s_add_u32 s28, s28, 32768
    s_mov_b32 m0, 148480
    s_nop 0
    buffer_load_dword v4, s[60:63], s28 offen offset:0 sc1 lds
    buffer_load_dword v4, s[60:63], s28 offen offset:256 sc1 lds
    s_mov_b64 s[68:69], s[10:11]
    s_mov_b32 s70, 2097152
    s_mov_b32 s71, 0x20000
    s_lshr_b32 s28, s2, 1
    s_mul_i32 s28, s28, 16384
    s_and_b32 s29, s2, 1
    s_mul_i32 s29, s29, 1024
    s_add_u32 s28, s28, s29
    v_lshrrev_b32 v4, 3, v1
    v_mul_u32_u24 v4, 2048, v4
    v_and_b32_e64 v5, 7, v1
    v_lshl_add_u32 v4, v5, 7, v4
    buffer_load_dword v152, v4, s[68:71], s28 offen
    s_mov_b64 s[68:69], s[14:15]
    s_mov_b32 s70, 7340032
    s_mov_b32 s71, 0x20000
    s_lshr_b32 s28, s2, 1
    s_mul_i32 s28, s28, 57344
    s_and_b32 s29, s2, 1
    s_mul_i32 s29, s29, 1792
    s_add_u32 s28, s28, s29
    s_add_u32 s28, s28, 3584
    v_lshrrev_b32_e64 v4, 4, v1
    v_mul_u32_u24 v4, 7168, v4
    v_and_b32 v5, 15, v1
    v_min_u32 v5, 13, v5
    v_lshl_add_u32 v4, v5, 7, v4
    buffer_load_dword v152, v4, s[68:71], s28 offen
    s_mov_b64 s[68:69], s[14:15]
    s_mov_b32 s70, 7340032
    s_mov_b32 s71, 0x20000
    s_lshr_b32 s28, s2, 1
    s_mul_i32 s28, s28, 57344
    s_and_b32 s29, s2, 1
    s_mul_i32 s29, s29, 1792
    s_add_u32 s28, s28, s29
    s_add_u32 s28, s28, 32256
    v_lshrrev_b32_e64 v4, 4, v1
    v_mul_u32_u24 v4, 7168, v4
    v_and_b32 v5, 15, v1
    v_min_u32 v5, 13, v5
    v_lshl_add_u32 v4, v5, 7, v4
    buffer_load_dword v152, v4, s[68:71], s28 offen
    s_mul_i32 s28, s33, 393216
    s_lshl_b32 s29, s34, 7
    s_add_u32 s28, s28, s29
    s_add_u32 s68, s6, s28
    s_addc_u32 s69, s7, 0
    s_mov_b32 s70, 387200
    s_mov_b32 s71, 0x20000
    v_lshrrev_b32_e64 v2, 3, v1
    v_mul_u32_u24 v2, 6144, v2
    v_and_b32_e64 v3, 7, v1
    v_lshl_add_u32 v16, v3, 4, v2
    v_add_u32 v17, 48128, v16
    v_add_u32 v18, 96256, v16
    v_add_u32 v19, 144384, v16
.dr_68:
    s_cmp_eq_u32 s64, 0
    s_cbranch_scc1 .dd_69
    s_barrier
    s_sub_u32 s64, s64, 1
    s_branch .dr_68
.dd_69:
    s_waitcnt vmcnt(3)
    v_mul_f32 v8, 0xba800000, v8
    v_mul_f32 v10, 0x3a800000, v10
    v_fma_f32 v10, -v8, v8, v10
    v_max_f32_e64 v10, 0, v10
    v_add_f32 v10, 0x3727c5ac, v10
    v_rsq_f32_e64 v136, v10
    v_mul_f32 v9, 0xba800000, v9
    v_mul_f32 v11, 0x3a800000, v11
    v_fma_f32 v11, -v9, v9, v11
    v_max_f32_e64 v11, 0, v11
    v_add_f32 v11, 0x3727c5ac, v11
    v_rsq_f32 v137, v11
    v_lshlrev_b32 v4, 3, v1
    v_add_u32 v4, 147456, v4
    ds_write_b64 v4, v[136:137]
    ds_write_b64 v4, v[8:9] offset:512
    s_waitcnt lgkmcnt(0)
    s_mov_b32 m0, 139264
    s_mov_b32 s28, 196608
    s_barrier
    buffer_load_dwordx4 v16, s[68:71], 0 offen offset:0 lds
    buffer_load_dwordx4 v17, s[68:71], 0 offen offset:1024 lds
    buffer_load_dwordx4 v18, s[68:71], 0 offen offset:2048 lds
    buffer_load_dwordx4 v19, s[68:71], 0 offen offset:3072 lds
    s_mov_b32 m0, 143360
    s_nop 0
    s_nop 0
    buffer_load_dwordx4 v16, s[68:71], s28 offen offset:0 lds
    buffer_load_dwordx4 v17, s[68:71], s28 offen offset:1024 lds
    buffer_load_dwordx4 v18, s[68:71], s28 offen offset:2048 lds
    buffer_load_dwordx4 v19, s[68:71], s28 offen offset:3072 lds
    v_mov_b32 v20, 0x3f803f80
    v_mov_b32 v21, 0x3f803f80
    v_mov_b32 v22, 0x3f803f80
    v_mov_b32 v23, 0x3f803f80
    v_lshrrev_b32 v2, 2, v1
    v_and_b32 v3, 3, v1
    v_lshlrev_b32_e64 v3, 3, v3
    v_lshl_add_u32 v2, v2, 7, v3
    v_add_u32 v2, 139264, v2
    s_nop 0
    s_waitcnt vmcnt(0)
    ds_read_b64_tr_b16 v[24:25], v2 offset:0
    ds_read_b64_tr_b16 v[26:27], v2 offset:2048
    ds_read_b64_tr_b16 v[28:29], v2 offset:4096
    ds_read_b64_tr_b16 v[30:31], v2 offset:6144
    ds_read_b64_tr_b16 v[32:33], v2 offset:32
    ds_read_b64_tr_b16 v[34:35], v2 offset:2080
    ds_read_b64_tr_b16 v[36:37], v2 offset:4128
    ds_read_b64_tr_b16 v[38:39], v2 offset:6176
    ds_read_b64_tr_b16 v[40:41], v2 offset:64
    ds_read_b64_tr_b16 v[42:43], v2 offset:2112
    ds_read_b64_tr_b16 v[44:45], v2 offset:4160
    ds_read_b64_tr_b16 v[46:47], v2 offset:6208
    ds_read_b64_tr_b16 v[48:49], v2 offset:96
    ds_read_b64_tr_b16 v[50:51], v2 offset:2144
    ds_read_b64_tr_b16 v[52:53], v2 offset:4192
    ds_read_b64_tr_b16 v[54:55], v2 offset:6240
    s_waitcnt lgkmcnt(0)
    v_mfma_f32_16x16x32_bf16 v[56:59], v[20:23], v[24:27], 0
    v_mfma_f32_16x16x32_bf16 v[56:59], v[20:23], v[28:31], v[56:59]
    v_mfma_f32_16x16x32_bf16 v[60:63], v[20:23], v[32:35], 0
    v_mfma_f32_16x16x32_bf16 v[60:63], v[20:23], v[36:39], v[60:63]
    v_mfma_f32_16x16x32_bf16 v[64:67], v[20:23], v[40:43], 0
    v_mfma_f32_16x16x32_bf16 v[64:67], v[20:23], v[44:47], v[64:67]
    v_mfma_f32_16x16x32_bf16 v[68:71], v[20:23], v[48:51], 0
    v_mfma_f32_16x16x32_bf16 v[68:71], v[20:23], v[52:55], v[68:71]
    v_cmp_le_u32 vcc, 16, v1
    s_nop 2
    v_cndmask_b32 v56, v56, v60, vcc
    v_cmp_le_u32 vcc, 32, v1
    s_nop 1
    v_cndmask_b32 v56, v56, v64, vcc
    v_cmp_le_u32 vcc, 48, v1
    s_nop 1
    v_cndmask_b32 v56, v56, v68, vcc
    s_lshl_b32 s28, s34, 8
    s_add_u32 s28, s28, 81920
    buffer_atomic_add_f32 v56, v153, s[60:63], s28 offen sc1
    s_mov_b32 s64, 4
.dr_70:
    s_cmp_eq_u32 s64, 0
    s_cbranch_scc1 .dd_71
    s_barrier
    s_sub_u32 s64, s64, 1
    s_branch .dr_70
.dd_71:
    s_waitcnt vmcnt(0)
    s_nop 0
    s_lshl_b32 s28, s34, 11
    s_atomic_add s40, s[52:53], s28 offset:196608
    s_atomic_add s40, s[52:53], s28 offset:196736
    s_atomic_add s40, s[52:53], s28 offset:196864
    s_atomic_add s40, s[52:53], s28 offset:196992
    s_mov_b32 s31, .code_cq-sequential_preLN__linear_kernel_hedgehog__mixer_gmlp__prompt_kernel
    s_and_b32 s31, s31, 0xfff80
    s_load_dwordx2 s[78:79], s[76:77], s31 offset:60
    s_load_dwordx2 s[78:79], s[76:77], s31 offset:188
    s_load_dwordx2 s[78:79], s[76:77], s31 offset:316
    s_load_dwordx2 s[78:79], s[76:77], s31 offset:444
    s_mov_b32 s64, 12
    s_cmp_eq_u32 s64, 0
    s_cbranch_scc1 .nb_72
    s_barrier
    s_branch .pg_15
.p2align 12
.pad_15:
    s_nop 0
    s_setpc_b64 s[44:45]
.pg_15:
    s_sub_u32 s64, s64, 1
.nb_72:
    s_cmp_eq_u32 s64, 0
    s_cbranch_scc1 .nb_73
    s_barrier
    s_sub_u32 s64, s64, 1
.nb_73:
    s_and_b32 s28, s33, 3
    s_lshl4_add_u32 s28, s34, s28
    s_lshl_b32 s28, s28, 7
.poll_74:
    s_load_dword s42, s[52:53], s28 offset:196608 glc
    s_cmp_eq_u32 s64, 0
    s_cbranch_scc1 .nb_76
    s_barrier
    s_sub_u32 s64, s64, 1
.nb_76:
    s_sub_u32 s38, s38, 1
    s_waitcnt lgkmcnt(0)
    s_cbranch_scc1 .pdone_75
    s_cmp_lt_u32 s42, 16
    s_cbranch_scc1 .poll_74
.pdone_75:
    s_max_i32 s38, s38, 0
    s_lshl_b32 s28, s34, 8
    s_add_u32 s28, s28, 81920
    s_mov_b32 m0, 148992
    s_nop 0
    buffer_load_dword v153, s[60:63], s28 offen sc1 lds
    s_lshl4_add_u32 s30, s34, s33
    s_lshl_b32 s28, s30, 14
    s_add_u32 s70, s28, 25165824
    s_add_u32 s68, s26, s70
    s_addc_u32 s69, s27, 0
    s_mov_b32 s70, 16384
    s_mov_b32 s71, 0x20000
    v_lshlrev_b32 v6, 4, v1
    v_lshlrev_b32 v2, 3, v1
    s_lshl_b32 s29, s34, 9
    s_add_u32 s29, s29, 57344
    buffer_load_dwordx2 v[136:137], v2, s[60:63], s29 offen sc1
    s_mov_b32 s28, 0
    buffer_load_dwordx4 v[8:11], v6, s[68:71], s28 offen offset:0 sc1
    buffer_load_dwordx4 v[12:15], v6, s[68:71], s28 offen offset:1024 sc1
    buffer_load_dwordx4 v[16:19], v6, s[68:71], s28 offen offset:2048 sc1
    buffer_load_dwordx4 v[20:23], v6, s[68:71], s28 offen offset:3072 sc1
    s_add_u32 s28, s28, 4096
    buffer_load_dwordx4 v[24:27], v6, s[68:71], s28 offen offset:0 sc1
    buffer_load_dwordx4 v[28:31], v6, s[68:71], s28 offen offset:1024 sc1
    buffer_load_dwordx4 v[32:35], v6, s[68:71], s28 offen offset:2048 sc1
    buffer_load_dwordx4 v[36:39], v6, s[68:71], s28 offen offset:3072 sc1
    s_add_u32 s28, s28, 4096
    buffer_load_dwordx4 v[40:43], v6, s[68:71], s28 offen offset:0 sc1
    buffer_load_dwordx4 v[44:47], v6, s[68:71], s28 offen offset:1024 sc1
    buffer_load_dwordx4 v[48:51], v6, s[68:71], s28 offen offset:2048 sc1
    buffer_load_dwordx4 v[52:55], v6, s[68:71], s28 offen offset:3072 sc1
    s_add_u32 s28, s28, 4096
    buffer_load_dwordx4 v[56:59], v6, s[68:71], s28 offen offset:0 sc1
    buffer_load_dwordx4 v[60:63], v6, s[68:71], s28 offen offset:1024 sc1
    buffer_load_dwordx4 v[64:67], v6, s[68:71], s28 offen offset:2048 sc1
    buffer_load_dwordx4 v[68:71], v6, s[68:71], s28 offen offset:3072 sc1
    s_lshl_b32 s28, s30, 9
    s_add_u32 s70, s28, 33554432
    s_add_u32 s68, s26, s70
    s_addc_u32 s69, s27, 0
    s_mov_b32 s70, 512
    s_mov_b32 s71, 0x20000
    s_mov_b32 s88, 0
    s_cmp_eq_u32 s64, 0
    s_cbranch_scc1 .nb_77
    s_barrier
    s_sub_u32 s64, s64, 1
.nb_77:
    s_cmp_eq_u32 s64, 0
    s_cbranch_scc1 .nb_78
    s_barrier
    s_sub_u32 s64, s64, 1
.nb_78:
    s_waitcnt vmcnt(16)
    s_setprio 2
    s_or_b32 s31, s64, s88
    s_cbranch_scc1 .pr_79
    v_cvt_pk_bf16_f32 v136, v136, v137
    v_add_u32 v2, 150528, v153
    ds_write_b32 v2, v136
    s_waitcnt lgkmcnt(0)
    s_barrier
    s_mov_b32 s88, 1
.pr_79:
    s_waitcnt vmcnt(12)
    v_lshlrev_b32_e64 v72, 16, v8
    v_and_b32 v73, 0xffff0000, v8
    v_lshlrev_b32_e64 v74, 16, v9
    v_and_b32 v75, 0xffff0000, v9
    v_lshlrev_b32_e64 v76, 16, v10
    v_and_b32 v77, 0xffff0000, v10
    v_lshlrev_b32_e64 v78, 16, v11
    v_and_b32 v79, 0xffff0000, v11
    v_lshlrev_b32_e64 v80, 16, v12
    v_and_b32 v81, 0xffff0000, v12
    v_add_f32 v72, v72, v80
    v_add_f32 v73, v73, v81
    v_lshlrev_b32_e64 v80, 16, v13
    v_and_b32 v81, 0xffff0000, v13
    v_add_f32 v74, v74, v80
    v_add_f32 v75, v75, v81
    v_lshlrev_b32_e64 v80, 16, v14
    v_and_b32 v81, 0xffff0000, v14
    v_add_f32 v76, v76, v80
    v_add_f32 v77, v77, v81
    v_lshlrev_b32_e64 v80, 16, v15
    v_and_b32 v81, 0xffff0000, v15
    v_add_f32 v78, v78, v80
    v_add_f32 v79, v79, v81
    v_lshlrev_b32_e64 v80, 16, v16
    v_and_b32 v81, 0xffff0000, v16
    v_add_f32 v72, v72, v80
    v_add_f32 v73, v73, v81
    v_lshlrev_b32_e64 v80, 16, v17
    v_and_b32 v81, 0xffff0000, v17
    v_add_f32 v74, v74, v80
    v_add_f32 v75, v75, v81
    v_lshlrev_b32_e64 v80, 16, v18
    v_and_b32 v81, 0xffff0000, v18
    v_add_f32 v76, v76, v80
    v_add_f32 v77, v77, v81
    v_lshlrev_b32_e64 v80, 16, v19
    v_and_b32 v81, 0xffff0000, v19
    v_add_f32 v78, v78, v80
    v_add_f32 v79, v79, v81
    v_lshlrev_b32_e64 v80, 16, v20
    v_and_b32 v81, 0xffff0000, v20
    v_add_f32 v72, v72, v80
    v_add_f32 v73, v73, v81
    v_lshlrev_b32_e64 v80, 16, v21
    v_and_b32 v81, 0xffff0000, v21
    v_add_f32 v74, v74, v80
    v_add_f32 v75, v75, v81
    v_lshlrev_b32_e64 v80, 16, v22
    v_and_b32 v81, 0xffff0000, v22
    v_add_f32 v76, v76, v80
    v_add_f32 v77, v77, v81
    v_lshlrev_b32_e64 v80, 16, v23
    v_and_b32 v81, 0xffff0000, v23
    v_add_f32 v78, v78, v80
    v_add_f32 v79, v79, v81
    s_cmp_eq_u32 s64, 0
    s_cbranch_scc1 .nb_80
    s_barrier
    s_sub_u32 s64, s64, 1
.nb_80:
    s_or_b32 s31, s64, s88
    s_cbranch_scc1 .pr_81
    v_cvt_pk_bf16_f32 v136, v136, v137
    v_add_u32 v2, 150528, v153
    ds_write_b32 v2, v136
    s_waitcnt lgkmcnt(0)
    s_barrier
    s_mov_b32 s88, 1
.pr_81:
    s_waitcnt vmcnt(8)
    v_lshlrev_b32_e64 v80, 16, v24
    v_and_b32 v81, 0xffff0000, v24
    v_add_f32 v72, v72, v80
    v_add_f32 v73, v73, v81
    v_lshlrev_b32_e64 v80, 16, v25
    v_and_b32 v81, 0xffff0000, v25
    v_add_f32 v74, v74, v80
    v_add_f32 v75, v75, v81
    v_lshlrev_b32_e64 v80, 16, v26
    v_and_b32 v81, 0xffff0000, v26
    v_add_f32 v76, v76, v80
    v_add_f32 v77, v77, v81
    v_lshlrev_b32_e64 v80, 16, v27
    v_and_b32 v81, 0xffff0000, v27
    v_add_f32 v78, v78, v80
    v_add_f32 v79, v79, v81
    v_lshlrev_b32_e64 v80, 16, v28
    v_and_b32 v81, 0xffff0000, v28
    v_add_f32 v72, v72, v80
    v_add_f32 v73, v73, v81
    v_lshlrev_b32_e64 v80, 16, v29
    v_and_b32 v81, 0xffff0000, v29
    v_add_f32 v74, v74, v80
    v_add_f32 v75, v75, v81
    v_lshlrev_b32_e64 v80, 16, v30
    v_and_b32 v81, 0xffff0000, v30
    v_add_f32 v76, v76, v80
    v_add_f32 v77, v77, v81
    v_lshlrev_b32_e64 v80, 16, v31
    v_and_b32 v81, 0xffff0000, v31
    v_add_f32 v78, v78, v80
    v_add_f32 v79, v79, v81
    v_lshlrev_b32_e64 v80, 16, v32
    v_and_b32 v81, 0xffff0000, v32
    v_add_f32 v72, v72, v80
    v_add_f32 v73, v73, v81
    v_lshlrev_b32_e64 v80, 16, v33
    v_and_b32 v81, 0xffff0000, v33
    v_add_f32 v74, v74, v80
    v_add_f32 v75, v75, v81
    v_lshlrev_b32_e64 v80, 16, v34
    v_and_b32 v81, 0xffff0000, v34
    v_add_f32 v76, v76, v80
    v_add_f32 v77, v77, v81
    v_lshlrev_b32_e64 v80, 16, v35
    v_and_b32 v81, 0xffff0000, v35
    v_add_f32 v78, v78, v80
    v_add_f32 v79, v79, v81
    v_lshlrev_b32_e64 v80, 16, v36
    v_and_b32 v81, 0xffff0000, v36
    v_add_f32 v72, v72, v80
    v_add_f32 v73, v73, v81
    v_lshlrev_b32_e64 v80, 16, v37
    v_and_b32 v81, 0xffff0000, v37
    v_add_f32 v74, v74, v80
    v_add_f32 v75, v75, v81
    v_lshlrev_b32_e64 v80, 16, v38
    v_and_b32 v81, 0xffff0000, v38
    v_add_f32 v76, v76, v80
    v_add_f32 v77, v77, v81
    v_lshlrev_b32_e64 v80, 16, v39
    v_and_b32 v81, 0xffff0000, v39
    v_add_f32 v78, v78, v80
    v_add_f32 v79, v79, v81
    s_cmp_eq_u32 s64, 0
    s_cbranch_scc1 .nb_82
    s_barrier
    s_sub_u32 s64, s64, 1
.nb_82:
    s_or_b32 s31, s64, s88
    s_cbranch_scc1 .pr_83
    v_cvt_pk_bf16_f32 v136, v136, v137
    v_add_u32 v2, 150528, v153
    ds_write_b32 v2, v136
    s_waitcnt lgkmcnt(0)
    s_barrier
    s_mov_b32 s88, 1
.pr_83:
    s_waitcnt vmcnt(4)
    v_lshlrev_b32_e64 v80, 16, v40
    v_and_b32 v81, 0xffff0000, v40
    v_add_f32 v72, v72, v80
    v_add_f32 v73, v73, v81
    v_lshlrev_b32_e64 v80, 16, v41
    v_and_b32 v81, 0xffff0000, v41
    v_add_f32 v74, v74, v80
    v_add_f32 v75, v75, v81
    v_lshlrev_b32_e64 v80, 16, v42
    v_and_b32 v81, 0xffff0000, v42
    v_add_f32 v76, v76, v80
    v_add_f32 v77, v77, v81
    v_lshlrev_b32_e64 v80, 16, v43
    v_and_b32 v81, 0xffff0000, v43
    v_add_f32 v78, v78, v80
    v_add_f32 v79, v79, v81
    v_lshlrev_b32_e64 v80, 16, v44
    v_and_b32 v81, 0xffff0000, v44
    v_add_f32 v72, v72, v80
    v_add_f32 v73, v73, v81
    v_lshlrev_b32_e64 v80, 16, v45
    v_and_b32 v81, 0xffff0000, v45
    v_add_f32 v74, v74, v80
    v_add_f32 v75, v75, v81
    v_lshlrev_b32_e64 v80, 16, v46
    v_and_b32 v81, 0xffff0000, v46
    v_add_f32 v76, v76, v80
    v_add_f32 v77, v77, v81
    v_lshlrev_b32_e64 v80, 16, v47
    v_and_b32 v81, 0xffff0000, v47
    v_add_f32 v78, v78, v80
    v_add_f32 v79, v79, v81
    v_lshlrev_b32_e64 v80, 16, v48
    v_and_b32 v81, 0xffff0000, v48
    v_add_f32 v72, v72, v80
    v_add_f32 v73, v73, v81
    v_lshlrev_b32_e64 v80, 16, v49
    v_and_b32 v81, 0xffff0000, v49
    v_add_f32 v74, v74, v80
    v_add_f32 v75, v75, v81
    v_lshlrev_b32_e64 v80, 16, v50
    v_and_b32 v81, 0xffff0000, v50
    v_add_f32 v76, v76, v80
    v_add_f32 v77, v77, v81
    v_lshlrev_b32_e64 v80, 16, v51
    v_and_b32 v81, 0xffff0000, v51
    v_add_f32 v78, v78, v80
    v_add_f32 v79, v79, v81
    v_lshlrev_b32_e64 v80, 16, v52
    v_and_b32 v81, 0xffff0000, v52
    v_add_f32 v72, v72, v80
    v_add_f32 v73, v73, v81
    v_lshlrev_b32_e64 v80, 16, v53
    v_and_b32 v81, 0xffff0000, v53
    v_add_f32 v74, v74, v80
    v_add_f32 v75, v75, v81
    v_lshlrev_b32_e64 v80, 16, v54
    v_and_b32 v81, 0xffff0000, v54
    v_add_f32 v76, v76, v80
    v_add_f32 v77, v77, v81
    v_lshlrev_b32_e64 v80, 16, v55
    v_and_b32 v81, 0xffff0000, v55
    v_add_f32 v78, v78, v80
    v_add_f32 v79, v79, v81
    s_cmp_eq_u32 s64, 0
    s_cbranch_scc1 .nb_84
    s_barrier
    s_sub_u32 s64, s64, 1
.nb_84:
    s_or_b32 s31, s64, s88
    s_cbranch_scc1 .pr_85
    v_cvt_pk_bf16_f32 v136, v136, v137
    v_add_u32 v2, 150528, v153
    ds_write_b32 v2, v136
    s_waitcnt lgkmcnt(0)
    s_barrier
    s_mov_b32 s88, 1
.pr_85:
    s_waitcnt vmcnt(0)
    v_lshlrev_b32_e64 v80, 16, v56
    v_and_b32 v81, 0xffff0000, v56
    v_add_f32 v72, v72, v80
    v_add_f32 v73, v73, v81
    v_lshlrev_b32_e64 v80, 16, v57
    v_and_b32 v81, 0xffff0000, v57
    v_add_f32 v74, v74, v80
    v_add_f32 v75, v75, v81
    v_lshlrev_b32_e64 v80, 16, v58
    v_and_b32 v81, 0xffff0000, v58
    v_add_f32 v76, v76, v80
    v_add_f32 v77, v77, v81
    v_lshlrev_b32_e64 v80, 16, v59
    v_and_b32 v81, 0xffff0000, v59
    v_add_f32 v78, v78, v80
    v_add_f32 v79, v79, v81
    v_lshlrev_b32_e64 v80, 16, v60
    v_and_b32 v81, 0xffff0000, v60
    v_add_f32 v72, v72, v80
    v_add_f32 v73, v73, v81
    v_lshlrev_b32_e64 v80, 16, v61
    v_and_b32 v81, 0xffff0000, v61
    v_add_f32 v74, v74, v80
    v_add_f32 v75, v75, v81
    v_lshlrev_b32_e64 v80, 16, v62
    v_and_b32 v81, 0xffff0000, v62
    v_add_f32 v76, v76, v80
    v_add_f32 v77, v77, v81
    v_lshlrev_b32_e64 v80, 16, v63
    v_and_b32 v81, 0xffff0000, v63
    v_add_f32 v78, v78, v80
    v_add_f32 v79, v79, v81
    v_lshlrev_b32_e64 v80, 16, v64
    v_and_b32 v81, 0xffff0000, v64
    v_add_f32 v72, v72, v80
    v_add_f32 v73, v73, v81
    v_lshlrev_b32_e64 v80, 16, v65
    v_and_b32 v81, 0xffff0000, v65
    v_add_f32 v74, v74, v80
    v_add_f32 v75, v75, v81
    v_lshlrev_b32_e64 v80, 16, v66
    v_and_b32 v81, 0xffff0000, v66
    v_add_f32 v76, v76, v80
    v_add_f32 v77, v77, v81
    v_lshlrev_b32_e64 v80, 16, v67
    v_and_b32 v81, 0xffff0000, v67
    v_add_f32 v78, v78, v80
    v_add_f32 v79, v79, v81
    v_lshlrev_b32_e64 v80, 16, v68
    v_and_b32 v81, 0xffff0000, v68
    v_add_f32 v72, v72, v80
    v_add_f32 v73, v73, v81
    v_lshlrev_b32_e64 v80, 16, v69
    v_and_b32 v81, 0xffff0000, v69
    v_add_f32 v74, v74, v80
    v_add_f32 v75, v75, v81
    v_lshlrev_b32_e64 v80, 16, v70
    v_and_b32 v81, 0xffff0000, v70
    v_add_f32 v76, v76, v80
    v_add_f32 v77, v77, v81
    v_lshlrev_b32_e64 v80, 16, v71
    v_and_b32 v81, 0xffff0000, v71
    v_add_f32 v78, v78, v80
    v_add_f32 v79, v79, v81
    v_permlane32_swap_b32 v72, v76
    v_permlane32_swap_b32 v73, v77
    v_permlane32_swap_b32 v74, v78
    v_permlane32_swap_b32 v75, v79
    v_add_f32 v72, v72, v76
    v_add_f32 v73, v73, v77
    v_add_f32 v74, v74, v78
    v_add_f32 v75, v75, v79
    v_cvt_pk_bf16_f32 v8, v72, v73
    v_cvt_pk_bf16_f32 v9, v74, v75
    v_and_b32 v4, 31, v1
    v_lshrrev_b32 v5, 5, v1
    v_lshlrev_b32_e64 v4, 4, v4
    v_lshl_add_u32 v4, v5, 3, v4
    buffer_store_dwordx2 v[8:9], v4, s[68:71], 0 offen sc1
    s_setprio 2
    s_or_b32 s31, s64, s88
    s_cbranch_scc1 .pr_86
    v_cvt_pk_bf16_f32 v136, v136, v137
    v_add_u32 v2, 150528, v153
    ds_write_b32 v2, v136
    s_waitcnt lgkmcnt(0)
    s_barrier
    s_mov_b32 s88, 1
.pr_86:
    s_cmp_eq_u32 s64, 0
    s_cbranch_scc1 .nb_87
    s_barrier
    s_sub_u32 s64, s64, 1
.nb_87:
    s_or_b32 s31, s64, s88
    s_cbranch_scc1 .pr_88
    v_cvt_pk_bf16_f32 v136, v136, v137
    v_add_u32 v2, 150528, v153
    ds_write_b32 v2, v136
    s_waitcnt lgkmcnt(0)
    s_barrier
    s_mov_b32 s88, 1
.pr_88:
    s_cmp_eq_u32 s64, 0
    s_cbranch_scc1 .nb_89
    s_barrier
    s_sub_u32 s64, s64, 1
.nb_89:
    s_or_b32 s31, s64, s88
    s_cbranch_scc1 .pr_90
    v_cvt_pk_bf16_f32 v136, v136, v137
    v_add_u32 v2, 150528, v153
    ds_write_b32 v2, v136
    s_waitcnt lgkmcnt(0)
    s_barrier
    s_mov_b32 s88, 1
.pr_90:
    s_waitcnt vmcnt(0)
    s_lshl_b32 s28, s34, 11
    s_atomic_add s40, s[52:53], s28 offset:229376
    s_atomic_add s40, s[52:53], s28 offset:229504
    s_atomic_add s40, s[52:53], s28 offset:229632
    s_atomic_add s40, s[52:53], s28 offset:229760
.dr_91:
    s_cmp_eq_u32 s64, 0
    s_cbranch_scc1 .dd_92
    s_barrier
    s_sub_u32 s64, s64, 1
    s_branch .dr_91
.dd_92:
    s_or_b32 s31, s64, s88
    s_cbranch_scc1 .pr_93
    v_cvt_pk_bf16_f32 v136, v136, v137
    v_add_u32 v2, 150528, v153
    ds_write_b32 v2, v136
    s_waitcnt lgkmcnt(0)
    s_barrier
    s_mov_b32 s88, 1
.pr_93:
    s_and_b32 s28, s33, 3
    s_lshl4_add_u32 s28, s34, s28
    s_lshl_b32 s28, s28, 7
.poll_94:
    s_load_dword s42, s[52:53], s28 offset:229376 glc
    s_sub_u32 s38, s38, 1
    s_waitcnt lgkmcnt(0)
    s_cbranch_scc1 .pdone_95
    s_cmp_lt_u32 s42, 16
    s_cbranch_scc1 .poll_94
.pdone_95:
    s_max_i32 s38, s38, 0
    s_lshl_b32 s28, s34, 13
    s_add_u32 s70, s28, 33554432
    s_add_u32 s68, s26, s70
    s_addc_u32 s69, s27, 0
    s_mov_b32 s70, 8192
    s_mov_b32 s71, 0x20000
    v_lshlrev_b32_e64 v4, 4, v1
    s_mov_b32 m0, 151552
    s_nop 0
    s_mov_b32 s28, 0
    buffer_load_dwordx4 v4, s[68:71], s28 offen offset:0 sc1 lds
    buffer_load_dwordx4 v4, s[68:71], s28 offen offset:1024 sc1 lds
    buffer_load_dwordx4 v4, s[68:71], s28 offen offset:2048 sc1 lds
    buffer_load_dwordx4 v4, s[68:71], s28 offen offset:3072 sc1 lds
    s_mov_b32 m0, 155648
    s_mov_b32 s28, 4096
    buffer_load_dwordx4 v4, s[68:71], s28 offen offset:0 sc1 lds
    buffer_load_dwordx4 v4, s[68:71], s28 offen offset:1024 sc1 lds
    buffer_load_dwordx4 v4, s[68:71], s28 offen offset:2048 sc1 lds
    buffer_load_dwordx4 v4, s[68:71], s28 offen offset:3072 sc1 lds
    s_waitcnt vmcnt(0)
    s_waitcnt lgkmcnt(0)
    s_barrier
    s_mov_b32 s64, 19
.dr_96:
    s_cmp_eq_u32 s64, 0
    s_cbranch_scc1 .dd_97
    s_barrier
    s_sub_u32 s64, s64, 1
    s_branch .dr_96
.dd_97:
    s_cmp_ge_u32 s35, 14
    s_cbranch_scc1 .helper_job
    s_sub_u32 s28, s33, s36
    s_and_b32 s28, s28, 3
    s_and_b32 s89, s33, 4
    s_add_u32 s28, s28, s89
    s_lshl_b32 s28, s28, 2
    s_lshr_b32 s89, 0x54321000, s28
    s_and_b32 s89, s89, 15
    s_cmp_ge_u32 s89, 5
    s_cselect_b32 s28, 5, 0
    s_sub_u32 s28, s89, s28
    s_lshl_b32 s28, s28, 14
    s_add_u32 s28, s28, 65536
    v_lshrrev_b32 v2, 2, v1
    v_bfe_u32 v3, v2, 1, 2
    v_lshlrev_b32_e64 v2, 7, v2
    v_lshl_add_u32 v2, v3, 5, v2
    v_and_b32_e64 v3, 3, v1
    v_lshl_add_u32 v2, v3, 3, v2
    v_add_u32 v16, s28, v2
    v_xor_b32 v17, 32, v16
    v_xor_b32_e64 v18, 64, v16
    v_xor_b32 v19, 96, v16
    v_mov_b32 v20, 0x3f803f80
    v_mov_b32 v21, 0x3f803f80
    v_mov_b32 v22, 0x3f803f80
    v_mov_b32 v23, 0x3f803f80
    s_add_u32 s64, s89, 1
.dr_98:
    s_cmp_eq_u32 s64, 0
    s_cbranch_scc1 .dd_99
    s_barrier
    s_sub_u32 s64, s64, 1
    s_branch .dr_98
.dd_99:
    s_nop 0
    s_sub_u32 s64, 15, s89
    ds_read_b64_tr_b16 v[24:25], v16 offset:0
    ds_read_b64_tr_b16 v[26:27], v16 offset:2048
    ds_read_b64_tr_b16 v[28:29], v16 offset:4096
    ds_read_b64_tr_b16 v[30:31], v16 offset:6144
    ds_read_b64_tr_b16 v[32:33], v17 offset:0
    ds_read_b64_tr_b16 v[34:35], v17 offset:2048
    ds_read_b64_tr_b16 v[36:37], v17 offset:4096
    ds_read_b64_tr_b16 v[38:39], v17 offset:6144
    ds_read_b64_tr_b16 v[40:41], v18 offset:0
    ds_read_b64_tr_b16 v[42:43], v18 offset:2048
    ds_read_b64_tr_b16 v[44:45], v18 offset:4096
    ds_read_b64_tr_b16 v[46:47], v18 offset:6144
    ds_read_b64_tr_b16 v[48:49], v19 offset:0
    ds_read_b64_tr_b16 v[50:51], v19 offset:2048
    ds_read_b64_tr_b16 v[52:53], v19 offset:4096
    ds_read_b64_tr_b16 v[54:55], v19 offset:6144
    ds_read_b64_tr_b16 v[56:57], v16 offset:8192
    ds_read_b64_tr_b16 v[58:59], v16 offset:10240
    ds_read_b64_tr_b16 v[60:61], v16 offset:12288
    ds_read_b64_tr_b16 v[62:63], v16 offset:14336
    ds_read_b64_tr_b16 v[64:65], v17 offset:8192
    ds_read_b64_tr_b16 v[66:67], v17 offset:10240
    ds_read_b64_tr_b16 v[68:69], v17 offset:12288
    ds_read_b64_tr_b16 v[70:71], v17 offset:14336
    ds_read_b64_tr_b16 v[72:73], v18 offset:8192
    ds_read_b64_tr_b16 v[74:75], v18 offset:10240
    ds_read_b64_tr_b16 v[76:77], v18 offset:12288
    ds_read_b64_tr_b16 v[78:79], v18 offset:14336
    ds_read_b64_tr_b16 v[80:81], v19 offset:8192
    ds_read_b64_tr_b16 v[82:83], v19 offset:10240
    ds_read_b64_tr_b16 v[84:85], v19 offset:12288
    ds_read_b64_tr_b16 v[86:87], v19 offset:14336
    s_waitcnt lgkmcnt(0)
    s_cmp_eq_u32 s64, 0
    s_cbranch_scc1 .nb_100
    s_barrier
    s_sub_u32 s64, s64, 1
.nb_100:
    v_mfma_f32_16x16x32_bf16 v[88:91], v[20:23], v[24:27], 0
    v_mfma_f32_16x16x32_bf16 v[88:91], v[20:23], v[28:31], v[88:91]
    v_mfma_f32_16x16x32_bf16 v[92:95], v[20:23], v[32:35], 0
    v_mfma_f32_16x16x32_bf16 v[92:95], v[20:23], v[36:39], v[92:95]
    v_mfma_f32_16x16x32_bf16 v[96:99], v[20:23], v[40:43], 0
    v_mfma_f32_16x16x32_bf16 v[96:99], v[20:23], v[44:47], v[96:99]
    v_mfma_f32_16x16x32_bf16 v[100:103], v[20:23], v[48:51], 0
    v_mfma_f32_16x16x32_bf16 v[100:103], v[20:23], v[52:55], v[100:103]
    v_mfma_f32_16x16x32_bf16 v[104:107], v[20:23], v[56:59], 0
    v_mfma_f32_16x16x32_bf16 v[104:107], v[20:23], v[60:63], v[104:107]
    v_mfma_f32_16x16x32_bf16 v[108:111], v[20:23], v[64:67], 0
    v_mfma_f32_16x16x32_bf16 v[108:111], v[20:23], v[68:71], v[108:111]
    v_mfma_f32_16x16x32_bf16 v[112:115], v[20:23], v[72:75], 0
    v_mfma_f32_16x16x32_bf16 v[112:115], v[20:23], v[76:79], v[112:115]
    v_mfma_f32_16x16x32_bf16 v[116:119], v[20:23], v[80:83], 0
    v_mfma_f32_16x16x32_bf16 v[116:119], v[20:23], v[84:87], v[116:119]
    s_cmp_eq_u32 s64, 0
    s_cbranch_scc1 .nb_101
    s_barrier
    s_sub_u32 s64, s64, 1
.nb_101:
    v_cmp_le_u32 vcc, 16, v1
    s_nop 1
    v_cndmask_b32 v88, v88, v92, vcc
    v_cndmask_b32 v104, v104, v108, vcc
    v_cmp_le_u32 vcc, 32, v1
    s_nop 1
    v_cndmask_b32 v88, v88, v96, vcc
    v_cndmask_b32 v104, v104, v112, vcc
    v_cmp_le_u32 vcc, 48, v1
    s_nop 1
    v_cndmask_b32 v88, v88, v100, vcc
    v_cndmask_b32 v104, v104, v116, vcc
    s_lshl_b32 s28, s35, 9
    s_add_u32 s28, s28, 48128
    buffer_atomic_add_f32 v88, v153, s[60:63], s28 offen offset:0 sc1
    buffer_atomic_add_f32 v104, v153, s[60:63], s28 offen offset:256 sc1
    s_cmp_eq_u32 s64, 0
    s_cbranch_scc1 .nb_102
    s_barrier
    s_sub_u32 s64, s64, 1
.nb_102:
    s_cmp_eq_u32 s64, 0
    s_cbranch_scc1 .nb_103
    s_barrier
    s_sub_u32 s64, s64, 1
.nb_103:
    s_waitcnt vmcnt(0)
    s_lshl_b32 s28, s35, 11
    s_atomic_add s40, s[52:53], s28 offset:262144
    s_atomic_add s40, s[52:53], s28 offset:262272
    s_atomic_add s40, s[52:53], s28 offset:262400
    s_atomic_add s40, s[52:53], s28 offset:262528
    s_and_b32 s28, s34, 3
    s_lshl4_add_u32 s28, s33, s28
    s_lshl_b32 s28, s28, 7
.poll_104:
    s_load_dword s42, s[52:53], s28 offset:0 glc
    s_cmp_eq_u32 s64, 0
    s_cbranch_scc1 .nb_106
    s_barrier
    s_sub_u32 s64, s64, 1
.nb_106:
    s_sub_u32 s38, s38, 1
    s_waitcnt lgkmcnt(0)
    s_cbranch_scc1 .pdone_105
    s_cmp_lt_u32 s42, 32
    s_cbranch_scc1 .poll_104
.pdone_105:
    s_max_i32 s38, s38, 0
    s_and_b32 s28, s33, 3
    s_lshl4_add_u32 s28, s35, s28
    s_lshl_b32 s28, s28, 7
.poll_107:
    s_load_dword s42, s[52:53], s28 offset:262144 glc
    s_cmp_eq_u32 s64, 0
    s_cbranch_scc1 .nb_109
    s_barrier
    s_sub_u32 s64, s64, 1
.nb_109:
    s_sub_u32 s38, s38, 1
    s_waitcnt lgkmcnt(0)
    s_cbranch_scc1 .pdone_108
    s_cmp_lt_u32 s42, 16
    s_cbranch_scc1 .poll_107
.pdone_108:
    s_max_i32 s38, s38, 0
    s_mov_b32 s31, .code_c3-sequential_preLN__linear_kernel_hedgehog__mixer_gmlp__prompt_kernel
    s_and_b32 s31, s31, 0xfff80
    s_load_dwordx2 s[78:79], s[76:77], s31 offset:60
    s_load_dwordx2 s[78:79], s[76:77], s31 offset:188
    s_load_dwordx2 s[78:79], s[76:77], s31 offset:316
    s_load_dwordx2 s[78:79], s[76:77], s31 offset:444
.w4_110:
    s_cmp_le_u32 s64, 2
    s_cbranch_scc1 .w4d_111
    s_cmp_eq_u32 s64, 0
    s_cbranch_scc1 .nb_112
    s_barrier
    s_sub_u32 s64, s64, 1
.nb_112:
    s_branch .w4_110
.w4d_111:
    v_lshlrev_b32 v4, 3, v1
    s_lshl_b32 s28, s33, 10
    buffer_load_dwordx2 v[8:9], v4, s[60:63], s28 offen offset:0 sc1
    buffer_load_dwordx2 v[10:11], v4, s[60:63], s28 offen offset:512 sc1
    v_lshlrev_b32 v4, 2, v1
    s_lshl_b32 s28, s35, 9
    s_add_u32 s28, s28, 48128
    s_mov_b32 m0, 148480
    s_nop 0
    buffer_load_dword v4, s[60:63], s28 offen offset:0 sc1 lds
    buffer_load_dword v4, s[60:63], s28 offen offset:256 sc1 lds
    s_cmp_eq_u32 s64, 0
    s_cbranch_scc1 .nb_113
    s_barrier
    s_sub_u32 s64, s64, 1
.nb_113:
    s_waitcnt vmcnt(2)
    v_mul_f32 v8, 0xba800000, v8
    v_mul_f32 v10, 0x3a800000, v10
    v_fma_f32 v10, -v8, v8, v10
    v_max_f32 v10, 0, v10
    v_add_f32 v10, 0x3727c5ac, v10
    v_rsq_f32 v139, v10
    v_mov_b32 v137, v8
    v_mul_f32 v136, v10, v139
    v_mul_f32 v138, v139, v139
    v_mul_f32 v139, 0xc0135761, v139
    v_mul_f32 v138, 0x3d372713, v138
    v_mul_f32_e64 v138, v138, v139
    v_mul_f32 v9, 0xba800000, v9
    v_mul_f32 v11, 0x3a800000, v11
    v_fma_f32 v11, -v9, v9, v11
    v_max_f32_e64 v11, 0, v11
    v_add_f32 v11, 0x3727c5ac, v11
    v_rsq_f32 v143, v11
    v_mov_b32 v141, v9
    v_mul_f32 v140, v11, v143
    v_mul_f32 v142, v143, v143
    v_mul_f32 v143, 0xc0135761, v143
    v_mul_f32 v142, 0x3d372713, v142
    v_mul_f32 v142, v142, v143
.dr_114:
    s_cmp_eq_u32 s64, 0
    s_cbranch_scc1 .dd_115
    s_barrier
    s_sub_u32 s64, s64, 1
    s_branch .dr_114
.dd_115:
    v_lshlrev_b32_e64 v4, 5, v1
    v_add_u32 v4, 151552, v4
    ds_write_b128 v4, v[136:139] offset:0
    ds_write_b128 v4, v[140:143] offset:16
    s_waitcnt vmcnt(0)
    s_waitcnt lgkmcnt(0)
    s_barrier
    s_mov_b32 s64, 3
.dr_116:
    s_cmp_eq_u32 s64, 0
    s_cbranch_scc1 .dd_117
    s_barrier
    s_sub_u32 s64, s64, 1
    s_branch .dr_116
.dd_117:
    s_lshl_b32 s28, s33, 11
    s_atomic_add s40, s[52:53], s28 offset:98304
    s_atomic_add s40, s[52:53], s28 offset:98432
    s_atomic_add s40, s[52:53], s28 offset:98560
    s_atomic_add s40, s[52:53], s28 offset:98688
    s_mov_b32 s64, 5
    s_cmp_eq_u32 s64, 0
    s_cbranch_scc1 .nb_118
    s_barrier
    s_branch .pg_16
.p2align 12
.pad_16:
    s_nop 0
    s_setpc_b64 s[44:45]
.pg_16:
    s_sub_u32 s64, s64, 1
.nb_118:
    s_and_b32 s28, s34, 3
    s_lshl4_add_u32 s28, s33, s28
    s_lshl_b32 s28, s28, 7
.poll_119:
    s_load_dword s42, s[52:53], s28 offset:98304 glc
    s_cmp_eq_u32 s64, 0
    s_cbranch_scc1 .nb_121
    s_barrier
    s_sub_u32 s64, s64, 1
.nb_121:
    s_sub_u32 s38, s38, 1
    s_waitcnt lgkmcnt(0)
    s_cbranch_scc1 .pdone_120
    s_cmp_lt_u32 s42, 14
    s_cbranch_scc1 .poll_119
.pdone_120:
    s_max_i32 s38, s38, 0
    v_lshlrev_b32 v4, 4, v1
    s_lshl_b32 s28, s33, 10
    s_add_u32 s28, s28, 16384
    s_mov_b32 m0, 149504
    s_nop 0
    buffer_load_dwordx4 v4, s[60:63], s28 offen sc1 lds
.dr_122:
    s_cmp_eq_u32 s64, 0
    s_cbranch_scc1 .dd_123
    s_barrier
    s_sub_u32 s64, s64, 1
    s_branch .dr_122
.dd_123:
    s_waitcnt vmcnt(0)
    s_barrier
    s_mov_b32 s64, 4
.dr_124:
    s_cmp_eq_u32 s64, 0
    s_cbranch_scc1 .dd_125
    s_barrier
    s_sub_u32 s64, s64, 1
    s_branch .dr_124
.dd_125:
    s_nop 0
    s_lshl_b32 s28, s35, 11
    s_atomic_add s40, s[52:53], s28 offset:327680
    s_atomic_add s40, s[52:53], s28 offset:327808
    s_atomic_add s40, s[52:53], s28 offset:327936
    s_atomic_add s40, s[52:53], s28 offset:328064
    s_mov_b32 s31, .code_c4-sequential_preLN__linear_kernel_hedgehog__mixer_gmlp__prompt_kernel
    s_and_b32 s31, s31, 0xfff80
    s_load_dwordx2 s[78:79], s[76:77], s31 offset:60
    s_load_dwordx2 s[78:79], s[76:77], s31 offset:188
    s_load_dwordx2 s[78:79], s[76:77], s31 offset:316
    s_load_dwordx2 s[78:79], s[76:77], s31 offset:444
    s_mov_b32 s64, 3
    s_and_b32 s28, s33, 3
    s_lshl4_add_u32 s28, s35, s28
    s_lshl_b32 s28, s28, 7
.poll_126:
    s_load_dword s42, s[52:53], s28 offset:294912 glc
    s_cmp_eq_u32 s64, 0
    s_cbranch_scc1 .nb_128
    s_barrier
    s_sub_u32 s64, s64, 1
.nb_128:
    s_sub_u32 s38, s38, 1
    s_waitcnt lgkmcnt(0)
    s_cbranch_scc1 .pdone_127
    s_cmp_lt_u32 s42, 32
    s_cbranch_scc1 .poll_126
.pdone_127:
    s_max_i32 s38, s38, 0
.w4_129:
    s_cmp_le_u32 s64, 2
    s_cbranch_scc1 .w4d_130
    s_cmp_eq_u32 s64, 0
    s_cbranch_scc1 .nb_131
    s_barrier
    s_sub_u32 s64, s64, 1
.nb_131:
    s_branch .w4_129
.w4d_130:
    v_lshlrev_b32 v4, 2, v1
    s_lshl_b32 s28, s35, 9
    s_add_u32 s28, s28, 40960
    s_mov_b32 m0, 148992
    s_nop 0
    buffer_load_dword v4, s[60:63], s28 offen offset:0 sc1 lds
    buffer_load_dword v4, s[60:63], s28 offen offset:256 sc1 lds
.dr_132:
    s_cmp_eq_u32 s64, 0
    s_cbranch_scc1 .dd_133
    s_barrier
    s_sub_u32 s64, s64, 1
    s_branch .dr_132
.dd_133:
    s_waitcnt vmcnt(0)
    s_barrier
    s_mov_b32 s64, 34
.w4_134:
    s_cmp_le_u32 s64, 7
    s_cbranch_scc1 .w4d_135
    s_cmp_eq_u32 s64, 0
    s_cbranch_scc1 .nb_136
    s_barrier
    s_sub_u32 s64, s64, 1
.nb_136:
    s_branch .w4_134
    s_nop 0
.w4d_135:
    s_mov_b32 s31, .code_c5-sequential_preLN__linear_kernel_hedgehog__mixer_gmlp__prompt_kernel
    s_and_b32 s31, s31, 0xfff80
    s_load_dwordx2 s[78:79], s[76:77], s31 offset:60
    s_load_dwordx2 s[78:79], s[76:77], s31 offset:188
    s_load_dwordx2 s[78:79], s[76:77], s31 offset:316
    s_load_dwordx2 s[78:79], s[76:77], s31 offset:444
.dr_137:
    s_cmp_eq_u32 s64, 0
    s_cbranch_scc1 .dd_138
    s_barrier
    s_sub_u32 s64, s64, 1
    s_branch .dr_137
.dd_138:
.hret_139:
    s_mov_b32 s64, 29
.dr_140:
    s_cmp_eq_u32 s64, 0
    s_cbranch_scc1 .dd_141
    s_barrier
    s_sub_u32 s64, s64, 1
    s_branch .dr_140
.dd_141:
    s_endpgm
.pad_17:
    s_nop 0
    s_setpc_b64 s[44:45]
.helper_job:
    s_lshl1_add_u32 s96, s33, s39
    s_mov_b64 s[56:57], s[14:15]
    s_mov_b32 s58, 7340032
    s_mov_b32 s59, 0x20000
    s_lshr_b32 s28, s96, 2
    s_lshl3_add_u32 s28, s28, s32
    s_mul_i32 s28, s28, 114688
    s_and_b32 s29, s96, 3
    s_mul_i32 s30, s29, 896
    s_add_u32 s28, s28, s30
    v_lshl_add_u32 v122, v1, 4, s28
    v_mov_b32 v123, 0x7ffffff0
    v_cmp_gt_u32 vcc, 56, v1
    s_nop 1
    v_cndmask_b32_e64 v122, v123, v122, vcc
    v_lshl_add_u32 v124, s32, 6, v1
    v_lshlrev_b32 v123, 5, v124
    s_waitcnt lgkmcnt(0)
    s_barrier
    s_mov_b32 s28, 0
    buffer_load_dwordx4 v[48:51], v122, s[56:59], s28 offen
    s_add_u32 s28, s28, 7168
    buffer_load_dwordx4 v[52:55], v122, s[56:59], s28 offen
    s_add_u32 s28, s28, 7168
    buffer_load_dwordx4 v[56:59], v122, s[56:59], s28 offen
    s_add_u32 s28, s28, 7168
    buffer_load_dwordx4 v[60:63], v122, s[56:59], s28 offen
    s_add_u32 s28, s28, 7168
    buffer_load_dwordx4 v[64:67], v122, s[56:59], s28 offen
    s_add_u32 s28, s28, 7168
    buffer_load_dwordx4 v[68:71], v122, s[56:59], s28 offen
    s_add_u32 s28, s28, 7168
    buffer_load_dwordx4 v[72:75], v122, s[56:59], s28 offen
    s_add_u32 s28, s28, 7168
    buffer_load_dwordx4 v[76:79], v122, s[56:59], s28 offen
    s_add_u32 s28, s28, 7168
    buffer_load_dwordx4 v[80:83], v122, s[56:59], s28 offen
    s_add_u32 s28, s28, 7168
    buffer_load_dwordx4 v[84:87], v122, s[56:59], s28 offen
    s_add_u32 s28, s28, 7168
    buffer_load_dwordx4 v[88:91], v122, s[56:59], s28 offen
    s_add_u32 s28, s28, 7168
    buffer_load_dwordx4 v[92:95], v122, s[56:59], s28 offen
    s_add_u32 s28, s28, 7168
    buffer_load_dwordx4 v[96:99], v122, s[56:59], s28 offen
    s_add_u32 s28, s28, 7168
    buffer_load_dwordx4 v[100:103], v122, s[56:59], s28 offen
    s_add_u32 s28, s28, 7168
    buffer_load_dwordx4 v[104:107], v122, s[56:59], s28 offen
    s_add_u32 s28, s28, 7168
    buffer_load_dwordx4 v[108:111], v122, s[56:59], s28 offen
    s_waitcnt vmcnt(12)
    v_lshlrev_b32 v112, 16, v48
    v_and_b32 v113, 0xffff0000, v48
    v_lshlrev_b32_e64 v114, 16, v49
    v_and_b32 v115, 0xffff0000, v49
    v_lshlrev_b32_e64 v116, 16, v50
    v_and_b32 v117, 0xffff0000, v50
    v_lshlrev_b32_e64 v118, 16, v51
    v_and_b32 v119, 0xffff0000, v51
    v_lshlrev_b32_e64 v120, 16, v52
    v_and_b32 v121, 0xffff0000, v52
    v_pk_add_f32 v[112:113], v[112:113], v[120:121]
    v_lshlrev_b32_e64 v120, 16, v53
    v_and_b32 v121, 0xffff0000, v53
    v_pk_add_f32 v[114:115], v[114:115], v[120:121]
    v_lshlrev_b32_e64 v120, 16, v54
    v_and_b32 v121, 0xffff0000, v54
    v_pk_add_f32 v[116:117], v[116:117], v[120:121]
    v_lshlrev_b32_e64 v120, 16, v55
    v_and_b32 v121, 0xffff0000, v55
    v_pk_add_f32 v[118:119], v[118:119], v[120:121]
    v_lshlrev_b32_e64 v120, 16, v56
    v_and_b32 v121, 0xffff0000, v56
    v_pk_add_f32 v[112:113], v[112:113], v[120:121]
    v_lshlrev_b32_e64 v120, 16, v57
    v_and_b32 v121, 0xffff0000, v57
    v_pk_add_f32 v[114:115], v[114:115], v[120:121]
    v_lshlrev_b32_e64 v120, 16, v58
    v_and_b32 v121, 0xffff0000, v58
    v_pk_add_f32 v[116:117], v[116:117], v[120:121]
    v_lshlrev_b32_e64 v120, 16, v59
    v_and_b32 v121, 0xffff0000, v59
    v_pk_add_f32 v[118:119], v[118:119], v[120:121]
    v_lshlrev_b32_e64 v120, 16, v60
    v_and_b32 v121, 0xffff0000, v60
    v_pk_add_f32 v[112:113], v[112:113], v[120:121]
    v_lshlrev_b32_e64 v120, 16, v61
    v_and_b32 v121, 0xffff0000, v61
    v_pk_add_f32 v[114:115], v[114:115], v[120:121]
    v_lshlrev_b32_e64 v120, 16, v62
    v_and_b32 v121, 0xffff0000, v62
    v_pk_add_f32 v[116:117], v[116:117], v[120:121]
    v_lshlrev_b32_e64 v120, 16, v63
    v_and_b32 v121, 0xffff0000, v63
    v_pk_add_f32 v[118:119], v[118:119], v[120:121]
    s_waitcnt vmcnt(8)
    v_lshlrev_b32 v120, 16, v64
    v_and_b32 v121, 0xffff0000, v64
    v_pk_add_f32 v[112:113], v[112:113], v[120:121]
    v_lshlrev_b32_e64 v120, 16, v65
    v_and_b32 v121, 0xffff0000, v65
    v_pk_add_f32 v[114:115], v[114:115], v[120:121]
    v_lshlrev_b32_e64 v120, 16, v66
    v_and_b32 v121, 0xffff0000, v66
    v_pk_add_f32 v[116:117], v[116:117], v[120:121]
    v_lshlrev_b32_e64 v120, 16, v67
    v_and_b32 v121, 0xffff0000, v67
    v_pk_add_f32 v[118:119], v[118:119], v[120:121]
    v_lshlrev_b32_e64 v120, 16, v68
    v_and_b32 v121, 0xffff0000, v68
    v_pk_add_f32 v[112:113], v[112:113], v[120:121]
    v_lshlrev_b32_e64 v120, 16, v69
    v_and_b32 v121, 0xffff0000, v69
    v_pk_add_f32 v[114:115], v[114:115], v[120:121]
    v_lshlrev_b32_e64 v120, 16, v70
    v_and_b32 v121, 0xffff0000, v70
    v_pk_add_f32 v[116:117], v[116:117], v[120:121]
    v_lshlrev_b32_e64 v120, 16, v71
    v_and_b32 v121, 0xffff0000, v71
    v_pk_add_f32 v[118:119], v[118:119], v[120:121]
    v_lshlrev_b32_e64 v120, 16, v72
    v_and_b32 v121, 0xffff0000, v72
    v_pk_add_f32 v[112:113], v[112:113], v[120:121]
    v_lshlrev_b32_e64 v120, 16, v73
    v_and_b32 v121, 0xffff0000, v73
    v_pk_add_f32 v[114:115], v[114:115], v[120:121]
    v_lshlrev_b32_e64 v120, 16, v74
    v_and_b32 v121, 0xffff0000, v74
    v_pk_add_f32 v[116:117], v[116:117], v[120:121]
    v_lshlrev_b32_e64 v120, 16, v75
    v_and_b32 v121, 0xffff0000, v75
    v_pk_add_f32 v[118:119], v[118:119], v[120:121]
    v_lshlrev_b32_e64 v120, 16, v76
    v_and_b32 v121, 0xffff0000, v76
    v_pk_add_f32 v[112:113], v[112:113], v[120:121]
    v_lshlrev_b32_e64 v120, 16, v77
    v_and_b32 v121, 0xffff0000, v77
    v_pk_add_f32 v[114:115], v[114:115], v[120:121]
    v_lshlrev_b32_e64 v120, 16, v78
    v_and_b32 v121, 0xffff0000, v78
    v_pk_add_f32 v[116:117], v[116:117], v[120:121]
    v_lshlrev_b32_e64 v120, 16, v79
    v_and_b32 v121, 0xffff0000, v79
    v_pk_add_f32 v[118:119], v[118:119], v[120:121]
    s_waitcnt vmcnt(4)
    v_lshlrev_b32 v120, 16, v80
    v_and_b32 v121, 0xffff0000, v80
    v_pk_add_f32 v[112:113], v[112:113], v[120:121]
    v_lshlrev_b32_e64 v120, 16, v81
    v_and_b32 v121, 0xffff0000, v81
    v_pk_add_f32 v[114:115], v[114:115], v[120:121]
    v_lshlrev_b32_e64 v120, 16, v82
    v_and_b32 v121, 0xffff0000, v82
    v_pk_add_f32 v[116:117], v[116:117], v[120:121]
    v_lshlrev_b32_e64 v120, 16, v83
    v_and_b32 v121, 0xffff0000, v83
    v_pk_add_f32 v[118:119], v[118:119], v[120:121]
    v_lshlrev_b32_e64 v120, 16, v84
    v_and_b32 v121, 0xffff0000, v84
    v_pk_add_f32 v[112:113], v[112:113], v[120:121]
    v_lshlrev_b32_e64 v120, 16, v85
    v_and_b32 v121, 0xffff0000, v85
    v_pk_add_f32 v[114:115], v[114:115], v[120:121]
    v_lshlrev_b32_e64 v120, 16, v86
    v_and_b32 v121, 0xffff0000, v86
    v_pk_add_f32 v[116:117], v[116:117], v[120:121]
    v_lshlrev_b32_e64 v120, 16, v87
    v_and_b32 v121, 0xffff0000, v87
    v_pk_add_f32 v[118:119], v[118:119], v[120:121]
    v_lshlrev_b32_e64 v120, 16, v88
    v_and_b32 v121, 0xffff0000, v88
    v_pk_add_f32 v[112:113], v[112:113], v[120:121]
    v_lshlrev_b32_e64 v120, 16, v89
    v_and_b32 v121, 0xffff0000, v89
    v_pk_add_f32 v[114:115], v[114:115], v[120:121]
    v_lshlrev_b32_e64 v120, 16, v90
    v_and_b32 v121, 0xffff0000, v90
    v_pk_add_f32 v[116:117], v[116:117], v[120:121]
    v_lshlrev_b32_e64 v120, 16, v91
    v_and_b32 v121, 0xffff0000, v91
    v_pk_add_f32 v[118:119], v[118:119], v[120:121]
    v_lshlrev_b32_e64 v120, 16, v92
    v_and_b32 v121, 0xffff0000, v92
    v_pk_add_f32 v[112:113], v[112:113], v[120:121]
    v_lshlrev_b32_e64 v120, 16, v93
    v_and_b32 v121, 0xffff0000, v93
    v_pk_add_f32 v[114:115], v[114:115], v[120:121]
    v_lshlrev_b32_e64 v120, 16, v94
    v_and_b32 v121, 0xffff0000, v94
    v_pk_add_f32 v[116:117], v[116:117], v[120:121]
    v_lshlrev_b32_e64 v120, 16, v95
    v_and_b32 v121, 0xffff0000, v95
    v_pk_add_f32 v[118:119], v[118:119], v[120:121]
    s_waitcnt vmcnt(0)
    v_lshlrev_b32 v120, 16, v96
    v_and_b32 v121, 0xffff0000, v96
    v_pk_add_f32 v[112:113], v[112:113], v[120:121]
    v_lshlrev_b32_e64 v120, 16, v97
    v_and_b32 v121, 0xffff0000, v97
    v_pk_add_f32 v[114:115], v[114:115], v[120:121]
    v_lshlrev_b32_e64 v120, 16, v98
    v_and_b32 v121, 0xffff0000, v98
    v_pk_add_f32 v[116:117], v[116:117], v[120:121]
    v_lshlrev_b32_e64 v120, 16, v99
    v_and_b32 v121, 0xffff0000, v99
    v_pk_add_f32 v[118:119], v[118:119], v[120:121]
    v_lshlrev_b32_e64 v120, 16, v100
    v_and_b32 v121, 0xffff0000, v100
    v_pk_add_f32 v[112:113], v[112:113], v[120:121]
    v_lshlrev_b32_e64 v120, 16, v101
    v_and_b32 v121, 0xffff0000, v101
    v_pk_add_f32 v[114:115], v[114:115], v[120:121]
    v_lshlrev_b32_e64 v120, 16, v102
    v_and_b32 v121, 0xffff0000, v102
    v_pk_add_f32 v[116:117], v[116:117], v[120:121]
    v_lshlrev_b32_e64 v120, 16, v103
    v_and_b32 v121, 0xffff0000, v103
    v_pk_add_f32 v[118:119], v[118:119], v[120:121]
    v_lshlrev_b32_e64 v120, 16, v104
    v_and_b32 v121, 0xffff0000, v104
    v_pk_add_f32 v[112:113], v[112:113], v[120:121]
    v_lshlrev_b32_e64 v120, 16, v105
    v_and_b32 v121, 0xffff0000, v105
    v_pk_add_f32 v[114:115], v[114:115], v[120:121]
    v_lshlrev_b32_e64 v120, 16, v106
    v_and_b32 v121, 0xffff0000, v106
    v_pk_add_f32 v[116:117], v[116:117], v[120:121]
    v_lshlrev_b32_e64 v120, 16, v107
    v_and_b32 v121, 0xffff0000, v107
    v_pk_add_f32 v[118:119], v[118:119], v[120:121]
    v_lshlrev_b32_e64 v120, 16, v108
    v_and_b32 v121, 0xffff0000, v108
    v_pk_add_f32 v[112:113], v[112:113], v[120:121]
    v_lshlrev_b32_e64 v120, 16, v109
    v_and_b32 v121, 0xffff0000, v109
    v_pk_add_f32 v[114:115], v[114:115], v[120:121]
    v_lshlrev_b32_e64 v120, 16, v110
    v_and_b32 v121, 0xffff0000, v110
    v_pk_add_f32 v[116:117], v[116:117], v[120:121]
    v_lshlrev_b32_e64 v120, 16, v111
    v_and_b32 v121, 0xffff0000, v111
    v_pk_add_f32 v[118:119], v[118:119], v[120:121]
    ds_write_b128 v123, v[112:115] offset:0
    ds_write_b128 v123, v[116:119] offset:16
    s_mov_b64 s[56:57], s[16:17]
    s_mov_b32 s58, 8388608
    s_mov_b32 s59, 0x20000
    s_lshl1_add_u32 s28, s33, s39
    s_lshl3_add_u32 s28, s28, s32
    s_mul_i32 s28, s28, 32768
    v_lshrrev_b32 v4, 5, v1
    v_mul_u32_u24 v4, 4096, v4
    v_and_b32_e64 v5, 31, v1
    v_lshl_add_u32 v4, v5, 7, v4
    buffer_load_dword v3, v4, s[56:59], s28 offen
    v_lshlrev_b32 v121, 2, v124
    s_and_b32 s29, s96, 3
    s_mul_i32 s29, s29, 1792
    s_add_u32 s29, s29, 40960
    s_waitcnt lgkmcnt(0)
    s_barrier
    ds_read_b32 v48, v121 offset:0
    ds_read_b32 v49, v121 offset:2048
    ds_read_b32 v50, v121 offset:4096
    ds_read_b32 v51, v121 offset:6144
    ds_read_b32 v52, v121 offset:8192
    ds_read_b32 v53, v121 offset:10240
    ds_read_b32 v54, v121 offset:12288
    ds_read_b32 v55, v121 offset:14336
    s_waitcnt lgkmcnt(0)
    v_add_f32 v48, v48, v49
    v_add_f32 v48, v48, v50
    v_add_f32 v48, v48, v51
    v_add_f32 v48, v48, v52
    v_add_f32 v48, v48, v53
    v_add_f32 v48, v48, v54
    v_add_f32 v48, v48, v55
    v_mov_b32 v120, v48
    s_cmp_eq_u32 s32, 7
    s_cbranch_scc1 .h7_188
    s_waitcnt lgkmcnt(0)
    buffer_atomic_add_f32 v120, v121, s[60:63], s29 offen sc1
.h7_188:
    s_waitcnt vmcnt(0) lgkmcnt(0)
    s_barrier
    s_cmp_lg_u32 s32, 0
    s_cbranch_scc1 .h4_189
    v_lshrrev_b32 v120, 2, v1
    v_and_b32 v121, 3, v1
    v_lshlrev_b32_e64 v120, 11, v120
    v_lshl_add_u32 v120, v121, 7, v120
    v_mov_b32_e64 v121, 1
    s_mov_b32 s29, 294912
    buffer_atomic_add v121, v120, s[52:55], s29 offen sc1
.h4_189:
    s_mov_b64 s[56:57], s[16:17]
    s_mov_b32 s58, 8388608
    s_mov_b32 s59, 0x20000
    s_lshl1_add_u32 s28, s33, s39
    s_lshl3_add_u32 s28, s28, s32
    s_mul_i32 s28, s28, 32768
    v_lshrrev_b32 v4, 5, v1
    v_mul_u32_u24 v4, 4096, v4
    v_and_b32_e64 v5, 31, v1
    v_lshl_add_u32 v4, v5, 7, v4
    s_add_u32 s28, s28, 8192
    buffer_load_dword v3, v4, s[56:59], s28 offen
    s_add_u32 s28, s28, 8192
    buffer_load_dword v3, v4, s[56:59], s28 offen
    s_add_u32 s28, s28, 8192
    buffer_load_dword v3, v4, s[56:59], s28 offen
    s_waitcnt vmcnt(0)
    s_cmp_lg_u32 s32, 4
    s_cbranch_scc1 .hs_190
    s_and_b32 s28, s33, 3
    s_lshl4_add_u32 s28, s36, s28
    s_lshl_b32 s28, s28, 7
.poll_191:
    s_load_dword s42, s[52:53], s28 offset:327680 glc
    s_sleep 32
    s_sub_u32 s38, s38, 1
    s_waitcnt lgkmcnt(0)
    s_cbranch_scc1 .pdone_192
    s_cmp_lt_u32 s42, 16
    s_cbranch_scc1 .poll_191
.pdone_192:
    s_max_i32 s38, s38, 0
.hs_190:
    s_barrier
    s_lshl_b32 s28, s33, 19
    s_add_u32 s56, s16, s28
    s_addc_u32 s57, s17, 0
    s_mov_b32 s58, 524288
    s_mov_b32 s59, 0x20000
    v_lshrrev_b32 v4, 2, v1
    v_lshl_add_u32 v4, s32, 4, v4
    v_lshlrev_b32 v4, 12, v4
    s_and_b32 s28, s33, 12
    s_add_u32 s29, s33, 1
    s_and_b32 s29, s29, 3
    s_lshl_b32 s29, s29, 1
    s_lshl1_add_u32 s28, s28, s29
    v_and_b32_e64 v5, 2, v1
    v_lshl_add_u32 v5, v5, 2, s28
    v_and_b32 v6, 1, v1
    v_add_u32 v5, v5, v6
    v_and_b32_e64 v5, 31, v5
    v_lshl_add_u32 v6, v5, 7, v4
    buffer_load_dword v3, v6, s[56:59], 0 offen
    v_xor_b32 v6, 2048, v6
    buffer_load_dword v3, v6, s[56:59], 0 offen
    s_mov_b64 s[56:57], s[20:21]
    s_mov_b32 s58, 3670016
    s_mov_b32 s59, 0x20000
    s_lshr_b32 s28, s2, 6
    s_lshl3_add_u32 s28, s28, s32
    s_lshl_b32 s28, s28, 14
    s_lshl_b32 s29, s39, 10
    s_add_u32 s28, s28, s29
    v_lshrrev_b32 v4, 3, v1
    v_lshlrev_b32 v4, 11, v4
    v_and_b32_e64 v5, 7, v1
    v_lshl_add_u32 v4, v5, 7, v4
    v_add_u32 v4, s28, v4
    s_and_b32 s28, s2, 6
    s_lshl_b32 s28, s28, 19
    s_and_b32 s30, s34, 3
    s_lshl4_add_u32 s30, s33, s30
    s_lshl_b32 s30, s30, 7
    buffer_load_dword v3, v4, s[56:59], s28 offen
    s_add_u32 s28, s28, 524288
    s_cmp_eq_u32 s28, 3670016
    s_cselect_b32 s28, 0, s28
    s_waitcnt vmcnt(0)
    buffer_load_dword v3, v4, s[56:59], s28 offen
    s_add_u32 s28, s28, 524288
    s_cmp_eq_u32 s28, 3670016
    s_cselect_b32 s28, 0, s28
    s_waitcnt vmcnt(0)
    buffer_load_dword v3, v4, s[56:59], s28 offen
    s_add_u32 s28, s28, 524288
    s_cmp_eq_u32 s28, 3670016
    s_cselect_b32 s28, 0, s28
    s_waitcnt vmcnt(0)
    s_load_dword s42, s[52:53], s30 offset:131072 glc
    s_waitcnt lgkmcnt(0)
    s_cmp_lg_u32 s42, 0
    s_cbranch_scc1 .hq_193
    buffer_load_dword v3, v4, s[56:59], s28 offen
    s_add_u32 s28, s28, 524288
    s_cmp_eq_u32 s28, 3670016
    s_cselect_b32 s28, 0, s28
    s_waitcnt vmcnt(0)
    s_load_dword s42, s[52:53], s30 offset:131072 glc
    s_waitcnt lgkmcnt(0)
    s_cmp_lg_u32 s42, 0
    s_cbranch_scc1 .hq_193
    buffer_load_dword v3, v4, s[56:59], s28 offen
    s_add_u32 s28, s28, 524288
    s_cmp_eq_u32 s28, 3670016
    s_cselect_b32 s28, 0, s28
    s_waitcnt vmcnt(0)
    s_load_dword s42, s[52:53], s30 offset:131072 glc
    s_waitcnt lgkmcnt(0)
    s_cmp_lg_u32 s42, 0
    s_cbranch_scc1 .hq_193
    buffer_load_dword v3, v4, s[56:59], s28 offen
    s_add_u32 s28, s28, 524288
    s_cmp_eq_u32 s28, 3670016
    s_cselect_b32 s28, 0, s28
    s_waitcnt vmcnt(0)
    s_load_dword s42, s[52:53], s30 offset:131072 glc
    s_waitcnt lgkmcnt(0)
    s_cmp_lg_u32 s42, 0
    s_cbranch_scc1 .hq_193
    buffer_load_dword v3, v4, s[56:59], s28 offen
    s_add_u32 s28, s28, 524288
    s_cmp_eq_u32 s28, 3670016
    s_cselect_b32 s28, 0, s28
    s_waitcnt vmcnt(0)
.hq_193:
    s_waitcnt vmcnt(0)
    s_waitcnt vmcnt(0)
    s_cmp_lt_u32 s32, 4
    s_cbranch_scc1 .hret_185
    s_cmp_lt_u32 s32, 6
    s_cbranch_scc1 .hret_39
    s_cmp_eq_u32 s32, 6
    s_cbranch_scc1 .hret_20
    s_branch .hret_139
.end_1:
    s_endpgm
.section .rodata,"a"
.p2align 6
.amdhsa_kernel sequential_preLN__linear_kernel_hedgehog__mixer_gmlp__prompt_kernel
  .amdhsa_next_free_vgpr 256
  .amdhsa_next_free_sgpr 102
  .amdhsa_accum_offset 256
  .amdhsa_group_segment_fixed_size 0
  .amdhsa_kernarg_size 96
  .amdhsa_user_sgpr_count 2
  .amdhsa_user_sgpr_kernarg_segment_ptr 1
  .amdhsa_system_sgpr_workgroup_id_x 1
  .amdhsa_float_denorm_mode_32 3
  .amdhsa_float_denorm_mode_16_64 3
.end_amdhsa_kernel
.text
```
